```python
import torch

def _softmax(x, axis=-1):
    return torch.softmax(x, dim=axis)

def _gelu(x):
    return torch.nn.functional.gelu(x, approximate='tanh')

def _silu(x):
    return torch.nn.functional.silu(x)

def _sigmoid(x):
    return torch.sigmoid(x)

def _layernorm(x, axis=-1, eps=1e-05):
    m = x.mean(dim=axis, keepdim=True)
    v = x.var(dim=axis, keepdim=True, unbiased=False)
    return (x - m) / torch.sqrt(v + eps)

def _scatter_add(tgt, idx, src, axis=0):
    return tgt.clone().index_add_(axis, idx, src)

def _segment_sum(src, seg, n):
    out = torch.zeros((n,) + src.shape[1:], dtype=src.dtype)
    return out.index_add_(0, seg, src)

def _pad(x, pw):
    flat = tuple((v for pair in reversed(pw) for v in pair))
    return torch.nn.functional.pad(x, flat)
kernel_name = 'adaLN_cond__sliding_block_cached__glu_gated_swiglu__prompt'

def setup_inputs():

    _w = lambda a: (lambda t: t.to(torch.bfloat16) if t.is_floating_point() else t)(torch.as_tensor(a))

    def _A_setup():
        B, Sq, D = (1, 2048, 640)
        Hq, Hkv, Sk, Dh = (32, 32, 2048, 192)
        assert Hq % Hkv == 0, (Hq, Hkv)
        return {'x': _w((lambda *s: torch.randn(*s, dtype=torch.bfloat16) * 0.05)(B, Sq, D)), 'k_cache': _w((lambda *s: torch.randn(*s, dtype=torch.bfloat16) * 1.6)(B, Hkv, Sk, Dh)), 'v_cache': _w((lambda *s: torch.randn(*s, dtype=torch.bfloat16) * 0.8)(B, Hkv, Sk, Dh)), 'wq': _w((lambda *s: torch.randn(*s, dtype=torch.bfloat16) * 1.6)(D, Hq * Dh) * D ** (-0.5)), 'wo': _w((lambda *s: torch.randn(*s, dtype=torch.bfloat16) * 0.8)(Hq * Dh, D) * (Hq * Dh) ** (-0.5))}
    _A_in = _A_setup()

    def _B_setup():
        B, S, D, F = (1, 2048, 640, 1536)
        return {'x': _w((lambda *s: torch.randn(*s, dtype=torch.bfloat16) * 0.05)(B, S, D)), 'w1': _w((lambda *s: torch.randn(*s, dtype=torch.bfloat16) * 0.4)(D, F) * (2.0 / D) ** 0.5), 'w3': _w((lambda *s: torch.randn(*s, dtype=torch.bfloat16) * 0.4)(D, F) * (2.0 / D) ** 0.5), 'w2': _w((lambda *s: torch.randn(*s, dtype=torch.bfloat16) * 0.4)(F, D) * (2.0 / F) ** 0.5)}
    _B_in = _B_setup()
    return {'A_x': _A_in['x'], 'A_k_cache': _A_in['k_cache'], 'A_v_cache': _A_in['v_cache'], 'A_wq': _A_in['wq'], 'A_wo': _A_in['wo'], 'B_x': _B_in['x'], 'B_w1': _B_in['w1'], 'B_w3': _B_in['w3'], 'B_w2': _B_in['w2'], 'c': _w((lambda *s: torch.randn(*s, dtype=torch.bfloat16) * 0.2)(1, 640) * 8.0), 'w_mod': _w((lambda *s: torch.randn(*s, dtype=torch.bfloat16) * 0.2)(640, 6 * 640) * 640 ** (-0.5) * 8.0)}

def reference(A_x, A_k_cache, A_v_cache, A_wq, A_wo, B_x, B_w1, B_w3, B_w2, c, w_mod):

    def _A_ref(x, k_cache, v_cache, wq, wo):
        B, Sq, D = x.shape
        Hq, Dh = (32, 192)
        Hkv, Sk = (k_cache.shape[1], k_cache.shape[2])
        W = min(4096, max(256, Sk // 4))
        rep = Hq // Hkv
        q = (lambda x, *d: x.permute(*d))((x @ wq).reshape(B, Sq, Hq, Dh), 0, 2, 1, 3)
        k = (lambda x, n, axis: torch.repeat_interleave(x, n, dim=axis))(k_cache[:, :, Sk - W:, :], rep, axis=1)
        v = (lambda x, n, axis: torch.repeat_interleave(x, n, dim=axis))(v_cache[:, :, Sk - W:, :], rep, axis=1)
        scores = torch.einsum('bhqd,bhkd->bhqk', q, k) * Dh ** (-0.5)
        p = _softmax(scores, axis=-1)
        o = torch.einsum('bhqk,bhkd->bhqd', p, v)
        return (lambda x, *d: x.permute(*d))(o, 0, 2, 1, 3).reshape(B, Sq, Hq * Dh) @ wo

    def _B_ref(x, w1, w3, w2):
        gate = torch.einsum('bsd,df->bsf', x, w1)
        up = torch.einsum('bsd,df->bsf', x, w3)
        h = _silu(gate) * up
        out = torch.einsum('bsf,fd->bsd', h, w2)
        return out
    x = A_x
    mod = (_silu(c) @ w_mod).reshape(c.shape[0], 6, 1, -1)
    sa, ca, ga, sb, cb, gb = (mod[:, 0].clone(), mod[:, 1].clone(), mod[:, 2].clone(), mod[:, 3].clone(), mod[:, 4].clone(), mod[:, 5].clone())
    h = _layernorm(x, axis=-1) * (1 + ca) + sa
    x = x + ga * _A_ref(h, A_k_cache, A_v_cache, A_wq, A_wo)
    h = _layernorm(x, axis=-1) * (1 + cb) + sb
    x = x + gb * _B_ref(h, B_w1, B_w3, B_w2)
    return x
```

```asm
; @launch grid=(256,1,1) block=(256,1,1) lds=163072
.amdgcn_target "amdgcn-amd-amdhsa--gfx950"
.text
.globl adaLN_cond__sliding_block_cached__glu_gated_swiglu__prompt_kernel
.p2align 8
.type adaLN_cond__sliding_block_cached__glu_gated_swiglu__prompt_kernel,@function
adaLN_cond__sliding_block_cached__glu_gated_swiglu__prompt_kernel:
  s_cmp_ge_u32 s2, 256
  s_cbranch_scc1 adaLN_cond__sliding_block_cached__glu_gated_swiglu__prompt_kernel_end
  s_load_dwordx2 s[52:53], s[0:1], 0
  s_load_dwordx2 s[50:51], s[0:1], 104
  s_load_dwordx2 s[44:45], s[0:1], 24
  s_load_dwordx2 s[46:47], s[0:1], 8
  s_load_dwordx2 s[48:49], s[0:1], 16
  s_load_dwordx2 s[54:55], s[0:1], 32
  s_load_dwordx2 s[56:57], s[0:1], 48
  s_load_dwordx2 s[58:59], s[0:1], 56
  s_load_dwordx2 s[60:61], s[0:1], 64
  s_load_dwordx2 s[62:63], s[0:1], 88
  s_load_dwordx2 s[84:85], s[0:1], 72
  s_load_dwordx2 s[86:87], s[0:1], 80
  s_load_dwordx2 s[88:89], s[0:1], 96
  v_and_b32 v255, 63, v0
  v_lshrrev_b32 v253, 6, v0
  s_nop 0
  v_readfirstlane_b32 s82, v253
  s_waitcnt lgkmcnt(0)
  s_cmp_ge_u32 s2, 60
  s_cbranch_scc1 role_late
s_mul_hi_u32 s29, s2, 0xccccccd
s_mul_i32 s28, s29, 20
s_sub_u32 s28, s2, s28
s_sub_u32 s36, s2, 60
s_mul_hi_u32 s37, s36, 0x6666667
s_mul_i32 s38, s37, 40
s_sub_u32 s38, s36, s38
s_add_u32 s38, s38, 20
s_cmp_ge_u32 s2, 60
s_cselect_b32 s28, s38, s28
s_cselect_b32 s29, s37, s29
v_and_b32 v29, 7, v0
v_lshrrev_b32 v30, 3, v0
s_movk_i32 s30, 7680
v_mul_lo_u32 v31, v30, s30
v_lshl_add_u32 v31, v29, 4, v31
v_lshlrev_b32 v32, 1, v30
s_mul_i32 s30, s29, 1720320
s_lshl_b32 s31, s28, 7
s_add_u32 s30, s30, s31
s_mul_i32 s31, s29, 448
s_mov_b32 s12, s84
s_mov_b32 s13, s85
s_mov_b32 s14, 1280
s_mov_b32 s15, 0x20000
s_mov_b32 s16, s86
s_mov_b32 s17, s87
s_mov_b32 s18, 4915200
s_mov_b32 s19, 0x20000
buffer_load_ushort v38, v32, s[12:15], s31 offen offset:0
buffer_load_ushort v39, v32, s[12:15], s31 offen offset:64
buffer_load_ushort v40, v32, s[12:15], s31 offen offset:128
buffer_load_ushort v41, v32, s[12:15], s31 offen offset:192
buffer_load_ushort v42, v32, s[12:15], s31 offen offset:256
buffer_load_ushort v43, v32, s[12:15], s31 offen offset:320
buffer_load_ushort v44, v32, s[12:15], s31 offen offset:384
buffer_load_dwordx4 v[52:55], v31, s[16:19], s30 offen
s_add_u32 s30, s30, 245760
buffer_load_dwordx4 v[56:59], v31, s[16:19], s30 offen
s_add_u32 s30, s30, 245760
buffer_load_dwordx4 v[60:63], v31, s[16:19], s30 offen
s_add_u32 s30, s30, 245760
buffer_load_dwordx4 v[64:67], v31, s[16:19], s30 offen
s_add_u32 s30, s30, 245760
buffer_load_dwordx4 v[68:71], v31, s[16:19], s30 offen
s_add_u32 s30, s30, 245760
buffer_load_dwordx4 v[72:75], v31, s[16:19], s30 offen
s_add_u32 s30, s30, 245760
buffer_load_dwordx4 v[76:79], v31, s[16:19], s30 offen
s_cmp_ge_u32 s2, 19
s_cbranch_scc1 role_noclr
s_add_u32 s32, s50, 62914560
s_addc_u32 s33, s51, 0
s_mov_b32 s34, 9728
s_mov_b32 s35, 0x20000
v_mov_b64 v[92:93], 0
v_mov_b64 v[94:95], 0
v_lshlrev_b32 v96, 4, v0
s_lshl_b32 s36, s2, 9
v_cmp_gt_u32 vcc, 32, v0
s_and_saveexec_b64 s[30:31], vcc
s_cbranch_execz role_clr_done
buffer_store_dwordx4 v[92:95], v96, s[32:35], s36 offen sc1
role_clr_done:
s_mov_b64 exec, s[30:31]
role_noclr:
role_late:
  v_and_b32 v1, 7, v255
  v_bfe_u32 v2, v255, 3, 2
  v_bfe_u32 v3, v255, 5, 1
  s_and_b32 s93, s2, 1
  s_lshl_b32 s93, s93, 3
  v_add_u32 v8, s93, v1
  s_lshr_b32 s93, s2, 1
  s_mul_i32 s92, s93, 20480
  s_mul_i32 s93, s82, 5
  v_add_u32 v5, s93, v3
  v_lshl_add_u32 v4, v2, 4, v8
  v_lshlrev_b32 v4, 4, v4
  v_lshl_add_u32 v4, v5, 10, v4
  v_lshlrev_b32 v7, 4, v1
  v_add_u32 v7, 151552, v7
  s_lshl_b32 s93, s82, 2
  v_add_u32 v6, s93, v7
  s_movk_i32 s93, 1280
  v_mul_lo_u32 v10, v8, s93
  v_lshl_add_u32 v10, v5, 6, v10
  v_lshl_add_u32 v10, v2, 4, v10
  v_lshlrev_b32 v11, 7, v5
  v_lshl_add_u32 v11, v2, 5, v11
  s_mov_b32 s12, s52
  s_mov_b32 s13, s53
  s_mov_b32 s14, 2621440
  s_mov_b32 s15, 0x20000
  buffer_load_dwordx4 v[16:19], v10, s[12:15], s92 offen offset:0
  buffer_load_dwordx4 v[20:23], v10, s[12:15], s92 offen offset:128
  s_mov_b32 exec_hi, 0
  buffer_load_dwordx4 v[24:27], v10, s[12:15], s92 offen offset:256
  s_mov_b32 exec_hi, -1
  v_mov_b32 v249, 0
  v_mov_b32 v248, 0x2a0000
  v_cmp_eq_u32 vcc, 1, v255
  s_nop 1
  v_cndmask_b32 v249, v249, v248, vcc
  v_mov_b32 v248, 62926848
  v_cmp_eq_u32 vcc, 2, v255
  s_nop 1
  v_cndmask_b32 v249, v249, v248, vcc
  global_load_dword a248, v249, s[50:51]
  v_mov_b32 v248, 128
  global_load_dword a249, v248, s[88:89] sc1
  s_getpc_b64 s[90:91]
adaLN_cond__sliding_block_cached__glu_gated_swiglu__prompt_kernel_pc:
  s_sub_u32 s90, s90, adaLN_cond__sliding_block_cached__glu_gated_swiglu__prompt_kernel_pc-adaLN_cond__sliding_block_cached__glu_gated_swiglu__prompt_kernel
  s_subb_u32 s91, s91, 0
  s_lshr_b32 s94, s2, 3
  s_mul_i32 s94, s94, 2048
  v_lshlrev_b32 v250, 4, v255
  v_add_u32 v250, s94, v250
  v_min_u32 v250, adaLN_cond__sliding_block_cached__glu_gated_swiglu__prompt_kernel_end-adaLN_cond__sliding_block_cached__glu_gated_swiglu__prompt_kernel-1040, v250
  global_load_dwordx4 a[244:247], v250, s[90:91] offset:0
  global_load_dwordx4 a[240:243], v250, s[90:91] offset:1024
  s_mul_i32 s40, s82, 192
  s_movk_i32 s41, 2731
  v_add_u32 v218, s40, v255
  v_mul_u32_u24 v219, s41, v218
  v_lshrrev_b32 v219, 16, v219
  v_mul_u32_u24 v220, 24, v219
  v_sub_u32 v220, v218, v220
  v_and_b32 v221, 24, v220
  v_and_b32 v220, 7, v220
  v_and_b32 v222, 2, v219
  v_lshlrev_b32 v222, 1, v222
  v_xor_b32 v222, v222, v220
  v_or_b32 v222, v222, v221
  v_lshlrev_b32 v222, 4, v222
  v_mul_u32_u24 v223, 0x3000, v219
  v_add_u32 v222, v222, v223
  v_mov_b32 v192, v222
  v_mov_b32 v195, v222
  v_mul_u32_u24 v223, 0x180, v219
  v_add_u32 v223, 2048, v223
  v_bfe_u32 v222, v219, 1, 3
  v_xor_b32 v222, v222, v220
  v_or_b32 v222, v222, v221
  v_lshl_add_u32 v208, v222, 4, v223
  v_and_b32 v222, 6, v219
  v_xor_b32 v222, v222, v220
  v_or_b32 v222, v222, v221
  v_lshl_add_u32 v211, v222, 4, v223
  v_add_u32 v218, s40, v255
  v_add_u32 v218, 64, v218
  v_mul_u32_u24 v219, s41, v218
  v_lshrrev_b32 v219, 16, v219
  v_mul_u32_u24 v220, 24, v219
  v_sub_u32 v220, v218, v220
  v_and_b32 v221, 24, v220
  v_and_b32 v220, 7, v220
  v_and_b32 v222, 2, v219
  v_lshlrev_b32 v222, 1, v222
  v_xor_b32 v222, v222, v220
  v_or_b32 v222, v222, v221
  v_lshlrev_b32 v222, 4, v222
  v_mul_u32_u24 v223, 0x3000, v219
  v_add_u32 v222, v222, v223
  v_subrev_u32 v222, 1024, v222
  v_mov_b32 v193, v222
  v_mov_b32 v196, v222
  v_mul_u32_u24 v223, 0x180, v219
  v_add_u32 v223, 1024, v223
  v_bfe_u32 v222, v219, 1, 3
  v_xor_b32 v222, v222, v220
  v_or_b32 v222, v222, v221
  v_lshl_add_u32 v209, v222, 4, v223
  v_and_b32 v222, 6, v219
  v_xor_b32 v222, v222, v220
  v_or_b32 v222, v222, v221
  v_lshl_add_u32 v212, v222, 4, v223
  v_add_u32 v218, s40, v255
  v_add_u32 v218, 128, v218
  v_mul_u32_u24 v219, s41, v218
  v_lshrrev_b32 v219, 16, v219
  v_mul_u32_u24 v220, 24, v219
  v_sub_u32 v220, v218, v220
  v_and_b32 v221, 24, v220
  v_and_b32 v220, 7, v220
  v_and_b32 v222, 2, v219
  v_lshlrev_b32 v222, 1, v222
  v_xor_b32 v222, v222, v220
  v_or_b32 v222, v222, v221
  v_lshlrev_b32 v222, 4, v222
  v_mul_u32_u24 v223, 0x3000, v219
  v_add_u32 v222, v222, v223
  v_subrev_u32 v222, 2048, v222
  v_mov_b32 v194, v222
  v_mov_b32 v197, v222
  v_mul_u32_u24 v223, 0x180, v219
  v_add_u32 v223, 0, v223
  v_bfe_u32 v222, v219, 1, 3
  v_xor_b32 v222, v222, v220
  v_or_b32 v222, v222, v221
  v_lshl_add_u32 v210, v222, 4, v223
  v_and_b32 v222, 6, v219
  v_xor_b32 v222, v222, v220
  v_or_b32 v222, v222, v221
  v_lshl_add_u32 v213, v222, 4, v223
  v_lshlrev_b32 v204, 4, v255
  v_lshlrev_b32 v205, 4, v255
  v_add_u32 v205, 20480, v205
  v_lshlrev_b32 v206, 4, v255
  v_add_u32 v206, 40960, v206
  v_lshlrev_b32 v207, 4, v255
  v_add_u32 v207, 61440, v207
  v_and_b32 v218, 15, v255
  v_lshrrev_b32 v219, 4, v255
  v_lshrrev_b32 v220, 2, v218
  v_lshl_add_u32 v220, v219, 3, v220
  v_mul_u32_u24 v220, 0x180, v220
  v_and_b32 v221, 3, v218
  v_and_b32 v222, 8, v218
  v_lshrrev_b32 v222, 1, v222
  v_or_b32 v223, 0, v221
  v_xor_b32 v223, v223, v222
  v_lshl_add_u32 v198, v223, 4, v220
  v_or_b32 v223, 4, v221
  v_xor_b32 v223, v223, v222
  v_lshl_add_u32 v199, v223, 4, v220
  v_mul_u32_u24 v220, 0x180, v218
  v_add_u32 v220, 98304, v220
  v_lshrrev_b32 v221, 1, v218
  v_or_b32 v223, 0, v219
  v_xor_b32 v223, v223, v221
  v_lshl_add_u32 v214, v223, 4, v220
  v_or_b32 v223, 4, v219
  v_xor_b32 v223, v223, v221
  v_lshl_add_u32 v215, v223, 4, v220
  v_lshrrev_b32 v220, 2, v218
  v_lshl_add_u32 v220, v219, 2, v220
  v_mul_u32_u24 v220, 0x180, v220
  v_add_u32 v220, 122880, v220
  v_bfe_u32 v221, v218, 1, 1
  v_lshl_add_u32 v220, v221, 4, v220
  v_and_b32 v221, 1, v218
  v_lshl_add_u32 v220, v221, 3, v220
  v_and_b32 v221, 1, v219
  v_lshlrev_b32 v221, 1, v221
  v_lshrrev_b32 v222, 3, v218
  v_or_b32 v221, v221, v222
  v_xor_b32 v223, 0, v221
  v_lshl_add_u32 v200, v223, 5, v220
  v_xor_b32 v223, 1, v221
  v_lshl_add_u32 v201, v223, 5, v220
  v_xor_b32 v223, 2, v221
  v_lshl_add_u32 v202, v223, 5, v220
  v_xor_b32 v223, 3, v221
  v_lshl_add_u32 v203, v223, 5, v220
  v_accvgpr_write_b32 a64, 0
  v_accvgpr_write_b32 a65, 0
  v_accvgpr_write_b32 a66, 0
  v_accvgpr_write_b32 a67, 0
  v_accvgpr_write_b32 a68, 0
  v_accvgpr_write_b32 a69, 0
  v_accvgpr_write_b32 a70, 0
  v_accvgpr_write_b32 a71, 0
  v_accvgpr_write_b32 a72, 0
  v_accvgpr_write_b32 a73, 0
  v_accvgpr_write_b32 a74, 0
  v_accvgpr_write_b32 a75, 0
  v_accvgpr_write_b32 a76, 0
  v_accvgpr_write_b32 a77, 0
  v_accvgpr_write_b32 a78, 0
  v_accvgpr_write_b32 a79, 0
  v_accvgpr_write_b32 a80, 0
  v_accvgpr_write_b32 a81, 0
  v_accvgpr_write_b32 a82, 0
  v_accvgpr_write_b32 a83, 0
  v_accvgpr_write_b32 a84, 0
  v_accvgpr_write_b32 a85, 0
  v_accvgpr_write_b32 a86, 0
  v_accvgpr_write_b32 a87, 0
  v_accvgpr_write_b32 a88, 0
  v_accvgpr_write_b32 a89, 0
  v_accvgpr_write_b32 a90, 0
  v_accvgpr_write_b32 a91, 0
  v_accvgpr_write_b32 a92, 0
  v_accvgpr_write_b32 a93, 0
  v_accvgpr_write_b32 a94, 0
  v_accvgpr_write_b32 a95, 0
  v_accvgpr_write_b32 a96, 0
  v_accvgpr_write_b32 a97, 0
  v_accvgpr_write_b32 a98, 0
  v_accvgpr_write_b32 a99, 0
  v_accvgpr_write_b32 a100, 0
  v_accvgpr_write_b32 a101, 0
  v_accvgpr_write_b32 a102, 0
  v_accvgpr_write_b32 a103, 0
  v_accvgpr_write_b32 a104, 0
  v_accvgpr_write_b32 a105, 0
  v_accvgpr_write_b32 a106, 0
  v_accvgpr_write_b32 a107, 0
  v_accvgpr_write_b32 a108, 0
  v_accvgpr_write_b32 a109, 0
  v_accvgpr_write_b32 a110, 0
  v_accvgpr_write_b32 a111, 0
  v_accvgpr_write_b32 a112, 0
  v_accvgpr_write_b32 a113, 0
  v_accvgpr_write_b32 a114, 0
  v_accvgpr_write_b32 a115, 0
  v_accvgpr_write_b32 a116, 0
  v_accvgpr_write_b32 a117, 0
  v_accvgpr_write_b32 a118, 0
  v_accvgpr_write_b32 a119, 0
  v_accvgpr_write_b32 a120, 0
  v_accvgpr_write_b32 a121, 0
  v_accvgpr_write_b32 a122, 0
  v_accvgpr_write_b32 a123, 0
  v_accvgpr_write_b32 a124, 0
  v_accvgpr_write_b32 a125, 0
  v_accvgpr_write_b32 a126, 0
  v_accvgpr_write_b32 a127, 0
  v_accvgpr_write_b32 a128, 0
  v_accvgpr_write_b32 a129, 0
  v_accvgpr_write_b32 a130, 0
  v_accvgpr_write_b32 a131, 0
  v_accvgpr_write_b32 a132, 0
  v_accvgpr_write_b32 a133, 0
  v_accvgpr_write_b32 a134, 0
  v_accvgpr_write_b32 a135, 0
  v_accvgpr_write_b32 a136, 0
  v_accvgpr_write_b32 a137, 0
  v_accvgpr_write_b32 a138, 0
  v_accvgpr_write_b32 a139, 0
  v_accvgpr_write_b32 a140, 0
  v_accvgpr_write_b32 a141, 0
  v_accvgpr_write_b32 a142, 0
  v_accvgpr_write_b32 a143, 0
  v_accvgpr_write_b32 a144, 0
  v_accvgpr_write_b32 a145, 0
  v_accvgpr_write_b32 a146, 0
  v_accvgpr_write_b32 a147, 0
  v_accvgpr_write_b32 a148, 0
  v_accvgpr_write_b32 a149, 0
  v_accvgpr_write_b32 a150, 0
  v_accvgpr_write_b32 a151, 0
  v_accvgpr_write_b32 a152, 0
  v_accvgpr_write_b32 a153, 0
  v_accvgpr_write_b32 a154, 0
  v_accvgpr_write_b32 a155, 0
  v_accvgpr_write_b32 a156, 0
  v_accvgpr_write_b32 a157, 0
  v_accvgpr_write_b32 a158, 0
  v_accvgpr_write_b32 a159, 0
  v_accvgpr_write_b32 a160, 0
  v_accvgpr_write_b32 a161, 0
  v_accvgpr_write_b32 a162, 0
  v_accvgpr_write_b32 a163, 0
  v_accvgpr_write_b32 a164, 0
  v_accvgpr_write_b32 a165, 0
  v_accvgpr_write_b32 a166, 0
  v_accvgpr_write_b32 a167, 0
  v_accvgpr_write_b32 a168, 0
  v_accvgpr_write_b32 a169, 0
  v_accvgpr_write_b32 a170, 0
  v_accvgpr_write_b32 a171, 0
  v_accvgpr_write_b32 a172, 0
  v_accvgpr_write_b32 a173, 0
  v_accvgpr_write_b32 a174, 0
  v_accvgpr_write_b32 a175, 0
  v_accvgpr_write_b32 a176, 0
  v_accvgpr_write_b32 a177, 0
  v_accvgpr_write_b32 a178, 0
  v_accvgpr_write_b32 a179, 0
  v_accvgpr_write_b32 a180, 0
  v_accvgpr_write_b32 a181, 0
  v_accvgpr_write_b32 a182, 0
  v_accvgpr_write_b32 a183, 0
  v_accvgpr_write_b32 a184, 0
  v_accvgpr_write_b32 a185, 0
  v_accvgpr_write_b32 a186, 0
  v_accvgpr_write_b32 a187, 0
  v_accvgpr_write_b32 a188, 0
  v_accvgpr_write_b32 a189, 0
  v_accvgpr_write_b32 a190, 0
  v_accvgpr_write_b32 a191, 0
  s_mul_i32 s94, s82, 320
  v_add_u32 v246, s94, v255
  v_mul_u32_u24 v247, 3277, v246
  v_lshrrev_b32 v247, 16, v247
  v_mul_u32_u24 v248, 20, v247
  v_sub_u32 v248, v246, v248
  v_lshrrev_b32 v249, 1, v247
  v_and_b32 v249, 2, v249
  v_xor_b32 v248, v249, v248
  v_mul_u32_u24 v247, 1280, v247
  v_lshl_add_u32 v232, v248, 4, v247
  v_add_u32 v246, s94, v255
  v_add_u32 v246, 64, v246
  v_mul_u32_u24 v247, 3277, v246
  v_lshrrev_b32 v247, 16, v247
  v_mul_u32_u24 v248, 20, v247
  v_sub_u32 v248, v246, v248
  v_lshrrev_b32 v249, 1, v247
  v_and_b32 v249, 2, v249
  v_xor_b32 v248, v249, v248
  v_mul_u32_u24 v247, 1280, v247
  v_lshl_add_u32 v233, v248, 4, v247
  v_subrev_u32 v233, 1024, v233
  v_add_u32 v246, s94, v255
  v_add_u32 v246, 128, v246
  v_mul_u32_u24 v247, 3277, v246
  v_lshrrev_b32 v247, 16, v247
  v_mul_u32_u24 v248, 20, v247
  v_sub_u32 v248, v246, v248
  v_lshrrev_b32 v249, 1, v247
  v_and_b32 v249, 2, v249
  v_xor_b32 v248, v249, v248
  v_mul_u32_u24 v247, 1280, v247
  v_lshl_add_u32 v234, v248, 4, v247
  v_subrev_u32 v234, 2048, v234
  v_add_u32 v246, s94, v255
  v_add_u32 v246, 192, v246
  v_mul_u32_u24 v247, 3277, v246
  v_lshrrev_b32 v247, 16, v247
  v_mul_u32_u24 v248, 20, v247
  v_sub_u32 v248, v246, v248
  v_lshrrev_b32 v249, 1, v247
  v_and_b32 v249, 2, v249
  v_xor_b32 v248, v249, v248
  v_mul_u32_u24 v247, 1280, v247
  v_lshl_add_u32 v235, v248, 4, v247
  v_subrev_u32 v235, 3072, v235
  v_add_u32 v246, s94, v255
  v_add_u32 v246, 256, v246
  v_mul_u32_u24 v247, 3277, v246
  v_lshrrev_b32 v247, 16, v247
  v_mul_u32_u24 v248, 20, v247
  v_sub_u32 v248, v246, v248
  v_lshrrev_b32 v249, 1, v247
  v_and_b32 v249, 2, v249
  v_xor_b32 v248, v249, v248
  v_mul_u32_u24 v247, 1280, v247
  v_lshl_add_u32 v236, v248, 4, v247
  s_mul_i32 s94, s82, 192
  v_add_u32 v246, s94, v255
  v_mul_u32_u24 v247, 5462, v246
  v_lshrrev_b32 v247, 16, v247
  v_mul_u32_u24 v248, 12, v247
  v_sub_u32 v248, v246, v248
  v_lshrrev_b32 v249, 1, v247
  v_and_b32 v249, 2, v249
  v_xor_b32 v248, v249, v248
  v_mul_u32_u24 v247, 3072, v247
  v_lshl_add_u32 v237, v248, 4, v247
  v_add_u32 v246, s94, v255
  v_add_u32 v246, 64, v246
  v_mul_u32_u24 v247, 5462, v246
  v_lshrrev_b32 v247, 16, v247
  v_mul_u32_u24 v248, 12, v247
  v_sub_u32 v248, v246, v248
  v_lshrrev_b32 v249, 1, v247
  v_and_b32 v249, 2, v249
  v_xor_b32 v248, v249, v248
  v_mul_u32_u24 v247, 3072, v247
  v_lshl_add_u32 v238, v248, 4, v247
  v_subrev_u32 v238, 1024, v238
  v_add_u32 v246, s94, v255
  v_add_u32 v246, 128, v246
  v_mul_u32_u24 v247, 5462, v246
  v_lshrrev_b32 v247, 16, v247
  v_mul_u32_u24 v248, 12, v247
  v_sub_u32 v248, v246, v248
  v_lshrrev_b32 v249, 1, v247
  v_and_b32 v249, 2, v249
  v_xor_b32 v248, v249, v248
  v_mul_u32_u24 v247, 3072, v247
  v_lshl_add_u32 v239, v248, 4, v247
  v_subrev_u32 v239, 2048, v239
  v_lshlrev_b32 v240, 4, v255
  v_add_u32 v241, 4096, v240
  s_cmp_lt_u32 s2, 60
  s_cbranch_scc1 role_issued
  s_cmp_ge_u32 s2, 180
  s_cbranch_scc1 role_not_a
s_mul_hi_u32 s29, s2, 0xccccccd
s_mul_i32 s28, s29, 20
s_sub_u32 s28, s2, s28
s_sub_u32 s36, s2, 60
s_mul_hi_u32 s37, s36, 0x6666667
s_mul_i32 s38, s37, 40
s_sub_u32 s38, s36, s38
s_add_u32 s38, s38, 20
s_cmp_ge_u32 s2, 60
s_cselect_b32 s28, s38, s28
s_cselect_b32 s29, s37, s29
v_and_b32 v29, 7, v0
v_lshrrev_b32 v30, 3, v0
s_movk_i32 s30, 7680
v_mul_lo_u32 v31, v30, s30
v_lshl_add_u32 v31, v29, 4, v31
v_lshlrev_b32 v32, 1, v30
s_mul_i32 s30, s29, 1720320
s_lshl_b32 s31, s28, 7
s_add_u32 s30, s30, s31
s_mul_i32 s31, s29, 448
s_mov_b32 s12, s84
s_mov_b32 s13, s85
s_mov_b32 s14, 1280
s_mov_b32 s15, 0x20000
s_mov_b32 s16, s86
s_mov_b32 s17, s87
s_mov_b32 s18, 4915200
s_mov_b32 s19, 0x20000
buffer_load_ushort v38, v32, s[12:15], s31 offen offset:0
buffer_load_ushort v39, v32, s[12:15], s31 offen offset:64
buffer_load_ushort v40, v32, s[12:15], s31 offen offset:128
buffer_load_ushort v41, v32, s[12:15], s31 offen offset:192
buffer_load_ushort v42, v32, s[12:15], s31 offen offset:256
buffer_load_ushort v43, v32, s[12:15], s31 offen offset:320
buffer_load_ushort v44, v32, s[12:15], s31 offen offset:384
buffer_load_dwordx4 v[52:55], v31, s[16:19], s30 offen
s_add_u32 s30, s30, 245760
buffer_load_dwordx4 v[56:59], v31, s[16:19], s30 offen
s_add_u32 s30, s30, 245760
buffer_load_dwordx4 v[60:63], v31, s[16:19], s30 offen
s_add_u32 s30, s30, 245760
buffer_load_dwordx4 v[64:67], v31, s[16:19], s30 offen
s_add_u32 s30, s30, 245760
buffer_load_dwordx4 v[68:71], v31, s[16:19], s30 offen
s_add_u32 s30, s30, 245760
buffer_load_dwordx4 v[72:75], v31, s[16:19], s30 offen
s_add_u32 s30, s30, 245760
buffer_load_dwordx4 v[76:79], v31, s[16:19], s30 offen
  s_branch role_issued
role_not_a:
  s_cmp_ge_u32 s2, 240
  s_cbranch_scc1 role_issued
v_mov_b32 v30, v255
v_bfe_u32 v31, v30, 4, 2
v_lshlrev_b32 v31, 1, v31
v_and_b32 v32, 7, v30
v_xor_b32 v31, v31, v32
v_lshlrev_b32 v31, 4, v31
v_lshrrev_b32 v32, 3, v30
v_mul_u32_u24 v34, 1280, v32
v_add_u32 v34, v34, v31
s_mul_i32 s29, s82, 8192
s_add_u32 s29, s29, 98304
s_mov_b32 s20, s60
s_mov_b32 s21, s61
s_mov_b32 s22, 1966080
s_mov_b32 s23, 0x20000
s_sub_u32 s30, s2, 180
s_lshl_b32 s30, s30, 3
s_lshl_b32 s31, s82, 1
s_add_u32 s30, s30, s31
s_mul_hi_u32 s33, s30, 0x1999999a
s_mul_i32 s34, s33, 10
s_sub_u32 s34, s30, s34
s_mul_i32 s37, s33, 40960
s_lshl_b32 s36, s34, 7
s_add_u32 s37, s37, s36
s_add_u32 m0, s29, 0
s_add_u32 s38, s37, 0
buffer_load_dwordx4 v34, s[20:23], s38 offen lds
s_add_u32 m0, s29, 1024
s_add_u32 s38, s37, 10240
buffer_load_dwordx4 v34, s[20:23], s38 offen lds
s_add_u32 m0, s29, 2048
s_add_u32 s38, s37, 20480
buffer_load_dwordx4 v34, s[20:23], s38 offen lds
s_add_u32 m0, s29, 3072
s_add_u32 s38, s37, 30720
buffer_load_dwordx4 v34, s[20:23], s38 offen lds
s_sub_u32 s30, s2, 180
s_lshl_b32 s30, s30, 3
s_lshl_b32 s31, s82, 1
s_add_u32 s30, s30, s31
s_add_u32 s30, s30, 1
s_mul_hi_u32 s33, s30, 0x1999999a
s_mul_i32 s34, s33, 10
s_sub_u32 s34, s30, s34
s_mul_i32 s37, s33, 40960
s_lshl_b32 s36, s34, 7
s_add_u32 s37, s37, s36
s_add_u32 m0, s29, 4096
s_add_u32 s38, s37, 0
buffer_load_dwordx4 v34, s[20:23], s38 offen lds
s_add_u32 m0, s29, 5120
s_add_u32 s38, s37, 10240
buffer_load_dwordx4 v34, s[20:23], s38 offen lds
s_add_u32 m0, s29, 6144
s_add_u32 s38, s37, 20480
buffer_load_dwordx4 v34, s[20:23], s38 offen lds
s_add_u32 m0, s29, 7168
s_add_u32 s38, s37, 30720
buffer_load_dwordx4 v34, s[20:23], s38 offen lds
role_issued:
  s_cmp_lt_u32 s2, 60
  s_cbranch_scc1 role_nopf
s_mov_b32 s24, s44
s_mov_b32 s25, s45
s_mov_b32 s26, 7864320
s_mov_b32 s27, 0x20000
s_and_b32 s94, s2, 7
s_lshl_b32 s94, s94, 2
s_bfe_u32 s95, s2, 0x20003
s_add_u32 s94, s94, s95
s_mul_i32 s94, s94, 384
s_lshr_b32 s95, s2, 5
s_mul_i32 s95, s95, 393216
s_add_u32 s94, s94, s95
s_mul_i32 s95, s82, 3072
s_add_u32 m0, s95, 73728
s_nop 0
buffer_load_dwordx4 v192, s[24:27], s94 offen lds
buffer_load_dwordx4 v193, s[24:27], s94 offen offset:1024 lds
buffer_load_dwordx4 v194, s[24:27], s94 offen offset:2048 lds
role_nopf:
  s_cmp_ge_u32 s2, 60
  s_cbranch_scc1 role_x_late
v_mov_b64 v[92:93], 0
v_mov_b64 v[94:95], 0
v_mov_b64 v[96:97], 0
v_mov_b64 v[98:99], 0
s_mov_b32 s30, 0xbfb8aa3b
s_waitcnt vmcnt(14)
v_lshlrev_b32 v38, 16, v38
v_lshlrev_b32 v39, 16, v39
v_lshlrev_b32 v40, 16, v40
v_lshlrev_b32 v41, 16, v41
v_lshlrev_b32 v42, 16, v42
v_lshlrev_b32 v43, 16, v43
v_lshlrev_b32 v44, 16, v44
v_mul_f32 v108, s30, v38
v_mul_f32 v109, s30, v39
v_mul_f32 v110, s30, v40
v_mul_f32 v111, s30, v41
v_mul_f32 v112, s30, v42
v_mul_f32 v113, s30, v43
v_mul_f32 v114, s30, v44
v_exp_f32 v108, v108
v_exp_f32 v109, v109
v_exp_f32 v110, v110
v_exp_f32 v111, v111
v_exp_f32 v112, v112
v_exp_f32 v113, v113
v_exp_f32 v114, v114
v_add_f32 v108, 1.0, v108
v_add_f32 v109, 1.0, v109
v_add_f32 v110, 1.0, v110
v_add_f32 v111, 1.0, v111
v_add_f32 v112, 1.0, v112
v_add_f32 v113, 1.0, v113
v_add_f32 v114, 1.0, v114
v_rcp_f32 v108, v108
v_rcp_f32 v109, v109
v_rcp_f32 v110, v110
v_rcp_f32 v111, v111
v_rcp_f32 v112, v112
v_rcp_f32 v113, v113
v_rcp_f32 v114, v114
v_mul_f32 v38, v38, v108
v_mul_f32 v39, v39, v109
v_mul_f32 v40, v40, v110
v_mul_f32 v41, v41, v111
v_mul_f32 v42, v42, v112
v_mul_f32 v43, v43, v113
v_mul_f32 v44, v44, v114
v_cvt_pk_bf16_f32 v38, v38, v38
v_and_b32 v38, 0xffff0000, v38
v_cvt_pk_bf16_f32 v39, v39, v39
v_and_b32 v39, 0xffff0000, v39
v_cvt_pk_bf16_f32 v40, v40, v40
v_and_b32 v40, 0xffff0000, v40
v_cvt_pk_bf16_f32 v41, v41, v41
v_and_b32 v41, 0xffff0000, v41
v_cvt_pk_bf16_f32 v42, v42, v42
v_and_b32 v42, 0xffff0000, v42
v_cvt_pk_bf16_f32 v43, v43, v43
v_and_b32 v43, 0xffff0000, v43
v_cvt_pk_bf16_f32 v44, v44, v44
v_and_b32 v44, 0xffff0000, v44
s_waitcnt vmcnt(7)
v_lshlrev_b32 v116, 16, v52
v_and_b32 v117, 0xffff0000, v52
v_pk_fma_f32 v[92:93], v[116:117], v[38:39], v[92:93] op_sel:[0,0,0] op_sel_hi:[1,0,1]
v_lshlrev_b32 v118, 16, v53
v_and_b32 v119, 0xffff0000, v53
v_pk_fma_f32 v[94:95], v[118:119], v[38:39], v[94:95] op_sel:[0,0,0] op_sel_hi:[1,0,1]
v_lshlrev_b32 v116, 16, v54
v_and_b32 v117, 0xffff0000, v54
v_pk_fma_f32 v[96:97], v[116:117], v[38:39], v[96:97] op_sel:[0,0,0] op_sel_hi:[1,0,1]
v_lshlrev_b32 v118, 16, v55
v_and_b32 v119, 0xffff0000, v55
v_pk_fma_f32 v[98:99], v[118:119], v[38:39], v[98:99] op_sel:[0,0,0] op_sel_hi:[1,0,1]
v_lshlrev_b32 v116, 16, v56
v_and_b32 v117, 0xffff0000, v56
v_pk_fma_f32 v[92:93], v[116:117], v[38:39], v[92:93] op_sel:[0,1,0] op_sel_hi:[1,1,1]
v_lshlrev_b32 v118, 16, v57
v_and_b32 v119, 0xffff0000, v57
v_pk_fma_f32 v[94:95], v[118:119], v[38:39], v[94:95] op_sel:[0,1,0] op_sel_hi:[1,1,1]
v_lshlrev_b32 v116, 16, v58
v_and_b32 v117, 0xffff0000, v58
v_pk_fma_f32 v[96:97], v[116:117], v[38:39], v[96:97] op_sel:[0,1,0] op_sel_hi:[1,1,1]
v_lshlrev_b32 v118, 16, v59
v_and_b32 v119, 0xffff0000, v59
v_pk_fma_f32 v[98:99], v[118:119], v[38:39], v[98:99] op_sel:[0,1,0] op_sel_hi:[1,1,1]
v_lshlrev_b32 v116, 16, v60
v_and_b32 v117, 0xffff0000, v60
v_pk_fma_f32 v[92:93], v[116:117], v[40:41], v[92:93] op_sel:[0,0,0] op_sel_hi:[1,0,1]
v_lshlrev_b32 v118, 16, v61
v_and_b32 v119, 0xffff0000, v61
v_pk_fma_f32 v[94:95], v[118:119], v[40:41], v[94:95] op_sel:[0,0,0] op_sel_hi:[1,0,1]
v_lshlrev_b32 v116, 16, v62
v_and_b32 v117, 0xffff0000, v62
v_pk_fma_f32 v[96:97], v[116:117], v[40:41], v[96:97] op_sel:[0,0,0] op_sel_hi:[1,0,1]
v_lshlrev_b32 v118, 16, v63
v_and_b32 v119, 0xffff0000, v63
v_pk_fma_f32 v[98:99], v[118:119], v[40:41], v[98:99] op_sel:[0,0,0] op_sel_hi:[1,0,1]
v_lshlrev_b32 v116, 16, v64
v_and_b32 v117, 0xffff0000, v64
v_pk_fma_f32 v[92:93], v[116:117], v[40:41], v[92:93] op_sel:[0,1,0] op_sel_hi:[1,1,1]
v_lshlrev_b32 v118, 16, v65
v_and_b32 v119, 0xffff0000, v65
v_pk_fma_f32 v[94:95], v[118:119], v[40:41], v[94:95] op_sel:[0,1,0] op_sel_hi:[1,1,1]
v_lshlrev_b32 v116, 16, v66
v_and_b32 v117, 0xffff0000, v66
v_pk_fma_f32 v[96:97], v[116:117], v[40:41], v[96:97] op_sel:[0,1,0] op_sel_hi:[1,1,1]
v_lshlrev_b32 v118, 16, v67
v_and_b32 v119, 0xffff0000, v67
v_pk_fma_f32 v[98:99], v[118:119], v[40:41], v[98:99] op_sel:[0,1,0] op_sel_hi:[1,1,1]
v_lshlrev_b32 v116, 16, v68
v_and_b32 v117, 0xffff0000, v68
v_pk_fma_f32 v[92:93], v[116:117], v[42:43], v[92:93] op_sel:[0,0,0] op_sel_hi:[1,0,1]
v_lshlrev_b32 v118, 16, v69
v_and_b32 v119, 0xffff0000, v69
v_pk_fma_f32 v[94:95], v[118:119], v[42:43], v[94:95] op_sel:[0,0,0] op_sel_hi:[1,0,1]
v_lshlrev_b32 v116, 16, v70
v_and_b32 v117, 0xffff0000, v70
v_pk_fma_f32 v[96:97], v[116:117], v[42:43], v[96:97] op_sel:[0,0,0] op_sel_hi:[1,0,1]
v_lshlrev_b32 v118, 16, v71
v_and_b32 v119, 0xffff0000, v71
v_pk_fma_f32 v[98:99], v[118:119], v[42:43], v[98:99] op_sel:[0,0,0] op_sel_hi:[1,0,1]
v_lshlrev_b32 v116, 16, v72
v_and_b32 v117, 0xffff0000, v72
v_pk_fma_f32 v[92:93], v[116:117], v[42:43], v[92:93] op_sel:[0,1,0] op_sel_hi:[1,1,1]
v_lshlrev_b32 v118, 16, v73
v_and_b32 v119, 0xffff0000, v73
v_pk_fma_f32 v[94:95], v[118:119], v[42:43], v[94:95] op_sel:[0,1,0] op_sel_hi:[1,1,1]
v_lshlrev_b32 v116, 16, v74
v_and_b32 v117, 0xffff0000, v74
v_pk_fma_f32 v[96:97], v[116:117], v[42:43], v[96:97] op_sel:[0,1,0] op_sel_hi:[1,1,1]
v_lshlrev_b32 v118, 16, v75
v_and_b32 v119, 0xffff0000, v75
v_pk_fma_f32 v[98:99], v[118:119], v[42:43], v[98:99] op_sel:[0,1,0] op_sel_hi:[1,1,1]
v_lshlrev_b32 v116, 16, v76
v_and_b32 v117, 0xffff0000, v76
v_pk_fma_f32 v[92:93], v[116:117], v[44:45], v[92:93] op_sel:[0,0,0] op_sel_hi:[1,0,1]
v_lshlrev_b32 v118, 16, v77
v_and_b32 v119, 0xffff0000, v77
v_pk_fma_f32 v[94:95], v[118:119], v[44:45], v[94:95] op_sel:[0,0,0] op_sel_hi:[1,0,1]
v_lshlrev_b32 v116, 16, v78
v_and_b32 v117, 0xffff0000, v78
v_pk_fma_f32 v[96:97], v[116:117], v[44:45], v[96:97] op_sel:[0,0,0] op_sel_hi:[1,0,1]
v_lshlrev_b32 v118, 16, v79
v_and_b32 v119, 0xffff0000, v79
v_pk_fma_f32 v[98:99], v[118:119], v[44:45], v[98:99] op_sel:[0,0,0] op_sel_hi:[1,0,1]
v_mov_b32 v100, v92
v_mov_b32 v101, v93
v_mov_b32 v102, v94
v_mov_b32 v103, v95
v_mov_b32 v104, v96
v_mov_b32 v105, v97
v_mov_b32 v106, v98
v_mov_b32 v107, v99
s_nop 1
v_add_f32_dpp v92, v100, v92 row_ror:8 row_mask:0xf bank_mask:0xf
v_add_f32_dpp v93, v101, v93 row_ror:8 row_mask:0xf bank_mask:0xf
v_add_f32_dpp v94, v102, v94 row_ror:8 row_mask:0xf bank_mask:0xf
v_add_f32_dpp v95, v103, v95 row_ror:8 row_mask:0xf bank_mask:0xf
v_add_f32_dpp v96, v104, v96 row_ror:8 row_mask:0xf bank_mask:0xf
v_add_f32_dpp v97, v105, v97 row_ror:8 row_mask:0xf bank_mask:0xf
v_add_f32_dpp v98, v106, v98 row_ror:8 row_mask:0xf bank_mask:0xf
v_add_f32_dpp v99, v107, v99 row_ror:8 row_mask:0xf bank_mask:0xf
v_mov_b32 v100, v92
v_mov_b32 v101, v93
v_mov_b32 v102, v94
v_mov_b32 v103, v95
v_mov_b32 v104, v96
v_mov_b32 v105, v97
v_mov_b32 v106, v98
v_mov_b32 v107, v99
s_nop 1
v_permlane16_swap_b32 v100, v92
v_permlane16_swap_b32 v101, v93
v_permlane16_swap_b32 v102, v94
v_permlane16_swap_b32 v103, v95
v_permlane16_swap_b32 v104, v96
v_permlane16_swap_b32 v105, v97
v_permlane16_swap_b32 v106, v98
v_permlane16_swap_b32 v107, v99
v_add_f32 v92, v100, v92
v_add_f32 v93, v101, v93
v_add_f32 v94, v102, v94
v_add_f32 v95, v103, v95
v_add_f32 v96, v104, v96
v_add_f32 v97, v105, v97
v_add_f32 v98, v106, v98
v_add_f32 v99, v107, v99
v_mov_b32 v100, v92
v_mov_b32 v101, v93
v_mov_b32 v102, v94
v_mov_b32 v103, v95
v_mov_b32 v104, v96
v_mov_b32 v105, v97
v_mov_b32 v106, v98
v_mov_b32 v107, v99
s_nop 1
v_permlane32_swap_b32 v100, v92
v_permlane32_swap_b32 v101, v93
v_permlane32_swap_b32 v102, v94
v_permlane32_swap_b32 v103, v95
v_permlane32_swap_b32 v104, v96
v_permlane32_swap_b32 v105, v97
v_permlane32_swap_b32 v106, v98
v_permlane32_swap_b32 v107, v99
v_add_f32 v92, v100, v92
v_add_f32 v93, v101, v93
v_add_f32 v94, v102, v94
v_add_f32 v95, v103, v95
v_add_f32 v96, v104, v96
v_add_f32 v97, v105, v97
v_add_f32 v98, v106, v98
v_add_f32 v99, v107, v99
v_lshrrev_b32 v33, 6, v0
v_lshlrev_b32 v33, 8, v33
v_lshl_add_u32 v33, v29, 5, v33
v_add_u32 v33, 151808, v33
v_and_b32 v34, 63, v0
v_cmp_gt_u32 vcc, 8, v34
s_and_saveexec_b64 s[30:31], vcc
ds_write_b128 v33, v[92:95]
ds_write_b128 v33, v[96:99] offset:16
s_mov_b64 exec, s[30:31]
s_waitcnt lgkmcnt(0)
s_barrier
s_cmp_lg_u32 s82, 0
s_cbranch_scc1 role_a_donec
v_lshlrev_b32 v33, 2, v0
v_add_u32 v34, 151808, v33
ds_read_b32 v92, v34 offset:0
ds_read_b32 v93, v34 offset:256
ds_read_b32 v94, v34 offset:512
ds_read_b32 v95, v34 offset:768
s_add_u32 s20, s50, 16384
s_addc_u32 s21, s51, 0
s_mov_b32 s22, 46080
s_mov_b32 s23, 0x20000
s_mul_hi_u32 s29, s2, 0xccccccd
s_mul_i32 s28, s29, 20
s_sub_u32 s28, s2, s28
s_sub_u32 s36, s2, 60
s_mul_hi_u32 s37, s36, 0x6666667
s_mul_i32 s38, s37, 40
s_sub_u32 s38, s36, s38
s_add_u32 s38, s38, 20
s_cmp_ge_u32 s2, 60
s_cselect_b32 s28, s38, s28
s_cselect_b32 s29, s37, s29
s_mul_i32 s30, s29, 15360
s_lshl_b32 s31, s28, 8
s_add_u32 s30, s30, s31
s_waitcnt lgkmcnt(0)
v_add_f32 v92, v92, v93
v_add_f32 v94, v94, v95
v_add_f32 v92, v92, v94
buffer_store_dword v92, v33, s[20:23], s30 offen sc1
s_cmp_ge_u32 s28, 20
s_cbranch_scc1 role_a_donec
s_waitcnt vmcnt(0)
v_mov_b32 v33, 0
v_mov_b32 v34, 1
s_mov_b64 exec, 1
global_atomic_add v35, v33, v34, s[88:89] sc0 sc1
s_waitcnt vmcnt(0)
v_cmp_eq_u32 vcc, 59, v35
s_and_saveexec_b64 s[30:31], vcc
s_cbranch_execz role_a_notlastc
global_store_dword v33, v34, s[88:89] offset:128 sc1
role_a_notlastc:
s_mov_b64 exec, -1
role_a_donec:
s_mov_b32 s24, s44
s_mov_b32 s25, s45
s_mov_b32 s26, 7864320
s_mov_b32 s27, 0x20000
s_and_b32 s94, s2, 7
s_lshl_b32 s94, s94, 2
s_bfe_u32 s95, s2, 0x20003
s_add_u32 s94, s94, s95
s_mul_i32 s94, s94, 384
s_lshr_b32 s95, s2, 5
s_mul_i32 s95, s95, 393216
s_add_u32 s94, s94, s95
s_mul_i32 s95, s82, 3072
s_add_u32 m0, s95, 73728
s_nop 0
buffer_load_dwordx4 v192, s[24:27], s94 offen lds
buffer_load_dwordx4 v193, s[24:27], s94 offen offset:1024 lds
buffer_load_dwordx4 v194, s[24:27], s94 offen offset:2048 lds
s_waitcnt vmcnt(3)
  s_branch role_x_ok
role_x_late:
  s_cmp_ge_u32 s2, 180
  s_cbranch_scc1 role_x_r
s_waitcnt vmcnt(17)
  s_branch role_x_ok
role_x_r:
  s_cmp_ge_u32 s2, 240
  s_cbranch_scc1 role_x_n
s_waitcnt vmcnt(11)
  s_branch role_x_ok
role_x_n:
s_waitcnt vmcnt(3)
role_x_ok:
  v_lshlrev_b32 v156, 16, v16
  v_and_b32 v157, 0xffff0000, v16
  v_lshlrev_b32 v158, 16, v17
  v_and_b32 v159, 0xffff0000, v17
  v_lshlrev_b32 v160, 16, v18
  v_and_b32 v161, 0xffff0000, v18
  v_lshlrev_b32 v162, 16, v19
  v_and_b32 v163, 0xffff0000, v19
  v_lshlrev_b32 v164, 16, v20
  v_and_b32 v165, 0xffff0000, v20
  v_lshlrev_b32 v166, 16, v21
  v_and_b32 v167, 0xffff0000, v21
  v_lshlrev_b32 v168, 16, v22
  v_and_b32 v169, 0xffff0000, v22
  v_lshlrev_b32 v170, 16, v23
  v_and_b32 v171, 0xffff0000, v23
  v_lshlrev_b32 v172, 16, v24
  v_and_b32 v173, 0xffff0000, v24
  v_lshlrev_b32 v174, 16, v25
  v_and_b32 v175, 0xffff0000, v25
  v_lshlrev_b32 v176, 16, v26
  v_and_b32 v177, 0xffff0000, v26
  v_lshlrev_b32 v178, 16, v27
  v_and_b32 v179, 0xffff0000, v27
  v_pk_add_f32 v[180:181], v[156:157], v[160:161]
  v_pk_add_f32 v[182:183], v[158:159], v[162:163]
  v_pk_add_f32 v[180:181], v[164:165], v[180:181]
  v_pk_add_f32 v[182:183], v[166:167], v[182:183]
  v_pk_add_f32 v[180:181], v[168:169], v[180:181]
  v_pk_add_f32 v[182:183], v[170:171], v[182:183]
  s_mov_b32 exec_hi, 0
  v_pk_add_f32 v[180:181], v[172:173], v[180:181]
  v_pk_add_f32 v[182:183], v[174:175], v[182:183]
  v_pk_add_f32 v[180:181], v[176:177], v[180:181]
  v_pk_add_f32 v[182:183], v[178:179], v[182:183]
  s_mov_b32 exec_hi, -1
  v_pk_add_f32 v[180:181], v[180:181], v[182:183]
  v_add_f32 v180, v180, v181
  v_mov_b32 v181, v180
  s_nop 1
  v_add_f32_dpp v180, v181, v180 row_ror:8 row_mask:0xf bank_mask:0xf
  v_mov_b32 v181, v180
  s_nop 1
  v_permlane16_swap_b32 v181, v180
  v_add_f32 v180, v181, v180
  v_mov_b32 v181, v180
  s_nop 1
  v_permlane32_swap_b32 v181, v180
  v_add_f32 v180, v181, v180
  ds_write_b32 v6, v180 offset:0
  s_waitcnt lgkmcnt(0)
  s_barrier
  ds_read_b128 v[184:187], v7 offset:0
  s_waitcnt lgkmcnt(0)
  v_add_f32 v184, v184, v185
  v_add_f32 v186, v186, v187
  v_add_f32 v180, v184, v186
  v_mul_f32 v180, 0xbacccccd, v180
  v_pk_add_f32 v[156:157], v[156:157], v[180:181] op_sel_hi:[1,0]
  v_pk_add_f32 v[158:159], v[158:159], v[180:181] op_sel_hi:[1,0]
  v_pk_add_f32 v[160:161], v[160:161], v[180:181] op_sel_hi:[1,0]
  v_pk_add_f32 v[162:163], v[162:163], v[180:181] op_sel_hi:[1,0]
  v_pk_add_f32 v[164:165], v[164:165], v[180:181] op_sel_hi:[1,0]
  v_pk_add_f32 v[166:167], v[166:167], v[180:181] op_sel_hi:[1,0]
  v_pk_add_f32 v[168:169], v[168:169], v[180:181] op_sel_hi:[1,0]
  v_pk_add_f32 v[170:171], v[170:171], v[180:181] op_sel_hi:[1,0]
  v_pk_add_f32 v[172:173], v[172:173], v[180:181] op_sel_hi:[1,0]
  v_pk_add_f32 v[174:175], v[174:175], v[180:181] op_sel_hi:[1,0]
  v_pk_add_f32 v[176:177], v[176:177], v[180:181] op_sel_hi:[1,0]
  v_pk_add_f32 v[178:179], v[178:179], v[180:181] op_sel_hi:[1,0]
  v_pk_mul_f32 v[180:181], v[156:157], v[156:157]
  v_pk_mul_f32 v[182:183], v[158:159], v[158:159]
  v_pk_fma_f32 v[180:181], v[160:161], v[160:161], v[180:181]
  v_pk_fma_f32 v[182:183], v[162:163], v[162:163], v[182:183]
  v_pk_fma_f32 v[180:181], v[164:165], v[164:165], v[180:181]
  v_pk_fma_f32 v[182:183], v[166:167], v[166:167], v[182:183]
  v_pk_fma_f32 v[180:181], v[168:169], v[168:169], v[180:181]
  v_pk_fma_f32 v[182:183], v[170:171], v[170:171], v[182:183]
  s_mov_b32 exec_hi, 0
  v_pk_fma_f32 v[180:181], v[172:173], v[172:173], v[180:181]
  v_pk_fma_f32 v[182:183], v[174:175], v[174:175], v[182:183]
  v_pk_fma_f32 v[180:181], v[176:177], v[176:177], v[180:181]
  v_pk_fma_f32 v[182:183], v[178:179], v[178:179], v[182:183]
  s_mov_b32 exec_hi, -1
  v_pk_add_f32 v[180:181], v[180:181], v[182:183]
  v_add_f32 v180, v180, v181
  v_mov_b32 v181, v180
  s_nop 1
  v_add_f32_dpp v180, v181, v180 row_ror:8 row_mask:0xf bank_mask:0xf
  v_mov_b32 v181, v180
  s_nop 1
  v_permlane16_swap_b32 v181, v180
  v_add_f32 v180, v181, v180
  v_mov_b32 v181, v180
  s_nop 1
  v_permlane32_swap_b32 v181, v180
  v_add_f32 v180, v181, v180
  ds_write_b32 v6, v180 offset:128
  s_waitcnt lgkmcnt(0)
  s_barrier
  ds_read_b128 v[184:187], v7 offset:128
  s_waitcnt lgkmcnt(0)
  v_add_f32 v184, v184, v185
  v_add_f32 v186, v186, v187
  v_add_f32 v180, v184, v186
  v_mov_b32 v181, 0x3727c5ac
  v_fmac_f32 v181, 0x3acccccd, v180
  v_rsq_f32 v180, v181
  s_nop 0
  v_pk_mul_f32 v[156:157], v[156:157], v[180:181] op_sel_hi:[1,0]
  v_pk_mul_f32 v[158:159], v[158:159], v[180:181] op_sel_hi:[1,0]
  v_pk_mul_f32 v[160:161], v[160:161], v[180:181] op_sel_hi:[1,0]
  v_pk_mul_f32 v[162:163], v[162:163], v[180:181] op_sel_hi:[1,0]
  v_pk_mul_f32 v[164:165], v[164:165], v[180:181] op_sel_hi:[1,0]
  v_pk_mul_f32 v[166:167], v[166:167], v[180:181] op_sel_hi:[1,0]
  v_pk_mul_f32 v[168:169], v[168:169], v[180:181] op_sel_hi:[1,0]
  v_pk_mul_f32 v[170:171], v[170:171], v[180:181] op_sel_hi:[1,0]
  v_pk_mul_f32 v[172:173], v[172:173], v[180:181] op_sel_hi:[1,0]
  v_pk_mul_f32 v[174:175], v[174:175], v[180:181] op_sel_hi:[1,0]
  v_pk_mul_f32 v[176:177], v[176:177], v[180:181] op_sel_hi:[1,0]
  v_pk_mul_f32 v[178:179], v[178:179], v[180:181] op_sel_hi:[1,0]
  s_cmp_lt_u32 s2, 60
  s_cbranch_scc1 role_done
  s_cmp_ge_u32 s2, 180
  s_cbranch_scc1 role_not_a2
v_mov_b64 v[92:93], 0
v_mov_b64 v[94:95], 0
v_mov_b64 v[96:97], 0
v_mov_b64 v[98:99], 0
s_mov_b32 s30, 0xbfb8aa3b
s_waitcnt vmcnt(10)
v_lshlrev_b32 v38, 16, v38
v_lshlrev_b32 v39, 16, v39
v_lshlrev_b32 v40, 16, v40
v_lshlrev_b32 v41, 16, v41
v_lshlrev_b32 v42, 16, v42
v_lshlrev_b32 v43, 16, v43
v_lshlrev_b32 v44, 16, v44
v_mul_f32 v108, s30, v38
v_mul_f32 v109, s30, v39
v_mul_f32 v110, s30, v40
v_mul_f32 v111, s30, v41
v_mul_f32 v112, s30, v42
v_mul_f32 v113, s30, v43
v_mul_f32 v114, s30, v44
v_exp_f32 v108, v108
v_exp_f32 v109, v109
v_exp_f32 v110, v110
v_exp_f32 v111, v111
v_exp_f32 v112, v112
v_exp_f32 v113, v113
v_exp_f32 v114, v114
v_add_f32 v108, 1.0, v108
v_add_f32 v109, 1.0, v109
v_add_f32 v110, 1.0, v110
v_add_f32 v111, 1.0, v111
v_add_f32 v112, 1.0, v112
v_add_f32 v113, 1.0, v113
v_add_f32 v114, 1.0, v114
v_rcp_f32 v108, v108
v_rcp_f32 v109, v109
v_rcp_f32 v110, v110
v_rcp_f32 v111, v111
v_rcp_f32 v112, v112
v_rcp_f32 v113, v113
v_rcp_f32 v114, v114
v_mul_f32 v38, v38, v108
v_mul_f32 v39, v39, v109
v_mul_f32 v40, v40, v110
v_mul_f32 v41, v41, v111
v_mul_f32 v42, v42, v112
v_mul_f32 v43, v43, v113
v_mul_f32 v44, v44, v114
v_cvt_pk_bf16_f32 v38, v38, v38
v_and_b32 v38, 0xffff0000, v38
v_cvt_pk_bf16_f32 v39, v39, v39
v_and_b32 v39, 0xffff0000, v39
v_cvt_pk_bf16_f32 v40, v40, v40
v_and_b32 v40, 0xffff0000, v40
v_cvt_pk_bf16_f32 v41, v41, v41
v_and_b32 v41, 0xffff0000, v41
v_cvt_pk_bf16_f32 v42, v42, v42
v_and_b32 v42, 0xffff0000, v42
v_cvt_pk_bf16_f32 v43, v43, v43
v_and_b32 v43, 0xffff0000, v43
v_cvt_pk_bf16_f32 v44, v44, v44
v_and_b32 v44, 0xffff0000, v44
s_waitcnt vmcnt(3)
v_lshlrev_b32 v116, 16, v52
v_and_b32 v117, 0xffff0000, v52
v_pk_fma_f32 v[92:93], v[116:117], v[38:39], v[92:93] op_sel:[0,0,0] op_sel_hi:[1,0,1]
v_lshlrev_b32 v118, 16, v53
v_and_b32 v119, 0xffff0000, v53
v_pk_fma_f32 v[94:95], v[118:119], v[38:39], v[94:95] op_sel:[0,0,0] op_sel_hi:[1,0,1]
v_lshlrev_b32 v116, 16, v54
v_and_b32 v117, 0xffff0000, v54
v_pk_fma_f32 v[96:97], v[116:117], v[38:39], v[96:97] op_sel:[0,0,0] op_sel_hi:[1,0,1]
v_lshlrev_b32 v118, 16, v55
v_and_b32 v119, 0xffff0000, v55
v_pk_fma_f32 v[98:99], v[118:119], v[38:39], v[98:99] op_sel:[0,0,0] op_sel_hi:[1,0,1]
v_lshlrev_b32 v116, 16, v56
v_and_b32 v117, 0xffff0000, v56
v_pk_fma_f32 v[92:93], v[116:117], v[38:39], v[92:93] op_sel:[0,1,0] op_sel_hi:[1,1,1]
v_lshlrev_b32 v118, 16, v57
v_and_b32 v119, 0xffff0000, v57
v_pk_fma_f32 v[94:95], v[118:119], v[38:39], v[94:95] op_sel:[0,1,0] op_sel_hi:[1,1,1]
v_lshlrev_b32 v116, 16, v58
v_and_b32 v117, 0xffff0000, v58
v_pk_fma_f32 v[96:97], v[116:117], v[38:39], v[96:97] op_sel:[0,1,0] op_sel_hi:[1,1,1]
v_lshlrev_b32 v118, 16, v59
v_and_b32 v119, 0xffff0000, v59
v_pk_fma_f32 v[98:99], v[118:119], v[38:39], v[98:99] op_sel:[0,1,0] op_sel_hi:[1,1,1]
v_lshlrev_b32 v116, 16, v60
v_and_b32 v117, 0xffff0000, v60
v_pk_fma_f32 v[92:93], v[116:117], v[40:41], v[92:93] op_sel:[0,0,0] op_sel_hi:[1,0,1]
v_lshlrev_b32 v118, 16, v61
v_and_b32 v119, 0xffff0000, v61
v_pk_fma_f32 v[94:95], v[118:119], v[40:41], v[94:95] op_sel:[0,0,0] op_sel_hi:[1,0,1]
v_lshlrev_b32 v116, 16, v62
v_and_b32 v117, 0xffff0000, v62
v_pk_fma_f32 v[96:97], v[116:117], v[40:41], v[96:97] op_sel:[0,0,0] op_sel_hi:[1,0,1]
v_lshlrev_b32 v118, 16, v63
v_and_b32 v119, 0xffff0000, v63
v_pk_fma_f32 v[98:99], v[118:119], v[40:41], v[98:99] op_sel:[0,0,0] op_sel_hi:[1,0,1]
v_lshlrev_b32 v116, 16, v64
v_and_b32 v117, 0xffff0000, v64
v_pk_fma_f32 v[92:93], v[116:117], v[40:41], v[92:93] op_sel:[0,1,0] op_sel_hi:[1,1,1]
v_lshlrev_b32 v118, 16, v65
v_and_b32 v119, 0xffff0000, v65
v_pk_fma_f32 v[94:95], v[118:119], v[40:41], v[94:95] op_sel:[0,1,0] op_sel_hi:[1,1,1]
v_lshlrev_b32 v116, 16, v66
v_and_b32 v117, 0xffff0000, v66
v_pk_fma_f32 v[96:97], v[116:117], v[40:41], v[96:97] op_sel:[0,1,0] op_sel_hi:[1,1,1]
v_lshlrev_b32 v118, 16, v67
v_and_b32 v119, 0xffff0000, v67
v_pk_fma_f32 v[98:99], v[118:119], v[40:41], v[98:99] op_sel:[0,1,0] op_sel_hi:[1,1,1]
v_lshlrev_b32 v116, 16, v68
v_and_b32 v117, 0xffff0000, v68
v_pk_fma_f32 v[92:93], v[116:117], v[42:43], v[92:93] op_sel:[0,0,0] op_sel_hi:[1,0,1]
v_lshlrev_b32 v118, 16, v69
v_and_b32 v119, 0xffff0000, v69
v_pk_fma_f32 v[94:95], v[118:119], v[42:43], v[94:95] op_sel:[0,0,0] op_sel_hi:[1,0,1]
v_lshlrev_b32 v116, 16, v70
v_and_b32 v117, 0xffff0000, v70
v_pk_fma_f32 v[96:97], v[116:117], v[42:43], v[96:97] op_sel:[0,0,0] op_sel_hi:[1,0,1]
v_lshlrev_b32 v118, 16, v71
v_and_b32 v119, 0xffff0000, v71
v_pk_fma_f32 v[98:99], v[118:119], v[42:43], v[98:99] op_sel:[0,0,0] op_sel_hi:[1,0,1]
v_lshlrev_b32 v116, 16, v72
v_and_b32 v117, 0xffff0000, v72
v_pk_fma_f32 v[92:93], v[116:117], v[42:43], v[92:93] op_sel:[0,1,0] op_sel_hi:[1,1,1]
v_lshlrev_b32 v118, 16, v73
v_and_b32 v119, 0xffff0000, v73
v_pk_fma_f32 v[94:95], v[118:119], v[42:43], v[94:95] op_sel:[0,1,0] op_sel_hi:[1,1,1]
v_lshlrev_b32 v116, 16, v74
v_and_b32 v117, 0xffff0000, v74
v_pk_fma_f32 v[96:97], v[116:117], v[42:43], v[96:97] op_sel:[0,1,0] op_sel_hi:[1,1,1]
v_lshlrev_b32 v118, 16, v75
v_and_b32 v119, 0xffff0000, v75
v_pk_fma_f32 v[98:99], v[118:119], v[42:43], v[98:99] op_sel:[0,1,0] op_sel_hi:[1,1,1]
v_lshlrev_b32 v116, 16, v76
v_and_b32 v117, 0xffff0000, v76
v_pk_fma_f32 v[92:93], v[116:117], v[44:45], v[92:93] op_sel:[0,0,0] op_sel_hi:[1,0,1]
v_lshlrev_b32 v118, 16, v77
v_and_b32 v119, 0xffff0000, v77
v_pk_fma_f32 v[94:95], v[118:119], v[44:45], v[94:95] op_sel:[0,0,0] op_sel_hi:[1,0,1]
v_lshlrev_b32 v116, 16, v78
v_and_b32 v117, 0xffff0000, v78
v_pk_fma_f32 v[96:97], v[116:117], v[44:45], v[96:97] op_sel:[0,0,0] op_sel_hi:[1,0,1]
v_lshlrev_b32 v118, 16, v79
v_and_b32 v119, 0xffff0000, v79
v_pk_fma_f32 v[98:99], v[118:119], v[44:45], v[98:99] op_sel:[0,0,0] op_sel_hi:[1,0,1]
v_mov_b32 v100, v92
v_mov_b32 v101, v93
v_mov_b32 v102, v94
v_mov_b32 v103, v95
v_mov_b32 v104, v96
v_mov_b32 v105, v97
v_mov_b32 v106, v98
v_mov_b32 v107, v99
s_nop 1
v_add_f32_dpp v92, v100, v92 row_ror:8 row_mask:0xf bank_mask:0xf
v_add_f32_dpp v93, v101, v93 row_ror:8 row_mask:0xf bank_mask:0xf
v_add_f32_dpp v94, v102, v94 row_ror:8 row_mask:0xf bank_mask:0xf
v_add_f32_dpp v95, v103, v95 row_ror:8 row_mask:0xf bank_mask:0xf
v_add_f32_dpp v96, v104, v96 row_ror:8 row_mask:0xf bank_mask:0xf
v_add_f32_dpp v97, v105, v97 row_ror:8 row_mask:0xf bank_mask:0xf
v_add_f32_dpp v98, v106, v98 row_ror:8 row_mask:0xf bank_mask:0xf
v_add_f32_dpp v99, v107, v99 row_ror:8 row_mask:0xf bank_mask:0xf
v_mov_b32 v100, v92
v_mov_b32 v101, v93
v_mov_b32 v102, v94
v_mov_b32 v103, v95
v_mov_b32 v104, v96
v_mov_b32 v105, v97
v_mov_b32 v106, v98
v_mov_b32 v107, v99
s_nop 1
v_permlane16_swap_b32 v100, v92
v_permlane16_swap_b32 v101, v93
v_permlane16_swap_b32 v102, v94
v_permlane16_swap_b32 v103, v95
v_permlane16_swap_b32 v104, v96
v_permlane16_swap_b32 v105, v97
v_permlane16_swap_b32 v106, v98
v_permlane16_swap_b32 v107, v99
v_add_f32 v92, v100, v92
v_add_f32 v93, v101, v93
v_add_f32 v94, v102, v94
v_add_f32 v95, v103, v95
v_add_f32 v96, v104, v96
v_add_f32 v97, v105, v97
v_add_f32 v98, v106, v98
v_add_f32 v99, v107, v99
v_mov_b32 v100, v92
v_mov_b32 v101, v93
v_mov_b32 v102, v94
v_mov_b32 v103, v95
v_mov_b32 v104, v96
v_mov_b32 v105, v97
v_mov_b32 v106, v98
v_mov_b32 v107, v99
s_nop 1
v_permlane32_swap_b32 v100, v92
v_permlane32_swap_b32 v101, v93
v_permlane32_swap_b32 v102, v94
v_permlane32_swap_b32 v103, v95
v_permlane32_swap_b32 v104, v96
v_permlane32_swap_b32 v105, v97
v_permlane32_swap_b32 v106, v98
v_permlane32_swap_b32 v107, v99
v_add_f32 v92, v100, v92
v_add_f32 v93, v101, v93
v_add_f32 v94, v102, v94
v_add_f32 v95, v103, v95
v_add_f32 v96, v104, v96
v_add_f32 v97, v105, v97
v_add_f32 v98, v106, v98
v_add_f32 v99, v107, v99
v_lshrrev_b32 v33, 6, v0
v_lshlrev_b32 v33, 8, v33
v_lshl_add_u32 v33, v29, 5, v33
v_add_u32 v33, 151808, v33
v_and_b32 v34, 63, v0
v_cmp_gt_u32 vcc, 8, v34
s_and_saveexec_b64 s[30:31], vcc
ds_write_b128 v33, v[92:95]
ds_write_b128 v33, v[96:99] offset:16
s_mov_b64 exec, s[30:31]
s_waitcnt lgkmcnt(0)
s_barrier
s_cmp_lg_u32 s82, 0
s_cbranch_scc1 role_a_donen
v_lshlrev_b32 v33, 2, v0
v_add_u32 v34, 151808, v33
ds_read_b32 v92, v34 offset:0
ds_read_b32 v93, v34 offset:256
ds_read_b32 v94, v34 offset:512
ds_read_b32 v95, v34 offset:768
s_add_u32 s20, s50, 16384
s_addc_u32 s21, s51, 0
s_mov_b32 s22, 46080
s_mov_b32 s23, 0x20000
s_mul_hi_u32 s29, s2, 0xccccccd
s_mul_i32 s28, s29, 20
s_sub_u32 s28, s2, s28
s_sub_u32 s36, s2, 60
s_mul_hi_u32 s37, s36, 0x6666667
s_mul_i32 s38, s37, 40
s_sub_u32 s38, s36, s38
s_add_u32 s38, s38, 20
s_cmp_ge_u32 s2, 60
s_cselect_b32 s28, s38, s28
s_cselect_b32 s29, s37, s29
s_mul_i32 s30, s29, 15360
s_lshl_b32 s31, s28, 8
s_add_u32 s30, s30, s31
s_waitcnt lgkmcnt(0)
v_add_f32 v92, v92, v93
v_add_f32 v94, v94, v95
v_add_f32 v92, v92, v94
buffer_store_dword v92, v33, s[20:23], s30 offen sc1
s_cmp_ge_u32 s28, 20
s_cbranch_scc1 role_a_donen
s_waitcnt vmcnt(0)
v_mov_b32 v33, 0
v_mov_b32 v34, 1
s_mov_b64 exec, 1
global_atomic_add v35, v33, v34, s[88:89] sc0 sc1
s_waitcnt vmcnt(0)
v_cmp_eq_u32 vcc, 59, v35
s_and_saveexec_b64 s[30:31], vcc
s_cbranch_execz role_a_notlastn
global_store_dword v33, v34, s[88:89] offset:128 sc1
role_a_notlastn:
s_mov_b64 exec, -1
role_a_donen:
  s_branch role_done
role_not_a2:
  s_cmp_ge_u32 s2, 240
  s_cbranch_scc1 role_done
v_and_b32 v35, 15, v30
v_lshrrev_b32 v36, 4, v30
v_lshrrev_b32 v37, 2, v35
v_lshl_add_u32 v37, v36, 2, v37
v_lshlrev_b32 v37, 7, v37
v_bfe_u32 v38, v35, 1, 1
v_lshl_add_u32 v37, v38, 4, v37
v_and_b32 v38, 1, v35
v_lshl_add_u32 v37, v38, 3, v37
s_mul_i32 s29, s82, 8192
s_add_u32 s29, s29, 98304
v_add_u32 v37, s29, v37
v_and_b32 v38, 1, v36
v_lshlrev_b32 v38, 1, v38
v_lshrrev_b32 v39, 3, v35
v_or_b32 v38, v38, v39
v_xor_b32 v39, 0, v38
v_lshl_add_u32 v40, v39, 5, v37
v_xor_b32 v39, 1, v38
v_lshl_add_u32 v41, v39, 5, v37
v_xor_b32 v39, 2, v38
v_lshl_add_u32 v42, v39, 5, v37
v_xor_b32 v39, 3, v38
v_lshl_add_u32 v43, v39, 5, v37
v_lshlrev_b32 v44, 4, v30
s_add_u32 s16, s50, 71303168
s_addc_u32 s17, s51, 0
s_mov_b32 s18, 1966080
s_mov_b32 s19, 0x20000
s_waitcnt vmcnt(7)
ds_read_b64_tr_b16 v[48:49], v40 offset:0
ds_read_b64_tr_b16 v[50:51], v40 offset:2048
ds_read_b64_tr_b16 v[52:53], v41 offset:0
ds_read_b64_tr_b16 v[54:55], v41 offset:2048
ds_read_b64_tr_b16 v[56:57], v42 offset:0
ds_read_b64_tr_b16 v[58:59], v42 offset:2048
ds_read_b64_tr_b16 v[60:61], v43 offset:0
ds_read_b64_tr_b16 v[62:63], v43 offset:2048
s_waitcnt vmcnt(3)
ds_read_b64_tr_b16 v[64:65], v40 offset:4096
ds_read_b64_tr_b16 v[66:67], v40 offset:6144
ds_read_b64_tr_b16 v[68:69], v41 offset:4096
ds_read_b64_tr_b16 v[70:71], v41 offset:6144
ds_read_b64_tr_b16 v[72:73], v42 offset:4096
ds_read_b64_tr_b16 v[74:75], v42 offset:6144
ds_read_b64_tr_b16 v[76:77], v43 offset:4096
ds_read_b64_tr_b16 v[78:79], v43 offset:6144
s_waitcnt lgkmcnt(0)
s_sub_u32 s30, s2, 180
s_lshl_b32 s30, s30, 3
s_lshl_b32 s31, s82, 1
s_add_u32 s30, s30, s31
s_mul_hi_u32 s33, s30, 0x1999999a
s_mul_i32 s34, s33, 10
s_sub_u32 s34, s30, s34
s_lshl_b32 s38, s34, 2
s_add_u32 s38, s38, 0
s_mul_hi_u32 s39, s38, 0x33333334
s_mul_i32 s40, s39, 5
s_sub_u32 s40, s38, s40
s_mul_i32 s39, s39, 48
s_add_u32 s39, s39, s33
s_mul_i32 s39, s39, 5
s_add_u32 s39, s39, s40
s_lshl_b32 s39, s39, 10
buffer_store_dwordx4 v[48:51], v44, s[16:19], s39 offen sc1
s_lshl_b32 s38, s34, 2
s_add_u32 s38, s38, 1
s_mul_hi_u32 s39, s38, 0x33333334
s_mul_i32 s40, s39, 5
s_sub_u32 s40, s38, s40
s_mul_i32 s39, s39, 48
s_add_u32 s39, s39, s33
s_mul_i32 s39, s39, 5
s_add_u32 s39, s39, s40
s_lshl_b32 s39, s39, 10
buffer_store_dwordx4 v[52:55], v44, s[16:19], s39 offen sc1
s_lshl_b32 s38, s34, 2
s_add_u32 s38, s38, 2
s_mul_hi_u32 s39, s38, 0x33333334
s_mul_i32 s40, s39, 5
s_sub_u32 s40, s38, s40
s_mul_i32 s39, s39, 48
s_add_u32 s39, s39, s33
s_mul_i32 s39, s39, 5
s_add_u32 s39, s39, s40
s_lshl_b32 s39, s39, 10
buffer_store_dwordx4 v[56:59], v44, s[16:19], s39 offen sc1
s_lshl_b32 s38, s34, 2
s_add_u32 s38, s38, 3
s_mul_hi_u32 s39, s38, 0x33333334
s_mul_i32 s40, s39, 5
s_sub_u32 s40, s38, s40
s_mul_i32 s39, s39, 48
s_add_u32 s39, s39, s33
s_mul_i32 s39, s39, 5
s_add_u32 s39, s39, s40
s_lshl_b32 s39, s39, 10
buffer_store_dwordx4 v[60:63], v44, s[16:19], s39 offen sc1
s_sub_u32 s30, s2, 180
s_lshl_b32 s30, s30, 3
s_lshl_b32 s31, s82, 1
s_add_u32 s30, s30, s31
s_add_u32 s30, s30, 1
s_mul_hi_u32 s33, s30, 0x1999999a
s_mul_i32 s34, s33, 10
s_sub_u32 s34, s30, s34
s_lshl_b32 s38, s34, 2
s_add_u32 s38, s38, 0
s_mul_hi_u32 s39, s38, 0x33333334
s_mul_i32 s40, s39, 5
s_sub_u32 s40, s38, s40
s_mul_i32 s39, s39, 48
s_add_u32 s39, s39, s33
s_mul_i32 s39, s39, 5
s_add_u32 s39, s39, s40
s_lshl_b32 s39, s39, 10
buffer_store_dwordx4 v[64:67], v44, s[16:19], s39 offen sc1
s_lshl_b32 s38, s34, 2
s_add_u32 s38, s38, 1
s_mul_hi_u32 s39, s38, 0x33333334
s_mul_i32 s40, s39, 5
s_sub_u32 s40, s38, s40
s_mul_i32 s39, s39, 48
s_add_u32 s39, s39, s33
s_mul_i32 s39, s39, 5
s_add_u32 s39, s39, s40
s_lshl_b32 s39, s39, 10
buffer_store_dwordx4 v[68:71], v44, s[16:19], s39 offen sc1
s_lshl_b32 s38, s34, 2
s_add_u32 s38, s38, 2
s_mul_hi_u32 s39, s38, 0x33333334
s_mul_i32 s40, s39, 5
s_sub_u32 s40, s38, s40
s_mul_i32 s39, s39, 48
s_add_u32 s39, s39, s33
s_mul_i32 s39, s39, 5
s_add_u32 s39, s39, s40
s_lshl_b32 s39, s39, 10
buffer_store_dwordx4 v[72:75], v44, s[16:19], s39 offen sc1
s_lshl_b32 s38, s34, 2
s_add_u32 s38, s38, 3
s_mul_hi_u32 s39, s38, 0x33333334
s_mul_i32 s40, s39, 5
s_sub_u32 s40, s38, s40
s_mul_i32 s39, s39, 48
s_add_u32 s39, s39, s33
s_mul_i32 s39, s39, 5
s_add_u32 s39, s39, s40
s_lshl_b32 s39, s39, 10
buffer_store_dwordx4 v[76:79], v44, s[16:19], s39 offen sc1
role_done:
  s_cmp_lt_u32 s2, 64
  s_cbranch_scc1 pfr_nopf
s_mov_b32 s24, s44
s_mov_b32 s25, s45
s_mov_b32 s26, 7864320
s_mov_b32 s27, 0x20000
s_mul_i32 s43, s82, 3072
s_add_u32 m0, s43, 73728
s_lshr_b32 s95, s2, 3
s_sub_u32 s95, s95, 8
s_lshl_b32 s95, s95, 1
s_mul_hi_u32 s42, s95, 0x15555556
s_mul_i32 s43, s42, 12
s_sub_u32 s43, s95, s43
s_add_u32 s43, s43, 8
s_mul_i32 s43, s43, 393216
s_and_b32 s94, s2, 7
s_lshl_b32 s94, s94, 2
s_add_u32 s94, s94, s42
s_mul_i32 s94, s94, 384
s_add_u32 s94, s94, s43
buffer_load_dwordx4 v192, s[24:27], s94 offen lds
buffer_load_dwordx4 v193, s[24:27], s94 offen offset:1024 lds
buffer_load_dwordx4 v194, s[24:27], s94 offen offset:2048 lds
s_lshr_b32 s95, s2, 3
s_sub_u32 s95, s95, 8
s_lshl_b32 s95, s95, 1
s_add_u32 s95, s95, 1
s_mul_hi_u32 s42, s95, 0x15555556
s_mul_i32 s43, s42, 12
s_sub_u32 s43, s95, s43
s_add_u32 s43, s43, 8
s_mul_i32 s43, s43, 393216
s_and_b32 s94, s2, 7
s_lshl_b32 s94, s94, 2
s_add_u32 s94, s94, s42
s_mul_i32 s94, s94, 384
s_add_u32 s94, s94, s43
buffer_load_dwordx4 v192, s[24:27], s94 offen lds
buffer_load_dwordx4 v193, s[24:27], s94 offen offset:1024 lds
buffer_load_dwordx4 v194, s[24:27], s94 offen offset:2048 lds
pfr_nopf:
  s_and_b32 s40, s2, 7
  s_lshl_b32 s40, s40, 2
  s_bfe_u32 s41, s2, 0x20003
  s_add_u32 s37, s40, s41
  s_lshr_b32 s38, s2, 5
  s_mov_b32 s4, s44
  s_mov_b32 s5, s45
  s_mov_b32 s6, 7864320
  s_mov_b32 s7, 0x20000
  s_mov_b32 s8, s44
  s_mov_b32 s9, s45
  s_mov_b32 s10, 7864320
  s_mov_b32 s11, 0x20000
  s_mul_i32 s28, s37, 384
  s_add_u32 s29, s28, 393216
  s_mov_b32 s30, 786432
  s_mul_i32 s31, s82, 3072
  s_mov_b32 s42, -122880
  s_mov_b32 s43, 24576
  s_mov_b32 s32, 0
  s_mov_b32 s34, 0
s_cmp_eq_u32 s82, 0
s_cbranch_scc0 adaLN_cond__sliding_block_cached__glu_gated_swiglu__prompt_kernel_w0_nopoll
s_mov_b32 s83, 128
v_lshlrev_b32 v253, 2, v255
v_add_u32 v253, s83, v253
s_mov_b32 exec_lo, 0x1
s_mov_b32 exec_hi, 0x0
s_mov_b32 s3, 400000
adaLN_cond__sliding_block_cached__glu_gated_swiglu__prompt_kernel_w0_poll:
global_load_dword v254, v253, s[88:89] sc1
s_waitcnt vmcnt(0)
v_cmp_ne_u32 vcc, 1, v254
s_nop 1
s_cmp_eq_u64 vcc, 0
s_cbranch_scc1 adaLN_cond__sliding_block_cached__glu_gated_swiglu__prompt_kernel_w0_ready
s_sleep 1
s_sub_u32 s3, s3, 1
s_cmp_lg_u32 s3, 0
s_cbranch_scc1 adaLN_cond__sliding_block_cached__glu_gated_swiglu__prompt_kernel_w0_poll
s_endpgm
adaLN_cond__sliding_block_cached__glu_gated_swiglu__prompt_kernel_w0_ready:
s_mov_b64 exec, -1
adaLN_cond__sliding_block_cached__glu_gated_swiglu__prompt_kernel_w0_nopoll:
  s_barrier
  s_add_u32 s16, s50, 16384
  s_addc_u32 s17, s51, 0
  s_mov_b32 s18, 46080
  s_mov_b32 s19, 0x20000
  s_lshl_b32 s93, s82, 6
  v_add_u32 v120, s93, v255
  v_cmp_gt_u32 vcc, 160, v120
  s_and_saveexec_b64 s[100:101], vcc
  s_cbranch_execz stg_b_st0
  v_lshlrev_b32 v121, 5, v120
  s_mov_b32 s93, 0
  buffer_load_dwordx4 v[124:127], v121, s[16:19], s93 offen offset:0 sc1
  buffer_load_dwordx4 v[128:131], v121, s[16:19], s93 offen offset:16 sc1
  s_mov_b32 s93, 15360
  buffer_load_dwordx4 v[132:135], v121, s[16:19], s93 offen offset:0 sc1
  buffer_load_dwordx4 v[136:139], v121, s[16:19], s93 offen offset:16 sc1
  s_mov_b32 s93, 30720
  buffer_load_dwordx4 v[140:143], v121, s[16:19], s93 offen offset:0 sc1
  buffer_load_dwordx4 v[144:147], v121, s[16:19], s93 offen offset:16 sc1
  s_waitcnt vmcnt(0)
  v_pk_add_f32 v[124:125], v[124:125], v[132:133]
  v_pk_add_f32 v[126:127], v[126:127], v[134:135]
  v_pk_add_f32 v[128:129], v[128:129], v[136:137]
  v_pk_add_f32 v[130:131], v[130:131], v[138:139]
  v_pk_add_f32 v[124:125], v[124:125], v[140:141]
  v_pk_add_f32 v[126:127], v[126:127], v[142:143]
  v_pk_add_f32 v[128:129], v[128:129], v[144:145]
  v_pk_add_f32 v[130:131], v[130:131], v[146:147]
  v_cvt_pk_bf16_f32 v124, v124, v124
  v_and_b32 v124, 0xffff0000, v124
  v_cvt_pk_bf16_f32 v125, v125, v125
  v_and_b32 v125, 0xffff0000, v125
  v_cvt_pk_bf16_f32 v126, v126, v126
  v_and_b32 v126, 0xffff0000, v126
  v_cvt_pk_bf16_f32 v127, v127, v127
  v_and_b32 v127, 0xffff0000, v127
  v_cvt_pk_bf16_f32 v128, v128, v128
  v_and_b32 v128, 0xffff0000, v128
  v_cvt_pk_bf16_f32 v129, v129, v129
  v_and_b32 v129, 0xffff0000, v129
  v_cvt_pk_bf16_f32 v130, v130, v130
  v_and_b32 v130, 0xffff0000, v130
  v_cvt_pk_bf16_f32 v131, v131, v131
  v_and_b32 v131, 0xffff0000, v131
  v_subrev_u32 v122, 80, v120
  v_cmp_gt_u32 vcc, 80, v122
  v_add_f32 v132, 1.0, v124
  v_add_f32 v133, 1.0, v125
  v_add_f32 v134, 1.0, v126
  v_add_f32 v135, 1.0, v127
  v_add_f32 v136, 1.0, v128
  v_add_f32 v137, 1.0, v129
  v_add_f32 v138, 1.0, v130
  v_add_f32 v139, 1.0, v131
  v_cvt_pk_bf16_f32 v132, v132, v132
  v_and_b32 v132, 0xffff0000, v132
  v_cvt_pk_bf16_f32 v133, v133, v133
  v_and_b32 v133, 0xffff0000, v133
  v_cvt_pk_bf16_f32 v134, v134, v134
  v_and_b32 v134, 0xffff0000, v134
  v_cvt_pk_bf16_f32 v135, v135, v135
  v_and_b32 v135, 0xffff0000, v135
  v_cvt_pk_bf16_f32 v136, v136, v136
  v_and_b32 v136, 0xffff0000, v136
  v_cvt_pk_bf16_f32 v137, v137, v137
  v_and_b32 v137, 0xffff0000, v137
  v_cvt_pk_bf16_f32 v138, v138, v138
  v_and_b32 v138, 0xffff0000, v138
  v_cvt_pk_bf16_f32 v139, v139, v139
  v_and_b32 v139, 0xffff0000, v139
  v_cndmask_b32 v124, v124, v132, vcc
  v_cndmask_b32 v125, v125, v133, vcc
  v_cndmask_b32 v126, v126, v134, vcc
  v_cndmask_b32 v127, v127, v135, vcc
  v_cndmask_b32 v128, v128, v136, vcc
  v_cndmask_b32 v129, v129, v137, vcc
  v_cndmask_b32 v130, v130, v138, vcc
  v_cndmask_b32 v131, v131, v139, vcc
  s_mov_b32 s93, 0x3dd53b95
  v_mul_f32 v124, s93, v124
  v_mul_f32 v125, s93, v125
  v_mul_f32 v126, s93, v126
  v_mul_f32 v127, s93, v127
  v_mul_f32 v128, s93, v128
  v_mul_f32 v129, s93, v129
  v_mul_f32 v130, s93, v130
  v_mul_f32 v131, s93, v131
  v_add_u32 v121, 152832, v121
  ds_write_b128 v121, v[124:127]
  ds_write_b128 v121, v[128:131] offset:16
stg_b_st0:
  s_mov_b64 exec, s[100:101]
  s_waitcnt lgkmcnt(0)
  s_barrier
  s_add_u32 s20, s50, 65536
  s_addc_u32 s21, s51, 0
  s_mov_b32 s22, 2621440
  s_mov_b32 s23, 0x20000
  v_add_u32 v11, 152832, v11
  ds_read_b128 v[56:59], v11 offset:0
  ds_read_b128 v[32:35], v11 offset:2560
  ds_read_b128 v[60:63], v11 offset:16
  ds_read_b128 v[36:39], v11 offset:2576
  ds_read_b128 v[64:67], v11 offset:256
  ds_read_b128 v[40:43], v11 offset:2816
  ds_read_b128 v[68:71], v11 offset:272
  ds_read_b128 v[44:47], v11 offset:2832
  ds_read_b128 v[72:75], v11 offset:512
  ds_read_b128 v[48:51], v11 offset:3072
  ds_read_b128 v[76:79], v11 offset:528
  ds_read_b128 v[52:55], v11 offset:3088
  s_waitcnt lgkmcnt(0)
  v_pk_fma_f32 v[156:157], v[156:157], v[32:33], v[56:57]
  v_pk_fma_f32 v[158:159], v[158:159], v[34:35], v[58:59]
  v_pk_fma_f32 v[160:161], v[160:161], v[36:37], v[60:61]
  v_pk_fma_f32 v[162:163], v[162:163], v[38:39], v[62:63]
  v_pk_fma_f32 v[164:165], v[164:165], v[40:41], v[64:65]
  v_pk_fma_f32 v[166:167], v[166:167], v[42:43], v[66:67]
  v_pk_fma_f32 v[168:169], v[168:169], v[44:45], v[68:69]
  v_pk_fma_f32 v[170:171], v[170:171], v[46:47], v[70:71]
  v_pk_fma_f32 v[172:173], v[172:173], v[48:49], v[72:73]
  v_pk_fma_f32 v[174:175], v[174:175], v[50:51], v[74:75]
  v_pk_fma_f32 v[176:177], v[176:177], v[52:53], v[76:77]
  v_pk_fma_f32 v[178:179], v[178:179], v[54:55], v[78:79]
  v_cvt_pk_bf16_f32 v16, v156, v157
  v_cvt_pk_bf16_f32 v17, v158, v159
  v_cvt_pk_bf16_f32 v18, v160, v161
  v_cvt_pk_bf16_f32 v19, v162, v163
  v_cvt_pk_bf16_f32 v20, v164, v165
  v_cvt_pk_bf16_f32 v21, v166, v167
  v_cvt_pk_bf16_f32 v22, v168, v169
  v_cvt_pk_bf16_f32 v23, v170, v171
  v_cvt_pk_bf16_f32 v24, v172, v173
  v_cvt_pk_bf16_f32 v25, v174, v175
  v_cvt_pk_bf16_f32 v26, v176, v177
  v_cvt_pk_bf16_f32 v27, v178, v179
  buffer_store_dwordx4 v[16:19], v4, s[20:23], s92 offen sc1
  buffer_store_dwordx4 v[20:23], v4, s[20:23], s92 offen offset:2048 sc1
  s_mov_b32 exec_hi, 0
  s_add_u32 s92, s92, 4096
  buffer_store_dwordx4 v[24:27], v4, s[20:23], s92 offen sc1
  s_mov_b32 exec_hi, -1
  s_waitcnt vmcnt(0)
  s_barrier
s_cmp_eq_u32 s82, 0
s_cbranch_scc0 adaLN_cond__sliding_block_cached__glu_gated_swiglu__prompt_kernel_sb_nosig
s_lshr_b32 s83, s2, 5
s_add_u32 s83, s83, 0
s_lshl_b32 s83, s83, 7
s_and_b32 s3, s2, 31
s_lshl_b32 s3, s3, 2
s_add_u32 s83, s83, s3
s_add_u32 s83, s83, 62914560
v_mov_b32 v253, s83
v_mov_b32 v254, 1
s_mov_b64 exec, 1
global_store_dword v253, v254, s[50:51] sc1
s_lshr_b32 s83, s2, 5
s_add_u32 s83, s83, 8
s_lshl_b32 s83, s83, 7
s_add_u32 s83, s83, 62914560
v_mov_b32 v253, s83
global_atomic_add v253, v254, s[50:51] sc1
s_mov_b64 exec, -1
adaLN_cond__sliding_block_cached__glu_gated_swiglu__prompt_kernel_sb_nosig:
  s_mov_b32 s12, s46
  s_mov_b32 s13, s47
  s_mov_b32 s14, 25165824
  s_mov_b32 s15, 0x20000
  s_mov_b32 s16, s48
  s_mov_b32 s17, s49
  s_mov_b32 s18, 25165824
  s_mov_b32 s19, 0x20000
  s_add_u32 s40, s37, 1
  s_mul_i32 s14, s40, 786432
  s_mov_b32 s18, s14
  s_add_u32 s20, s50, 65536
  s_addc_u32 s21, s51, 0
  s_mov_b32 s22, 2621440
  s_mov_b32 s23, 0x20000
  s_add_u32 s24, s50, 3145728
  s_addc_u32 s25, s51, 0
  s_mov_b32 s26, 25165824
  s_mov_b32 s27, 0x20000
  s_lshl_b32 s40, s38, 4
  s_lshl_b32 s41, s82, 2
  s_add_u32 s40, s40, s41
  s_mul_i32 s36, s40, 20480
  s_add_u32 s39, s36, 20480
  s_mov_b32 s88, 2621440
  s_mov_b32 s84, s54
  s_mov_b32 s85, s55
  s_mov_b32 s86, 7864320
  s_mov_b32 s87, 0x20000
  v_lshlrev_b32 v216, 4, v255
  s_and_b32 s40, s2, 7
  s_mul_i32 s89, s40, 983040
  s_lshr_b32 s40, s2, 3
  s_lshl_b32 s40, s40, 2
  s_add_u32 s40, s40, s82
  s_lshl_b32 s40, s40, 13
  s_add_u32 s89, s89, s40
  s_lshl_b32 s40, s2, 2
  s_add_u32 s40, s40, s82
  s_lshl_b32 s90, s40, 11
  s_lshl_b32 s91, s82, 10
  s_add_u32 s91, s91, 147456
  v_mov_b64 v[0:1], 0
  v_mov_b64 v[2:3], 0
  v_mov_b64 v[4:5], 0
  v_mov_b64 v[6:7], 0
  v_mov_b64 v[8:9], 0
  v_mov_b64 v[10:11], 0
  v_mov_b64 v[12:13], 0
  v_mov_b64 v[14:15], 0
  v_mov_b64 v[16:17], 0
  v_mov_b64 v[18:19], 0
  v_mov_b64 v[20:21], 0
  v_mov_b64 v[22:23], 0
  v_mov_b64 v[24:25], 0
  v_mov_b64 v[26:27], 0
  v_mov_b64 v[28:29], 0
  v_mov_b64 v[30:31], 0
  v_mov_b64 v[32:33], 0
  v_mov_b64 v[34:35], 0
  v_mov_b64 v[36:37], 0
  v_mov_b64 v[38:39], 0
  v_mov_b64 v[40:41], 0
  v_mov_b64 v[42:43], 0
  v_mov_b64 v[44:45], 0
  v_mov_b64 v[46:47], 0
  v_mov_b64 v[48:49], 0
  v_mov_b64 v[50:51], 0
  v_mov_b64 v[52:53], 0
  v_mov_b64 v[54:55], 0
  v_mov_b64 v[56:57], 0
  v_mov_b64 v[58:59], 0
  v_mov_b64 v[60:61], 0
  v_mov_b64 v[62:63], 0
  v_mov_b64 v[64:65], 0
  v_mov_b64 v[66:67], 0
  v_mov_b64 v[68:69], 0
  v_mov_b64 v[70:71], 0
  v_mov_b64 v[72:73], 0
  v_mov_b64 v[74:75], 0
  v_mov_b64 v[76:77], 0
  v_mov_b64 v[78:79], 0
  v_mov_b64 v[80:81], 0
  v_mov_b64 v[82:83], 0
  v_mov_b64 v[84:85], 0
  v_mov_b64 v[86:87], 0
  v_mov_b64 v[88:89], 0
  v_mov_b64 v[90:91], 0
  v_mov_b64 v[92:93], 0
  v_mov_b64 v[94:95], 0
  v_mov_b64 v[96:97], 0
  v_mov_b64 v[98:99], 0
  v_mov_b64 v[100:101], 0
  v_mov_b64 v[102:103], 0
  v_mov_b64 v[104:105], 0
  v_mov_b64 v[106:107], 0
  v_mov_b64 v[108:109], 0
  v_mov_b64 v[110:111], 0
  v_mov_b64 v[112:113], 0
  v_mov_b64 v[114:115], 0
  v_mov_b64 v[116:117], 0
  v_mov_b64 v[118:119], 0
  v_mov_b64 v[120:121], 0
  v_mov_b64 v[122:123], 0
  v_mov_b64 v[124:125], 0
  v_mov_b64 v[126:127], 0
  v_mov_b64 v[128:129], 0
  v_mov_b64 v[130:131], 0
  v_mov_b64 v[132:133], 0
  v_mov_b64 v[134:135], 0
  v_mov_b64 v[136:137], 0
  v_mov_b64 v[138:139], 0
  v_mov_b64 v[140:141], 0
  v_mov_b64 v[142:143], 0
  v_mov_b64 v[144:145], 0
  v_mov_b64 v[146:147], 0
  v_mov_b64 v[148:149], 0
  v_mov_b64 v[150:151], 0
  v_mov_b64 v[152:153], 0
  v_mov_b64 v[154:155], 0
  v_mov_b64 v[156:157], 0
  v_mov_b64 v[158:159], 0
  v_mov_b64 v[160:161], 0
  v_mov_b64 v[162:163], 0
  v_mov_b64 v[164:165], 0
  v_mov_b64 v[166:167], 0
  v_mov_b64 v[168:169], 0
  v_mov_b64 v[170:171], 0
  v_mov_b64 v[172:173], 0
  v_mov_b64 v[174:175], 0
  v_mov_b64 v[176:177], 0
  v_mov_b64 v[178:179], 0
  v_mov_b64 v[180:181], 0
  v_mov_b64 v[182:183], 0
  v_mov_b64 v[184:185], 0
  v_mov_b64 v[186:187], 0
  v_mov_b64 v[188:189], 0
  v_mov_b64 v[190:191], 0
  s_waitcnt vmcnt(0)
  s_cmp_eq_u32 s82, 0
  s_cbranch_scc1 adaLN_cond__sliding_block_cached__glu_gated_swiglu__prompt_kernel_wb_w0a
  s_mov_b32 m0, s31
  s_nop 0
  buffer_load_dwordx4 v192, s[4:7], s28 offen lds
  buffer_load_dwordx4 v193, s[4:7], s28 offen offset:1024 lds
  buffer_load_dwordx4 v194, s[4:7], s28 offen offset:2048 lds
  s_add_u32 m0, s31, 12288
  s_add_u32 s28, s28, s30
  buffer_load_dwordx4 v195, s[8:11], s29 offen lds
  buffer_load_dwordx4 v196, s[8:11], s29 offen offset:1024 lds
  buffer_load_dwordx4 v197, s[8:11], s29 offen offset:2048 lds
  s_add_u32 s29, s29, s30
  s_add_u32 s32, s32, 1
  s_cmp_eq_u32 s32, 6
  s_cselect_b32 s40, s42, s43
  s_cselect_b32 s32, 0, s32
  s_add_u32 s31, s31, s40
  s_mov_b32 m0, s31
  s_nop 0
  buffer_load_dwordx4 v192, s[4:7], s28 offen lds
  buffer_load_dwordx4 v193, s[4:7], s28 offen offset:1024 lds
  buffer_load_dwordx4 v194, s[4:7], s28 offen offset:2048 lds
  s_add_u32 m0, s31, 12288
  s_add_u32 s28, s28, s30
  buffer_load_dwordx4 v195, s[8:11], s29 offen lds
  buffer_load_dwordx4 v196, s[8:11], s29 offen offset:1024 lds
  buffer_load_dwordx4 v197, s[8:11], s29 offen offset:2048 lds
  s_add_u32 s29, s29, s30
  s_add_u32 s32, s32, 1
  s_cmp_eq_u32 s32, 6
  s_cselect_b32 s40, s42, s43
  s_cselect_b32 s32, 0, s32
  s_add_u32 s31, s31, s40
  s_mov_b32 m0, s31
  s_nop 0
  buffer_load_dwordx4 v192, s[4:7], s28 offen lds
  buffer_load_dwordx4 v193, s[4:7], s28 offen offset:1024 lds
  buffer_load_dwordx4 v194, s[4:7], s28 offen offset:2048 lds
  s_add_u32 m0, s31, 12288
  s_add_u32 s28, s28, s30
  buffer_load_dwordx4 v195, s[8:11], s29 offen lds
  buffer_load_dwordx4 v196, s[8:11], s29 offen offset:1024 lds
  buffer_load_dwordx4 v197, s[8:11], s29 offen offset:2048 lds
  s_add_u32 s29, s29, s30
  s_add_u32 s32, s32, 1
  s_cmp_eq_u32 s32, 6
  s_cselect_b32 s40, s42, s43
  s_cselect_b32 s32, 0, s32
  s_add_u32 s31, s31, s40
  s_mov_b32 m0, s31
  s_nop 0
  buffer_load_dwordx4 v192, s[4:7], s28 offen lds
  buffer_load_dwordx4 v193, s[4:7], s28 offen offset:1024 lds
  buffer_load_dwordx4 v194, s[4:7], s28 offen offset:2048 lds
  s_add_u32 m0, s31, 12288
  s_add_u32 s28, s28, s30
  buffer_load_dwordx4 v195, s[8:11], s29 offen lds
  buffer_load_dwordx4 v196, s[8:11], s29 offen offset:1024 lds
  buffer_load_dwordx4 v197, s[8:11], s29 offen offset:2048 lds
  s_add_u32 s29, s29, s30
  s_add_u32 s32, s32, 1
  s_cmp_eq_u32 s32, 6
  s_cselect_b32 s40, s42, s43
  s_cselect_b32 s32, 0, s32
  s_add_u32 s31, s31, s40
adaLN_cond__sliding_block_cached__glu_gated_swiglu__prompt_kernel_wb_w0a:
s_cmp_eq_u32 s82, 0
s_cbranch_scc0 adaLN_cond__sliding_block_cached__glu_gated_swiglu__prompt_kernel_wb_nopoll
s_lshr_b32 s83, s2, 5
s_add_u32 s83, s83, 0
s_lshl_b32 s83, s83, 7
s_add_u32 s83, s83, 62914560
v_lshlrev_b32 v253, 2, v255
v_add_u32 v253, s83, v253
s_mov_b32 exec_lo, 0xffffffff
s_mov_b32 exec_hi, 0x0
s_mov_b32 s3, 400000
global_load_dword v254, v253, s[50:51] sc1
s_sleep 10
adaLN_cond__sliding_block_cached__glu_gated_swiglu__prompt_kernel_wb_poll:
global_load_dword v252, v253, s[50:51] sc1
s_waitcnt vmcnt(1)
v_cmp_ne_u32 vcc, 1, v254
s_nop 1
s_cmp_eq_u64 vcc, 0
s_cbranch_scc1 adaLN_cond__sliding_block_cached__glu_gated_swiglu__prompt_kernel_wb_ready
global_load_dword v254, v253, s[50:51] sc1
s_waitcnt vmcnt(1)
v_cmp_ne_u32 vcc, 1, v252
s_nop 1
s_cmp_eq_u64 vcc, 0
s_cbranch_scc1 adaLN_cond__sliding_block_cached__glu_gated_swiglu__prompt_kernel_wb_ready
s_sub_u32 s3, s3, 1
s_cmp_lg_u32 s3, 0
s_cbranch_scc1 adaLN_cond__sliding_block_cached__glu_gated_swiglu__prompt_kernel_wb_poll
s_endpgm
adaLN_cond__sliding_block_cached__glu_gated_swiglu__prompt_kernel_wb_ready:
s_mov_b64 exec, -1
adaLN_cond__sliding_block_cached__glu_gated_swiglu__prompt_kernel_wb_nopoll:
  s_barrier
s_cmp_eq_u32 s82, 0
s_cbranch_scc0 adaLN_cond__sliding_block_cached__glu_gated_swiglu__prompt_kernel_wb_w0b
s_mov_b32 m0, s31
s_nop 0
buffer_load_dwordx4 v192, s[4:7], s28 offen lds
buffer_load_dwordx4 v193, s[4:7], s28 offen offset:1024 lds
buffer_load_dwordx4 v194, s[4:7], s28 offen offset:2048 lds
s_add_u32 m0, s31, 12288
s_add_u32 s28, s28, s30
buffer_load_dwordx4 v195, s[8:11], s29 offen lds
buffer_load_dwordx4 v196, s[8:11], s29 offen offset:1024 lds
buffer_load_dwordx4 v197, s[8:11], s29 offen offset:2048 lds
s_add_u32 s29, s29, s30
s_add_u32 s32, s32, 1
s_cmp_eq_u32 s32, 6
s_cselect_b32 s40, s42, s43
s_cselect_b32 s32, 0, s32
s_add_u32 s31, s31, s40
s_mov_b32 m0, s31
s_nop 0
buffer_load_dwordx4 v192, s[4:7], s28 offen lds
buffer_load_dwordx4 v193, s[4:7], s28 offen offset:1024 lds
buffer_load_dwordx4 v194, s[4:7], s28 offen offset:2048 lds
s_add_u32 m0, s31, 12288
s_add_u32 s28, s28, s30
buffer_load_dwordx4 v195, s[8:11], s29 offen lds
buffer_load_dwordx4 v196, s[8:11], s29 offen offset:1024 lds
buffer_load_dwordx4 v197, s[8:11], s29 offen offset:2048 lds
s_add_u32 s29, s29, s30
s_add_u32 s32, s32, 1
s_cmp_eq_u32 s32, 6
s_cselect_b32 s40, s42, s43
s_cselect_b32 s32, 0, s32
s_add_u32 s31, s31, s40
s_mov_b32 m0, s31
s_nop 0
buffer_load_dwordx4 v192, s[4:7], s28 offen lds
buffer_load_dwordx4 v193, s[4:7], s28 offen offset:1024 lds
buffer_load_dwordx4 v194, s[4:7], s28 offen offset:2048 lds
s_add_u32 m0, s31, 12288
s_add_u32 s28, s28, s30
buffer_load_dwordx4 v195, s[8:11], s29 offen lds
buffer_load_dwordx4 v196, s[8:11], s29 offen offset:1024 lds
buffer_load_dwordx4 v197, s[8:11], s29 offen offset:2048 lds
s_add_u32 s29, s29, s30
s_add_u32 s32, s32, 1
s_cmp_eq_u32 s32, 6
s_cselect_b32 s40, s42, s43
s_cselect_b32 s32, 0, s32
s_add_u32 s31, s31, s40
s_mov_b32 m0, s31
s_nop 0
buffer_load_dwordx4 v192, s[4:7], s28 offen lds
buffer_load_dwordx4 v193, s[4:7], s28 offen offset:1024 lds
buffer_load_dwordx4 v194, s[4:7], s28 offen offset:2048 lds
s_add_u32 m0, s31, 12288
s_add_u32 s28, s28, s30
buffer_load_dwordx4 v195, s[8:11], s29 offen lds
buffer_load_dwordx4 v196, s[8:11], s29 offen offset:1024 lds
buffer_load_dwordx4 v197, s[8:11], s29 offen offset:2048 lds
s_add_u32 s29, s29, s30
s_add_u32 s32, s32, 1
s_cmp_eq_u32 s32, 6
s_cselect_b32 s40, s42, s43
s_cselect_b32 s32, 0, s32
s_add_u32 s31, s31, s40
adaLN_cond__sliding_block_cached__glu_gated_swiglu__prompt_kernel_wb_w0b:
  buffer_load_dwordx4 a[0:3], v204, s[20:23], s36 offen sc1
  buffer_load_dwordx4 a[4:7], v205, s[20:23], s36 offen sc1
  buffer_load_dwordx4 a[8:11], v206, s[20:23], s36 offen sc1
  buffer_load_dwordx4 a[12:15], v207, s[20:23], s36 offen sc1
  s_add_u32 s36, s36, 1024
  buffer_load_dwordx4 a[16:19], v204, s[20:23], s36 offen sc1
  buffer_load_dwordx4 a[20:23], v205, s[20:23], s36 offen sc1
  buffer_load_dwordx4 a[24:27], v206, s[20:23], s36 offen sc1
  buffer_load_dwordx4 a[28:31], v207, s[20:23], s36 offen sc1
  s_add_u32 s36, s36, 1024
  buffer_load_dwordx4 a[32:35], v204, s[20:23], s36 offen sc1
  buffer_load_dwordx4 a[36:39], v205, s[20:23], s36 offen sc1
  buffer_load_dwordx4 a[40:43], v206, s[20:23], s36 offen sc1
  buffer_load_dwordx4 a[44:47], v207, s[20:23], s36 offen sc1
  s_add_u32 s36, s36, 1024
  s_waitcnt vmcnt(8)
  s_barrier
  ds_read_b64_tr_b16 a[192:193], v198 offset:0
  ds_read_b64_tr_b16 a[194:195], v198 offset:1536
  ds_read_b64_tr_b16 a[196:197], v198 offset:8
  ds_read_b64_tr_b16 a[198:199], v198 offset:1544
  ds_read_b64_tr_b16 a[200:201], v199 offset:0
  ds_read_b64_tr_b16 a[202:203], v199 offset:1536
  ds_read_b64_tr_b16 a[204:205], v199 offset:8
  ds_read_b64_tr_b16 a[206:207], v199 offset:1544
  s_waitcnt lgkmcnt(6)
  s_mov_b32 s35, 5
adaLN_cond__sliding_block_cached__glu_gated_swiglu__prompt_kernel_c_p1:
  v_mfma_f32_16x16x32_bf16 v[0:3], a[192:195], a[0:3], v[0:3]
  ds_read_b64_tr_b16 a[208:209], v198 offset:128
  v_mfma_f32_16x16x32_bf16 v[48:51], a[192:195], a[4:7], v[48:51]
  buffer_load_dwordx4 a[48:51], v204, s[20:23], s36 offen sc1
  v_mfma_f32_16x16x32_bf16 v[96:99], a[192:195], a[8:11], v[96:99]
  ds_read_b64_tr_b16 a[210:211], v198 offset:1664
  v_mfma_f32_16x16x32_bf16 v[144:147], a[192:195], a[12:15], v[144:147]
  s_waitcnt lgkmcnt(6)
  v_mfma_f32_16x16x32_bf16 v[4:7], a[196:199], a[0:3], v[4:7]
  ds_read_b64_tr_b16 a[212:213], v198 offset:136
  v_mfma_f32_16x16x32_bf16 v[52:55], a[196:199], a[4:7], v[52:55]
  buffer_load_dwordx4 a[52:55], v205, s[20:23], s36 offen sc1
  v_mfma_f32_16x16x32_bf16 v[100:103], a[196:199], a[8:11], v[100:103]
  ds_read_b64_tr_b16 a[214:215], v198 offset:1672
  v_mfma_f32_16x16x32_bf16 v[148:151], a[196:199], a[12:15], v[148:151]
  s_waitcnt lgkmcnt(6)
  v_mfma_f32_16x16x32_bf16 v[8:11], a[200:203], a[0:3], v[8:11]
  ds_read_b64_tr_b16 a[216:217], v199 offset:128
  v_mfma_f32_16x16x32_bf16 v[56:59], a[200:203], a[4:7], v[56:59]
  buffer_load_dwordx4 a[56:59], v206, s[20:23], s36 offen sc1
  v_mfma_f32_16x16x32_bf16 v[104:107], a[200:203], a[8:11], v[104:107]
  ds_read_b64_tr_b16 a[218:219], v199 offset:1664
  v_mfma_f32_16x16x32_bf16 v[152:155], a[200:203], a[12:15], v[152:155]
  s_waitcnt lgkmcnt(6)
  v_mfma_f32_16x16x32_bf16 v[12:15], a[204:207], a[0:3], v[12:15]
  ds_read_b64_tr_b16 a[220:221], v199 offset:136
  v_mfma_f32_16x16x32_bf16 v[60:63], a[204:207], a[4:7], v[60:63]
  buffer_load_dwordx4 a[60:63], v207, s[20:23], s36 offen sc1
  v_mfma_f32_16x16x32_bf16 v[108:111], a[204:207], a[8:11], v[108:111]
  s_mov_b32 m0, s31
  ds_read_b64_tr_b16 a[222:223], v199 offset:1672
  v_mfma_f32_16x16x32_bf16 v[156:159], a[204:207], a[12:15], v[156:159]
  s_waitcnt lgkmcnt(6)
  v_mfma_f32_16x16x32_bf16 v[16:19], a[208:211], a[0:3], v[16:19]
  s_add_u32 s36, s36, 1024
  ds_read_b64_tr_b16 a[192:193], v198 offset:256
  v_mfma_f32_16x16x32_bf16 v[64:67], a[208:211], a[4:7], v[64:67]
  s_cmp_lt_u32 s36, s39
  v_mfma_f32_16x16x32_bf16 v[112:115], a[208:211], a[8:11], v[112:115]
  s_cselect_b32 s22, s88, 0
  ds_read_b64_tr_b16 a[194:195], v198 offset:1792
  v_mfma_f32_16x16x32_bf16 v[160:163], a[208:211], a[12:15], v[160:163]
  s_waitcnt lgkmcnt(6)
  v_mfma_f32_16x16x32_bf16 v[20:23], a[212:215], a[0:3], v[20:23]
  ds_read_b64_tr_b16 a[196:197], v198 offset:264
  v_mfma_f32_16x16x32_bf16 v[68:71], a[212:215], a[4:7], v[68:71]
  buffer_load_dwordx4 v192, s[4:7], s28 offen lds
  v_mfma_f32_16x16x32_bf16 v[116:119], a[212:215], a[8:11], v[116:119]
  ds_read_b64_tr_b16 a[198:199], v198 offset:1800
  v_mfma_f32_16x16x32_bf16 v[164:167], a[212:215], a[12:15], v[164:167]
  s_waitcnt lgkmcnt(6)
  v_mfma_f32_16x16x32_bf16 v[24:27], a[216:219], a[0:3], v[24:27]
  ds_read_b64_tr_b16 a[200:201], v199 offset:256
  v_mfma_f32_16x16x32_bf16 v[72:75], a[216:219], a[4:7], v[72:75]
  v_mfma_f32_16x16x32_bf16 v[120:123], a[216:219], a[8:11], v[120:123]
  ds_read_b64_tr_b16 a[202:203], v199 offset:1792
  v_mfma_f32_16x16x32_bf16 v[168:171], a[216:219], a[12:15], v[168:171]
  s_waitcnt lgkmcnt(6)
  v_mfma_f32_16x16x32_bf16 v[28:31], a[220:223], a[0:3], v[28:31]
  ds_read_b64_tr_b16 a[204:205], v199 offset:264
  v_mfma_f32_16x16x32_bf16 v[76:79], a[220:223], a[4:7], v[76:79]
  buffer_load_dwordx4 v193, s[4:7], s28 offen offset:1024 lds
  v_mfma_f32_16x16x32_bf16 v[124:127], a[220:223], a[8:11], v[124:127]
  ds_read_b64_tr_b16 a[206:207], v199 offset:1800
  v_mfma_f32_16x16x32_bf16 v[172:175], a[220:223], a[12:15], v[172:175]
  s_waitcnt lgkmcnt(6)
  v_mfma_f32_16x16x32_bf16 v[32:35], a[192:195], a[0:3], v[32:35]
  ds_read_b64_tr_b16 a[208:209], v198 offset:12288
  v_mfma_f32_16x16x32_bf16 v[80:83], a[192:195], a[4:7], v[80:83]
  v_mfma_f32_16x16x32_bf16 v[128:131], a[192:195], a[8:11], v[128:131]
  ds_read_b64_tr_b16 a[210:211], v198 offset:13824
  v_mfma_f32_16x16x32_bf16 v[176:179], a[192:195], a[12:15], v[176:179]
  s_waitcnt lgkmcnt(6)
  v_mfma_f32_16x16x32_bf16 v[36:39], a[196:199], a[0:3], v[36:39]
  ds_read_b64_tr_b16 a[212:213], v198 offset:12296
  v_mfma_f32_16x16x32_bf16 v[84:87], a[196:199], a[4:7], v[84:87]
  buffer_load_dwordx4 v194, s[4:7], s28 offen offset:2048 lds
  v_mfma_f32_16x16x32_bf16 v[132:135], a[196:199], a[8:11], v[132:135]
  ds_read_b64_tr_b16 a[214:215], v198 offset:13832
  v_mfma_f32_16x16x32_bf16 v[180:183], a[196:199], a[12:15], v[180:183]
  s_waitcnt lgkmcnt(6)
  v_mfma_f32_16x16x32_bf16 v[40:43], a[200:203], a[0:3], v[40:43]
  s_add_u32 s28, s28, s30
  ds_read_b64_tr_b16 a[216:217], v199 offset:12288
  v_mfma_f32_16x16x32_bf16 v[88:91], a[200:203], a[4:7], v[88:91]
  v_mfma_f32_16x16x32_bf16 v[136:139], a[200:203], a[8:11], v[136:139]
  s_add_u32 s34, s34, 1
  ds_read_b64_tr_b16 a[218:219], v199 offset:13824
  v_mfma_f32_16x16x32_bf16 v[184:187], a[200:203], a[12:15], v[184:187]
  s_waitcnt lgkmcnt(6)
  s_cmp_eq_u32 s34, 6
  v_mfma_f32_16x16x32_bf16 v[44:47], a[204:207], a[0:3], v[44:47]
  s_cselect_b32 s33, s42, s43
  ds_read_b64_tr_b16 a[220:221], v199 offset:12296
  v_mfma_f32_16x16x32_bf16 v[92:95], a[204:207], a[4:7], v[92:95]
  s_cselect_b32 s34, 0, s34
  v_mfma_f32_16x16x32_bf16 v[140:143], a[204:207], a[8:11], v[140:143]
  ds_read_b64_tr_b16 a[222:223], v199 offset:13832
  v_mfma_f32_16x16x32_bf16 v[188:191], a[204:207], a[12:15], v[188:191]
  s_waitcnt vmcnt(11) lgkmcnt(6)
  v_mfma_f32_16x16x32_bf16 v[0:3], a[208:211], a[16:19], v[0:3]
  ds_read_b64_tr_b16 a[192:193], v198 offset:12416
  v_mfma_f32_16x16x32_bf16 v[48:51], a[208:211], a[20:23], v[48:51]
  buffer_load_dwordx4 a[0:3], v204, s[20:23], s36 offen sc1
  v_mfma_f32_16x16x32_bf16 v[96:99], a[208:211], a[24:27], v[96:99]
  ds_read_b64_tr_b16 a[194:195], v198 offset:13952
  v_mfma_f32_16x16x32_bf16 v[144:147], a[208:211], a[28:31], v[144:147]
  s_waitcnt lgkmcnt(6)
  v_mfma_f32_16x16x32_bf16 v[4:7], a[212:215], a[16:19], v[4:7]
  ds_read_b64_tr_b16 a[196:197], v198 offset:12424
  v_mfma_f32_16x16x32_bf16 v[52:55], a[212:215], a[20:23], v[52:55]
  buffer_load_dwordx4 a[4:7], v205, s[20:23], s36 offen sc1
  v_mfma_f32_16x16x32_bf16 v[100:103], a[212:215], a[24:27], v[100:103]
  ds_read_b64_tr_b16 a[198:199], v198 offset:13960
  v_mfma_f32_16x16x32_bf16 v[148:151], a[212:215], a[28:31], v[148:151]
  s_waitcnt lgkmcnt(6)
  v_mfma_f32_16x16x32_bf16 v[8:11], a[216:219], a[16:19], v[8:11]
  ds_read_b64_tr_b16 a[200:201], v199 offset:12416
  v_mfma_f32_16x16x32_bf16 v[56:59], a[216:219], a[20:23], v[56:59]
  buffer_load_dwordx4 a[8:11], v206, s[20:23], s36 offen sc1
  v_mfma_f32_16x16x32_bf16 v[104:107], a[216:219], a[24:27], v[104:107]
  ds_read_b64_tr_b16 a[202:203], v199 offset:13952
  v_mfma_f32_16x16x32_bf16 v[152:155], a[216:219], a[28:31], v[152:155]
  s_waitcnt lgkmcnt(6)
  v_mfma_f32_16x16x32_bf16 v[12:15], a[220:223], a[16:19], v[12:15]
  ds_read_b64_tr_b16 a[204:205], v199 offset:12424
  v_mfma_f32_16x16x32_bf16 v[60:63], a[220:223], a[20:23], v[60:63]
  buffer_load_dwordx4 a[12:15], v207, s[20:23], s36 offen sc1
  v_mfma_f32_16x16x32_bf16 v[108:111], a[220:223], a[24:27], v[108:111]
  s_add_u32 m0, s31, 12288
  ds_read_b64_tr_b16 a[206:207], v199 offset:13960
  v_mfma_f32_16x16x32_bf16 v[156:159], a[220:223], a[28:31], v[156:159]
  s_waitcnt lgkmcnt(6)
  v_mfma_f32_16x16x32_bf16 v[16:19], a[192:195], a[16:19], v[16:19]
  s_add_u32 s36, s36, 1024
  ds_read_b64_tr_b16 a[208:209], v198 offset:12544
  v_mfma_f32_16x16x32_bf16 v[64:67], a[192:195], a[20:23], v[64:67]
  s_cmp_lt_u32 s36, s39
  v_mfma_f32_16x16x32_bf16 v[112:115], a[192:195], a[24:27], v[112:115]
  s_cselect_b32 s22, s88, 0
  ds_read_b64_tr_b16 a[210:211], v198 offset:14080
  v_mfma_f32_16x16x32_bf16 v[160:163], a[192:195], a[28:31], v[160:163]
  s_waitcnt lgkmcnt(6)
  v_mfma_f32_16x16x32_bf16 v[20:23], a[196:199], a[16:19], v[20:23]
  ds_read_b64_tr_b16 a[212:213], v198 offset:12552
  v_mfma_f32_16x16x32_bf16 v[68:71], a[196:199], a[20:23], v[68:71]
  buffer_load_dwordx4 v195, s[8:11], s29 offen lds
  v_mfma_f32_16x16x32_bf16 v[116:119], a[196:199], a[24:27], v[116:119]
  ds_read_b64_tr_b16 a[214:215], v198 offset:14088
  v_mfma_f32_16x16x32_bf16 v[164:167], a[196:199], a[28:31], v[164:167]
  s_waitcnt lgkmcnt(6)
  v_mfma_f32_16x16x32_bf16 v[24:27], a[200:203], a[16:19], v[24:27]
  ds_read_b64_tr_b16 a[216:217], v199 offset:12544
  v_add_u32 v198, s33, v198
  v_mfma_f32_16x16x32_bf16 v[72:75], a[200:203], a[20:23], v[72:75]
  v_mfma_f32_16x16x32_bf16 v[120:123], a[200:203], a[24:27], v[120:123]
  ds_read_b64_tr_b16 a[218:219], v199 offset:14080
  v_mfma_f32_16x16x32_bf16 v[168:171], a[200:203], a[28:31], v[168:171]
  s_waitcnt lgkmcnt(6)
  v_mfma_f32_16x16x32_bf16 v[28:31], a[204:207], a[16:19], v[28:31]
  ds_read_b64_tr_b16 a[220:221], v199 offset:12552
  v_mfma_f32_16x16x32_bf16 v[76:79], a[204:207], a[20:23], v[76:79]
  buffer_load_dwordx4 v196, s[8:11], s29 offen offset:1024 lds
  v_mfma_f32_16x16x32_bf16 v[124:127], a[204:207], a[24:27], v[124:127]
  s_barrier
  ds_read_b64_tr_b16 a[222:223], v199 offset:14088
  v_mfma_f32_16x16x32_bf16 v[172:175], a[204:207], a[28:31], v[172:175]
  s_waitcnt lgkmcnt(6)
  v_mfma_f32_16x16x32_bf16 v[32:35], a[208:211], a[16:19], v[32:35]
  ds_read_b64_tr_b16 a[192:193], v198 offset:0
  v_add_u32 v199, s33, v199
  v_mfma_f32_16x16x32_bf16 v[80:83], a[208:211], a[20:23], v[80:83]
  v_mfma_f32_16x16x32_bf16 v[128:131], a[208:211], a[24:27], v[128:131]
  ds_read_b64_tr_b16 a[194:195], v198 offset:1536
  v_mfma_f32_16x16x32_bf16 v[176:179], a[208:211], a[28:31], v[176:179]
  s_waitcnt lgkmcnt(6)
  v_mfma_f32_16x16x32_bf16 v[36:39], a[212:215], a[16:19], v[36:39]
  ds_read_b64_tr_b16 a[196:197], v198 offset:8
  v_mfma_f32_16x16x32_bf16 v[84:87], a[212:215], a[20:23], v[84:87]
  buffer_load_dwordx4 v197, s[8:11], s29 offen offset:2048 lds
  v_mfma_f32_16x16x32_bf16 v[132:135], a[212:215], a[24:27], v[132:135]
  s_add_u32 s29, s29, s30
  ds_read_b64_tr_b16 a[198:199], v198 offset:1544
  v_mfma_f32_16x16x32_bf16 v[180:183], a[212:215], a[28:31], v[180:183]
  s_waitcnt lgkmcnt(6)
  v_mfma_f32_16x16x32_bf16 v[40:43], a[216:219], a[16:19], v[40:43]
  s_add_u32 s32, s32, 1
  ds_read_b64_tr_b16 a[200:201], v199 offset:0
  v_mfma_f32_16x16x32_bf16 v[88:91], a[216:219], a[20:23], v[88:91]
  s_cmp_eq_u32 s32, 6
  v_mfma_f32_16x16x32_bf16 v[136:139], a[216:219], a[24:27], v[136:139]
  s_cselect_b32 s40, s42, s43
  ds_read_b64_tr_b16 a[202:203], v199 offset:1536
  v_mfma_f32_16x16x32_bf16 v[184:187], a[216:219], a[28:31], v[184:187]
  s_waitcnt lgkmcnt(6)
  s_cselect_b32 s32, 0, s32
  v_mfma_f32_16x16x32_bf16 v[44:47], a[220:223], a[16:19], v[44:47]
  s_add_u32 s31, s31, s40
  ds_read_b64_tr_b16 a[204:205], v199 offset:8
  v_mfma_f32_16x16x32_bf16 v[92:95], a[220:223], a[20:23], v[92:95]
  v_mfma_f32_16x16x32_bf16 v[140:143], a[220:223], a[24:27], v[140:143]
  ds_read_b64_tr_b16 a[206:207], v199 offset:1544
  v_mfma_f32_16x16x32_bf16 v[188:191], a[220:223], a[28:31], v[188:191]
  s_waitcnt vmcnt(14) lgkmcnt(6)
  v_mfma_f32_16x16x32_bf16 v[0:3], a[192:195], a[32:35], v[0:3]
  ds_read_b64_tr_b16 a[208:209], v198 offset:128
  v_mfma_f32_16x16x32_bf16 v[48:51], a[192:195], a[36:39], v[48:51]
  buffer_load_dwordx4 a[16:19], v204, s[20:23], s36 offen sc1
  v_mfma_f32_16x16x32_bf16 v[96:99], a[192:195], a[40:43], v[96:99]
  ds_read_b64_tr_b16 a[210:211], v198 offset:1664
  v_mfma_f32_16x16x32_bf16 v[144:147], a[192:195], a[44:47], v[144:147]
  s_waitcnt lgkmcnt(6)
  v_mfma_f32_16x16x32_bf16 v[4:7], a[196:199], a[32:35], v[4:7]
  ds_read_b64_tr_b16 a[212:213], v198 offset:136
  v_mfma_f32_16x16x32_bf16 v[52:55], a[196:199], a[36:39], v[52:55]
  buffer_load_dwordx4 a[20:23], v205, s[20:23], s36 offen sc1
  v_mfma_f32_16x16x32_bf16 v[100:103], a[196:199], a[40:43], v[100:103]
  ds_read_b64_tr_b16 a[214:215], v198 offset:1672
  v_mfma_f32_16x16x32_bf16 v[148:151], a[196:199], a[44:47], v[148:151]
  s_waitcnt lgkmcnt(6)
  v_mfma_f32_16x16x32_bf16 v[8:11], a[200:203], a[32:35], v[8:11]
  ds_read_b64_tr_b16 a[216:217], v199 offset:128
  v_mfma_f32_16x16x32_bf16 v[56:59], a[200:203], a[36:39], v[56:59]
  buffer_load_dwordx4 a[24:27], v206, s[20:23], s36 offen sc1
  v_mfma_f32_16x16x32_bf16 v[104:107], a[200:203], a[40:43], v[104:107]
  ds_read_b64_tr_b16 a[218:219], v199 offset:1664
  v_mfma_f32_16x16x32_bf16 v[152:155], a[200:203], a[44:47], v[152:155]
  s_waitcnt lgkmcnt(6)
  v_mfma_f32_16x16x32_bf16 v[12:15], a[204:207], a[32:35], v[12:15]
  ds_read_b64_tr_b16 a[220:221], v199 offset:136
  v_mfma_f32_16x16x32_bf16 v[60:63], a[204:207], a[36:39], v[60:63]
  buffer_load_dwordx4 a[28:31], v207, s[20:23], s36 offen sc1
  v_mfma_f32_16x16x32_bf16 v[108:111], a[204:207], a[40:43], v[108:111]
  s_mov_b32 m0, s31
  ds_read_b64_tr_b16 a[222:223], v199 offset:1672
  v_mfma_f32_16x16x32_bf16 v[156:159], a[204:207], a[44:47], v[156:159]
  s_waitcnt lgkmcnt(6)
  v_mfma_f32_16x16x32_bf16 v[16:19], a[208:211], a[32:35], v[16:19]
  s_add_u32 s36, s36, 1024
  ds_read_b64_tr_b16 a[192:193], v198 offset:256
  v_mfma_f32_16x16x32_bf16 v[64:67], a[208:211], a[36:39], v[64:67]
  s_cmp_lt_u32 s36, s39
  v_mfma_f32_16x16x32_bf16 v[112:115], a[208:211], a[40:43], v[112:115]
  s_cselect_b32 s22, s88, 0
  ds_read_b64_tr_b16 a[194:195], v198 offset:1792
  v_mfma_f32_16x16x32_bf16 v[160:163], a[208:211], a[44:47], v[160:163]
  s_waitcnt lgkmcnt(6)
  v_mfma_f32_16x16x32_bf16 v[20:23], a[212:215], a[32:35], v[20:23]
  ds_read_b64_tr_b16 a[196:197], v198 offset:264
  v_mfma_f32_16x16x32_bf16 v[68:71], a[212:215], a[36:39], v[68:71]
  buffer_load_dwordx4 v192, s[4:7], s28 offen lds
  v_mfma_f32_16x16x32_bf16 v[116:119], a[212:215], a[40:43], v[116:119]
  ds_read_b64_tr_b16 a[198:199], v198 offset:1800
  v_mfma_f32_16x16x32_bf16 v[164:167], a[212:215], a[44:47], v[164:167]
  s_waitcnt lgkmcnt(6)
  v_mfma_f32_16x16x32_bf16 v[24:27], a[216:219], a[32:35], v[24:27]
  ds_read_b64_tr_b16 a[200:201], v199 offset:256
  v_mfma_f32_16x16x32_bf16 v[72:75], a[216:219], a[36:39], v[72:75]
  v_mfma_f32_16x16x32_bf16 v[120:123], a[216:219], a[40:43], v[120:123]
  ds_read_b64_tr_b16 a[202:203], v199 offset:1792
  v_mfma_f32_16x16x32_bf16 v[168:171], a[216:219], a[44:47], v[168:171]
  s_waitcnt lgkmcnt(6)
  v_mfma_f32_16x16x32_bf16 v[28:31], a[220:223], a[32:35], v[28:31]
  ds_read_b64_tr_b16 a[204:205], v199 offset:264
  v_mfma_f32_16x16x32_bf16 v[76:79], a[220:223], a[36:39], v[76:79]
  buffer_load_dwordx4 v193, s[4:7], s28 offen offset:1024 lds
  v_mfma_f32_16x16x32_bf16 v[124:127], a[220:223], a[40:43], v[124:127]
  ds_read_b64_tr_b16 a[206:207], v199 offset:1800
  v_mfma_f32_16x16x32_bf16 v[172:175], a[220:223], a[44:47], v[172:175]
  s_waitcnt lgkmcnt(6)
  v_mfma_f32_16x16x32_bf16 v[32:35], a[192:195], a[32:35], v[32:35]
  ds_read_b64_tr_b16 a[208:209], v198 offset:12288
  v_mfma_f32_16x16x32_bf16 v[80:83], a[192:195], a[36:39], v[80:83]
  v_mfma_f32_16x16x32_bf16 v[128:131], a[192:195], a[40:43], v[128:131]
  ds_read_b64_tr_b16 a[210:211], v198 offset:13824
  v_mfma_f32_16x16x32_bf16 v[176:179], a[192:195], a[44:47], v[176:179]
  s_waitcnt lgkmcnt(6)
  v_mfma_f32_16x16x32_bf16 v[36:39], a[196:199], a[32:35], v[36:39]
  ds_read_b64_tr_b16 a[212:213], v198 offset:12296
  v_mfma_f32_16x16x32_bf16 v[84:87], a[196:199], a[36:39], v[84:87]
  buffer_load_dwordx4 v194, s[4:7], s28 offen offset:2048 lds
  v_mfma_f32_16x16x32_bf16 v[132:135], a[196:199], a[40:43], v[132:135]
  ds_read_b64_tr_b16 a[214:215], v198 offset:13832
  v_mfma_f32_16x16x32_bf16 v[180:183], a[196:199], a[44:47], v[180:183]
  s_waitcnt lgkmcnt(6)
  v_mfma_f32_16x16x32_bf16 v[40:43], a[200:203], a[32:35], v[40:43]
  s_add_u32 s28, s28, s30
  ds_read_b64_tr_b16 a[216:217], v199 offset:12288
  v_mfma_f32_16x16x32_bf16 v[88:91], a[200:203], a[36:39], v[88:91]
  v_mfma_f32_16x16x32_bf16 v[136:139], a[200:203], a[40:43], v[136:139]
  s_add_u32 s34, s34, 1
  ds_read_b64_tr_b16 a[218:219], v199 offset:13824
  v_mfma_f32_16x16x32_bf16 v[184:187], a[200:203], a[44:47], v[184:187]
  s_waitcnt lgkmcnt(6)
  s_cmp_eq_u32 s34, 6
  v_mfma_f32_16x16x32_bf16 v[44:47], a[204:207], a[32:35], v[44:47]
  s_cselect_b32 s33, s42, s43
  ds_read_b64_tr_b16 a[220:221], v199 offset:12296
  v_mfma_f32_16x16x32_bf16 v[92:95], a[204:207], a[36:39], v[92:95]
  s_cselect_b32 s34, 0, s34
  v_mfma_f32_16x16x32_bf16 v[140:143], a[204:207], a[40:43], v[140:143]
  ds_read_b64_tr_b16 a[222:223], v199 offset:13832
  v_mfma_f32_16x16x32_bf16 v[188:191], a[204:207], a[44:47], v[188:191]
  s_waitcnt vmcnt(17) lgkmcnt(6)
  v_mfma_f32_16x16x32_bf16 v[0:3], a[208:211], a[48:51], v[0:3]
  ds_read_b64_tr_b16 a[192:193], v198 offset:12416
  v_mfma_f32_16x16x32_bf16 v[48:51], a[208:211], a[52:55], v[48:51]
  buffer_load_dwordx4 a[32:35], v204, s[20:23], s36 offen sc1
  v_mfma_f32_16x16x32_bf16 v[96:99], a[208:211], a[56:59], v[96:99]
  ds_read_b64_tr_b16 a[194:195], v198 offset:13952
  v_mfma_f32_16x16x32_bf16 v[144:147], a[208:211], a[60:63], v[144:147]
  s_waitcnt lgkmcnt(6)
  v_mfma_f32_16x16x32_bf16 v[4:7], a[212:215], a[48:51], v[4:7]
  ds_read_b64_tr_b16 a[196:197], v198 offset:12424
  v_mfma_f32_16x16x32_bf16 v[52:55], a[212:215], a[52:55], v[52:55]
  buffer_load_dwordx4 a[36:39], v205, s[20:23], s36 offen sc1
  v_mfma_f32_16x16x32_bf16 v[100:103], a[212:215], a[56:59], v[100:103]
  ds_read_b64_tr_b16 a[198:199], v198 offset:13960
  v_mfma_f32_16x16x32_bf16 v[148:151], a[212:215], a[60:63], v[148:151]
  s_waitcnt lgkmcnt(6)
  v_mfma_f32_16x16x32_bf16 v[8:11], a[216:219], a[48:51], v[8:11]
  ds_read_b64_tr_b16 a[200:201], v199 offset:12416
  v_mfma_f32_16x16x32_bf16 v[56:59], a[216:219], a[52:55], v[56:59]
  buffer_load_dwordx4 a[40:43], v206, s[20:23], s36 offen sc1
  v_mfma_f32_16x16x32_bf16 v[104:107], a[216:219], a[56:59], v[104:107]
  ds_read_b64_tr_b16 a[202:203], v199 offset:13952
  v_mfma_f32_16x16x32_bf16 v[152:155], a[216:219], a[60:63], v[152:155]
  s_waitcnt lgkmcnt(6)
  v_mfma_f32_16x16x32_bf16 v[12:15], a[220:223], a[48:51], v[12:15]
  ds_read_b64_tr_b16 a[204:205], v199 offset:12424
  v_mfma_f32_16x16x32_bf16 v[60:63], a[220:223], a[52:55], v[60:63]
  buffer_load_dwordx4 a[44:47], v207, s[20:23], s36 offen sc1
  v_mfma_f32_16x16x32_bf16 v[108:111], a[220:223], a[56:59], v[108:111]
  s_add_u32 m0, s31, 12288
  ds_read_b64_tr_b16 a[206:207], v199 offset:13960
  v_mfma_f32_16x16x32_bf16 v[156:159], a[220:223], a[60:63], v[156:159]
  s_waitcnt lgkmcnt(6)
  v_mfma_f32_16x16x32_bf16 v[16:19], a[192:195], a[48:51], v[16:19]
  s_add_u32 s36, s36, 1024
  ds_read_b64_tr_b16 a[208:209], v198 offset:12544
  v_mfma_f32_16x16x32_bf16 v[64:67], a[192:195], a[52:55], v[64:67]
  s_cmp_lt_u32 s36, s39
  v_mfma_f32_16x16x32_bf16 v[112:115], a[192:195], a[56:59], v[112:115]
  s_cselect_b32 s22, s88, 0
  ds_read_b64_tr_b16 a[210:211], v198 offset:14080
  v_mfma_f32_16x16x32_bf16 v[160:163], a[192:195], a[60:63], v[160:163]
  s_waitcnt lgkmcnt(6)
  v_mfma_f32_16x16x32_bf16 v[20:23], a[196:199], a[48:51], v[20:23]
  ds_read_b64_tr_b16 a[212:213], v198 offset:12552
  v_mfma_f32_16x16x32_bf16 v[68:71], a[196:199], a[52:55], v[68:71]
  buffer_load_dwordx4 v195, s[8:11], s29 offen lds
  v_mfma_f32_16x16x32_bf16 v[116:119], a[196:199], a[56:59], v[116:119]
  ds_read_b64_tr_b16 a[214:215], v198 offset:14088
  v_mfma_f32_16x16x32_bf16 v[164:167], a[196:199], a[60:63], v[164:167]
  s_waitcnt lgkmcnt(6)
  v_mfma_f32_16x16x32_bf16 v[24:27], a[200:203], a[48:51], v[24:27]
  ds_read_b64_tr_b16 a[216:217], v199 offset:12544
  v_add_u32 v198, s33, v198
  v_mfma_f32_16x16x32_bf16 v[72:75], a[200:203], a[52:55], v[72:75]
  v_mfma_f32_16x16x32_bf16 v[120:123], a[200:203], a[56:59], v[120:123]
  ds_read_b64_tr_b16 a[218:219], v199 offset:14080
  v_mfma_f32_16x16x32_bf16 v[168:171], a[200:203], a[60:63], v[168:171]
  s_waitcnt lgkmcnt(6)
  v_mfma_f32_16x16x32_bf16 v[28:31], a[204:207], a[48:51], v[28:31]
  ds_read_b64_tr_b16 a[220:221], v199 offset:12552
  v_mfma_f32_16x16x32_bf16 v[76:79], a[204:207], a[52:55], v[76:79]
  buffer_load_dwordx4 v196, s[8:11], s29 offen offset:1024 lds
  v_mfma_f32_16x16x32_bf16 v[124:127], a[204:207], a[56:59], v[124:127]
  s_barrier
  ds_read_b64_tr_b16 a[222:223], v199 offset:14088
  v_mfma_f32_16x16x32_bf16 v[172:175], a[204:207], a[60:63], v[172:175]
  s_waitcnt lgkmcnt(6)
  v_mfma_f32_16x16x32_bf16 v[32:35], a[208:211], a[48:51], v[32:35]
  ds_read_b64_tr_b16 a[192:193], v198 offset:0
  v_add_u32 v199, s33, v199
  v_mfma_f32_16x16x32_bf16 v[80:83], a[208:211], a[52:55], v[80:83]
  v_mfma_f32_16x16x32_bf16 v[128:131], a[208:211], a[56:59], v[128:131]
  ds_read_b64_tr_b16 a[194:195], v198 offset:1536
  v_mfma_f32_16x16x32_bf16 v[176:179], a[208:211], a[60:63], v[176:179]
  s_waitcnt lgkmcnt(6)
  v_mfma_f32_16x16x32_bf16 v[36:39], a[212:215], a[48:51], v[36:39]
  ds_read_b64_tr_b16 a[196:197], v198 offset:8
  v_mfma_f32_16x16x32_bf16 v[84:87], a[212:215], a[52:55], v[84:87]
  buffer_load_dwordx4 v197, s[8:11], s29 offen offset:2048 lds
  v_mfma_f32_16x16x32_bf16 v[132:135], a[212:215], a[56:59], v[132:135]
  s_add_u32 s29, s29, s30
  ds_read_b64_tr_b16 a[198:199], v198 offset:1544
  v_mfma_f32_16x16x32_bf16 v[180:183], a[212:215], a[60:63], v[180:183]
  s_waitcnt lgkmcnt(6)
  s_add_u32 s32, s32, 1
  v_mfma_f32_16x16x32_bf16 v[40:43], a[216:219], a[48:51], v[40:43]
  s_cmp_eq_u32 s32, 6
  ds_read_b64_tr_b16 a[200:201], v199 offset:0
  v_mfma_f32_16x16x32_bf16 v[88:91], a[216:219], a[52:55], v[88:91]
  s_cselect_b32 s40, s42, s43
  v_mfma_f32_16x16x32_bf16 v[136:139], a[216:219], a[56:59], v[136:139]
  s_cselect_b32 s32, 0, s32
  ds_read_b64_tr_b16 a[202:203], v199 offset:1536
  v_mfma_f32_16x16x32_bf16 v[184:187], a[216:219], a[60:63], v[184:187]
  s_waitcnt lgkmcnt(6)
  s_add_u32 s31, s31, s40
  v_mfma_f32_16x16x32_bf16 v[44:47], a[220:223], a[48:51], v[44:47]
  s_sub_u32 s35, s35, 1
  ds_read_b64_tr_b16 a[204:205], v199 offset:8
  v_mfma_f32_16x16x32_bf16 v[92:95], a[220:223], a[52:55], v[92:95]
  s_cmp_eq_u32 s35, 2
  v_mfma_f32_16x16x32_bf16 v[140:143], a[220:223], a[56:59], v[140:143]
  ds_read_b64_tr_b16 a[206:207], v199 offset:1544
  v_mfma_f32_16x16x32_bf16 v[188:191], a[220:223], a[60:63], v[188:191]
  s_waitcnt vmcnt(17) lgkmcnt(6)
  s_cbranch_scc0 adaLN_cond__sliding_block_cached__glu_gated_swiglu__prompt_kernel_c_p1_nosw
s_mov_b32 s4, s12
s_mov_b32 s8, s16
s_mov_b32 s5, s13
s_mov_b32 s9, s17
s_mov_b32 s6, s14
s_mov_b32 s10, s18
s_mov_b32 s7, s15
s_mov_b32 s11, s19
s_mul_i32 s28, s37, 786432
s_add_u32 s28, s28, 587776
s_sub_u32 s29, s28, 12288
s_mov_b32 s30, 12288
v_mov_b32 v192, v208
v_mov_b32 v195, v211
v_mov_b32 v193, v209
v_mov_b32 v196, v212
v_mov_b32 v194, v210
v_mov_b32 v197, v213
adaLN_cond__sliding_block_cached__glu_gated_swiglu__prompt_kernel_c_p1_nosw:
  s_cmp_lg_u32 s35, 0
  s_cbranch_scc1 adaLN_cond__sliding_block_cached__glu_gated_swiglu__prompt_kernel_c_p1
  s_mov_b32 s88, 1966080
  v_mov_b32 v198, v214
  v_mov_b32 v199, v215
  ds_read_b128 a[208:211], v198 offset:0
  ds_read_b128 a[212:215], v199 offset:0
  ds_read_b128 a[216:219], v198 offset:128
  ds_read_b128 a[220:223], v199 offset:128
  s_waitcnt vmcnt(5)
  s_nop 1
  v_cvt_pk_bf16_f32 v0, v0, v1
  v_cvt_pk_bf16_f32 v1, v2, v3
  v_cvt_pk_bf16_f32 v2, v4, v5
  v_cvt_pk_bf16_f32 v3, v6, v7
  v_cvt_pk_bf16_f32 v4, v8, v9
  v_cvt_pk_bf16_f32 v5, v10, v11
  v_cvt_pk_bf16_f32 v6, v12, v13
  v_cvt_pk_bf16_f32 v7, v14, v15
  v_cvt_pk_bf16_f32 v8, v16, v17
  v_cvt_pk_bf16_f32 v9, v18, v19
  v_cvt_pk_bf16_f32 v10, v20, v21
  v_cvt_pk_bf16_f32 v11, v22, v23
  v_cvt_pk_bf16_f32 v12, v24, v25
  v_cvt_pk_bf16_f32 v13, v26, v27
  v_cvt_pk_bf16_f32 v14, v28, v29
  v_cvt_pk_bf16_f32 v15, v30, v31
  v_cvt_pk_bf16_f32 v16, v32, v33
  v_cvt_pk_bf16_f32 v17, v34, v35
  v_cvt_pk_bf16_f32 v18, v36, v37
  v_cvt_pk_bf16_f32 v19, v38, v39
  v_cvt_pk_bf16_f32 v20, v40, v41
  v_cvt_pk_bf16_f32 v21, v42, v43
  v_cvt_pk_bf16_f32 v22, v44, v45
  v_cvt_pk_bf16_f32 v23, v46, v47
  v_cvt_pk_bf16_f32 v24, v48, v49
  v_cvt_pk_bf16_f32 v25, v50, v51
  v_cvt_pk_bf16_f32 v26, v52, v53
  v_cvt_pk_bf16_f32 v27, v54, v55
  v_cvt_pk_bf16_f32 v28, v56, v57
  v_cvt_pk_bf16_f32 v29, v58, v59
  v_cvt_pk_bf16_f32 v30, v60, v61
  v_cvt_pk_bf16_f32 v31, v62, v63
  v_cvt_pk_bf16_f32 v32, v64, v65
  v_cvt_pk_bf16_f32 v33, v66, v67
  v_cvt_pk_bf16_f32 v34, v68, v69
  v_cvt_pk_bf16_f32 v35, v70, v71
  v_cvt_pk_bf16_f32 v36, v72, v73
  v_cvt_pk_bf16_f32 v37, v74, v75
  v_cvt_pk_bf16_f32 v38, v76, v77
  v_cvt_pk_bf16_f32 v39, v78, v79
  v_cvt_pk_bf16_f32 v40, v80, v81
  v_cvt_pk_bf16_f32 v41, v82, v83
  v_cvt_pk_bf16_f32 v42, v84, v85
  v_cvt_pk_bf16_f32 v43, v86, v87
  v_cvt_pk_bf16_f32 v44, v88, v89
  v_cvt_pk_bf16_f32 v45, v90, v91
  v_cvt_pk_bf16_f32 v46, v92, v93
  v_cvt_pk_bf16_f32 v47, v94, v95
  v_cvt_pk_bf16_f32 v48, v96, v97
  v_cvt_pk_bf16_f32 v49, v98, v99
  v_cvt_pk_bf16_f32 v50, v100, v101
  v_cvt_pk_bf16_f32 v51, v102, v103
  v_cvt_pk_bf16_f32 v52, v104, v105
  v_cvt_pk_bf16_f32 v53, v106, v107
  v_cvt_pk_bf16_f32 v54, v108, v109
  v_cvt_pk_bf16_f32 v55, v110, v111
  v_cvt_pk_bf16_f32 v56, v112, v113
  v_cvt_pk_bf16_f32 v57, v114, v115
  v_cvt_pk_bf16_f32 v58, v116, v117
  v_cvt_pk_bf16_f32 v59, v118, v119
  v_cvt_pk_bf16_f32 v60, v120, v121
  v_cvt_pk_bf16_f32 v61, v122, v123
  v_cvt_pk_bf16_f32 v62, v124, v125
  v_cvt_pk_bf16_f32 v63, v126, v127
  v_cvt_pk_bf16_f32 v64, v128, v129
  v_cvt_pk_bf16_f32 v65, v130, v131
  v_cvt_pk_bf16_f32 v66, v132, v133
  v_cvt_pk_bf16_f32 v67, v134, v135
  v_cvt_pk_bf16_f32 v68, v136, v137
  v_cvt_pk_bf16_f32 v69, v138, v139
  v_cvt_pk_bf16_f32 v70, v140, v141
  v_cvt_pk_bf16_f32 v71, v142, v143
  v_cvt_pk_bf16_f32 v72, v144, v145
  v_cvt_pk_bf16_f32 v73, v146, v147
  v_cvt_pk_bf16_f32 v74, v148, v149
  v_cvt_pk_bf16_f32 v75, v150, v151
  v_cvt_pk_bf16_f32 v76, v152, v153
  v_cvt_pk_bf16_f32 v77, v154, v155
  v_cvt_pk_bf16_f32 v78, v156, v157
  v_cvt_pk_bf16_f32 v79, v158, v159
  v_cvt_pk_bf16_f32 v80, v160, v161
  v_cvt_pk_bf16_f32 v81, v162, v163
  v_cvt_pk_bf16_f32 v82, v164, v165
  v_cvt_pk_bf16_f32 v83, v166, v167
  v_cvt_pk_bf16_f32 v84, v168, v169
  v_cvt_pk_bf16_f32 v85, v170, v171
  v_cvt_pk_bf16_f32 v86, v172, v173
  v_cvt_pk_bf16_f32 v87, v174, v175
  v_cvt_pk_bf16_f32 v88, v176, v177
  v_cvt_pk_bf16_f32 v89, v178, v179
  v_cvt_pk_bf16_f32 v90, v180, v181
  v_cvt_pk_bf16_f32 v91, v182, v183
  v_cvt_pk_bf16_f32 v92, v184, v185
  v_cvt_pk_bf16_f32 v93, v186, v187
  v_cvt_pk_bf16_f32 v94, v188, v189
  v_cvt_pk_bf16_f32 v95, v190, v191
  s_mov_b32 m0, s31
  s_waitcnt lgkmcnt(3)
  v_mfma_f32_16x16x32_bf16 v[96:99], a[208:211], v[0:3], 0
  ds_read_b128 a[192:195], v198 offset:256
  v_accvgpr_write_b32 a0, 0
  v_mfma_f32_16x16x32_bf16 v[100:103], a[208:211], v[24:27], 0
  buffer_load_dwordx4 v192, s[4:7], s28 offen lds
  v_mfma_f32_16x16x32_bf16 v[104:107], a[208:211], v[48:51], 0
  v_accvgpr_write_b32 a1, 0
  v_accvgpr_write_b32 a2, 0
  v_mfma_f32_16x16x32_bf16 v[108:111], a[208:211], v[72:75], 0
  s_waitcnt lgkmcnt(3)
  v_accvgpr_write_b32 a3, 0
  v_accvgpr_write_b32 a4, 0
  v_mfma_f32_16x16x32_bf16 v[96:99], a[212:215], v[4:7], v[96:99]
  ds_read_b128 a[196:199], v199 offset:256
  v_accvgpr_write_b32 a5, 0
  v_mfma_f32_16x16x32_bf16 v[100:103], a[212:215], v[28:31], v[100:103]
  buffer_load_dwordx4 v193, s[4:7], s28 offen offset:1024 lds
  v_mfma_f32_16x16x32_bf16 v[104:107], a[212:215], v[52:55], v[104:107]
  v_accvgpr_write_b32 a6, 0
  v_accvgpr_write_b32 a7, 0
  v_mfma_f32_16x16x32_bf16 v[108:111], a[212:215], v[76:79], v[108:111]
  s_waitcnt lgkmcnt(3)
  v_accvgpr_write_b32 a8, 0
  v_accvgpr_write_b32 a9, 0
  v_mfma_f32_16x16x32_bf16 v[96:99], a[216:219], v[8:11], v[96:99]
  ds_read_b128 a[200:203], v198 offset:6144
  v_accvgpr_write_b32 a10, 0
  v_mfma_f32_16x16x32_bf16 v[100:103], a[216:219], v[32:35], v[100:103]
  buffer_load_dwordx4 v194, s[4:7], s28 offen offset:2048 lds
  v_mfma_f32_16x16x32_bf16 v[104:107], a[216:219], v[56:59], v[104:107]
  s_add_u32 m0, s31, 12288
  v_accvgpr_write_b32 a11, 0
  v_accvgpr_write_b32 a12, 0
  v_mfma_f32_16x16x32_bf16 v[108:111], a[216:219], v[80:83], v[108:111]
  s_waitcnt lgkmcnt(3)
  v_accvgpr_write_b32 a13, 0
  v_accvgpr_write_b32 a14, 0
  v_mfma_f32_16x16x32_bf16 v[96:99], a[220:223], v[12:15], v[96:99]
  s_add_u32 s28, s28, s30
  ds_read_b128 a[204:207], v199 offset:6144
  v_accvgpr_write_b32 a15, 0
  v_mfma_f32_16x16x32_bf16 v[100:103], a[220:223], v[36:39], v[100:103]
  buffer_load_dwordx4 v195, s[8:11], s29 offen lds
  v_mfma_f32_16x16x32_bf16 v[104:107], a[220:223], v[60:63], v[104:107]
  s_add_u32 s34, s34, 1
  v_accvgpr_write_b32 a16, 0
  v_accvgpr_write_b32 a17, 0
  v_mfma_f32_16x16x32_bf16 v[108:111], a[220:223], v[84:87], v[108:111]
  s_waitcnt lgkmcnt(3)
  s_cmp_eq_u32 s34, 6
  v_accvgpr_write_b32 a18, 0
  v_mfma_f32_16x16x32_bf16 v[96:99], a[192:195], v[16:19], v[96:99]
  s_cselect_b32 s33, s42, s43
  ds_read_b128 a[208:211], v198 offset:6272
  v_accvgpr_write_b32 a19, 0
  v_mfma_f32_16x16x32_bf16 v[100:103], a[192:195], v[40:43], v[100:103]
  buffer_load_dwordx4 v196, s[8:11], s29 offen offset:1024 lds
  v_mfma_f32_16x16x32_bf16 v[104:107], a[192:195], v[64:67], v[104:107]
  s_cselect_b32 s34, 0, s34
  v_accvgpr_write_b32 a20, 0
  v_accvgpr_write_b32 a21, 0
  v_mfma_f32_16x16x32_bf16 v[108:111], a[192:195], v[88:91], v[108:111]
  s_waitcnt lgkmcnt(3)
  v_accvgpr_write_b32 a22, 0
  v_accvgpr_write_b32 a23, 0
  v_mfma_f32_16x16x32_bf16 v[96:99], a[196:199], v[20:23], v[96:99]
  ds_read_b128 a[212:215], v199 offset:6272
  v_accvgpr_write_b32 a24, 0
  v_mfma_f32_16x16x32_bf16 v[100:103], a[196:199], v[44:47], v[100:103]
  buffer_load_dwordx4 v197, s[8:11], s29 offen offset:2048 lds
  v_mfma_f32_16x16x32_bf16 v[104:107], a[196:199], v[68:71], v[104:107]
  s_add_u32 s29, s29, s30
  v_accvgpr_write_b32 a25, 0
  v_accvgpr_write_b32 a26, 0
  v_mfma_f32_16x16x32_bf16 v[108:111], a[196:199], v[92:95], v[108:111]
  s_waitcnt lgkmcnt(3)
  s_add_u32 s32, s32, 1
  v_accvgpr_write_b32 a27, 0
  v_mfma_f32_16x16x32_bf16 v[112:115], a[200:203], v[0:3], 0
  s_cmp_eq_u32 s32, 6
  ds_read_b128 a[216:219], v198 offset:6400
  v_accvgpr_write_b32 a28, 0
  v_mfma_f32_16x16x32_bf16 v[116:119], a[200:203], v[24:27], 0
  s_cselect_b32 s40, s42, s43
  v_accvgpr_write_b32 a29, 0
  v_accvgpr_write_b32 a30, 0
  v_mfma_f32_16x16x32_bf16 v[120:123], a[200:203], v[48:51], 0
  s_cselect_b32 s32, 0, s32
  v_accvgpr_write_b32 a31, 0
  v_accvgpr_write_b32 a32, 0
  v_mfma_f32_16x16x32_bf16 v[124:127], a[200:203], v[72:75], 0
  s_waitcnt lgkmcnt(3)
  s_add_u32 s31, s31, s40
  v_accvgpr_write_b32 a33, 0
  v_mfma_f32_16x16x32_bf16 v[112:115], a[204:207], v[4:7], v[112:115]
  s_mov_b32 m0, s31
  ds_read_b128 a[220:223], v199 offset:6400
  v_accvgpr_write_b32 a34, 0
  v_mfma_f32_16x16x32_bf16 v[116:119], a[204:207], v[28:31], v[116:119]
  v_accvgpr_write_b32 a35, 0
  v_accvgpr_write_b32 a36, 0
  v_mfma_f32_16x16x32_bf16 v[120:123], a[204:207], v[52:55], v[120:123]
  v_add_u32 v198, s33, v198
  v_add_u32 v199, s33, v199
  v_mfma_f32_16x16x32_bf16 v[124:127], a[204:207], v[76:79], v[124:127]
  s_waitcnt lgkmcnt(3)
  v_accvgpr_write_b32 a37, 0
  v_accvgpr_write_b32 a38, 0
  v_mfma_f32_16x16x32_bf16 v[112:115], a[208:211], v[8:11], v[112:115]
  s_waitcnt vmcnt(9)
  v_accvgpr_write_b32 a39, 0
  v_accvgpr_write_b32 a40, 0
  v_mfma_f32_16x16x32_bf16 v[116:119], a[208:211], v[32:35], v[116:119]
  s_barrier
  v_accvgpr_write_b32 a41, 0
  v_accvgpr_write_b32 a42, 0
  v_mfma_f32_16x16x32_bf16 v[120:123], a[208:211], v[56:59], v[120:123]
  ds_read_b128 a[192:195], v198 offset:0
  v_accvgpr_write_b32 a43, 0
  v_mfma_f32_16x16x32_bf16 v[124:127], a[208:211], v[80:83], v[124:127]
  s_waitcnt lgkmcnt(3)
  ds_read_b128 a[196:199], v199 offset:0
  v_accvgpr_write_b32 a44, 0
  v_mfma_f32_16x16x32_bf16 v[112:115], a[212:215], v[12:15], v[112:115]
  ds_read_b128 a[200:203], v198 offset:128
  v_accvgpr_write_b32 a45, 0
  v_mfma_f32_16x16x32_bf16 v[116:119], a[212:215], v[36:39], v[116:119]
  ds_read_b128 a[204:207], v199 offset:128
  v_accvgpr_write_b32 a46, 0
  v_mfma_f32_16x16x32_bf16 v[120:123], a[212:215], v[60:63], v[120:123]
  v_accvgpr_write_b32 a47, 0
  v_accvgpr_write_b32 a48, 0
  v_mfma_f32_16x16x32_bf16 v[124:127], a[212:215], v[84:87], v[124:127]
  s_waitcnt lgkmcnt(5)
  v_accvgpr_write_b32 a49, 0
  v_accvgpr_write_b32 a50, 0
  v_mfma_f32_16x16x32_bf16 v[112:115], a[216:219], v[16:19], v[112:115]
  v_accvgpr_write_b32 a51, 0
  v_accvgpr_write_b32 a52, 0
  v_mfma_f32_16x16x32_bf16 v[116:119], a[216:219], v[40:43], v[116:119]
  v_accvgpr_write_b32 a53, 0
  v_accvgpr_write_b32 a54, 0
  v_mfma_f32_16x16x32_bf16 v[120:123], a[216:219], v[64:67], v[120:123]
  v_accvgpr_write_b32 a55, 0
  v_accvgpr_write_b32 a56, 0
  v_mfma_f32_16x16x32_bf16 v[124:127], a[216:219], v[88:91], v[124:127]
  s_waitcnt lgkmcnt(4)
  v_accvgpr_write_b32 a57, 0
  v_accvgpr_write_b32 a58, 0
  v_mfma_f32_16x16x32_bf16 v[112:115], a[220:223], v[20:23], v[112:115]
  v_accvgpr_write_b32 a59, 0
  v_accvgpr_write_b32 a60, 0
  v_mfma_f32_16x16x32_bf16 v[116:119], a[220:223], v[44:47], v[116:119]
  v_accvgpr_write_b32 a61, 0
  v_accvgpr_write_b32 a62, 0
  v_mfma_f32_16x16x32_bf16 v[120:123], a[220:223], v[68:71], v[120:123]
  v_accvgpr_write_b32 a63, 0
  v_mfma_f32_16x16x32_bf16 v[124:127], a[220:223], v[92:95], v[124:127]
  s_nop 7
  v_max3_f32 v180, v96, v97, v98
  v_max3_f32 v180, v180, v99, v112
  v_max3_f32 v180, v180, v113, v114
  v_max_f32 v180, v180, v115
  v_max3_f32 v181, v100, v101, v102
  v_max3_f32 v181, v181, v103, v116
  v_max3_f32 v181, v181, v117, v118
  v_max_f32 v181, v181, v119
  v_max3_f32 v182, v104, v105, v106
  v_max3_f32 v182, v182, v107, v120
  v_max3_f32 v182, v182, v121, v122
  v_max_f32 v182, v182, v123
  v_max3_f32 v183, v108, v109, v110
  v_max3_f32 v183, v183, v111, v124
  v_max3_f32 v183, v183, v125, v126
  v_max_f32 v183, v183, v127
  v_mov_b32 v184, v180
  v_mov_b32 v185, v181
  v_mov_b32 v186, v182
  v_mov_b32 v187, v183
  v_permlane32_swap_b32 v184, v180
  v_permlane32_swap_b32 v185, v181
  v_permlane32_swap_b32 v186, v182
  v_permlane32_swap_b32 v187, v183
  v_max_f32 v180, v184, v180
  v_max_f32 v181, v185, v181
  v_max_f32 v182, v186, v182
  v_max_f32 v183, v187, v183
  v_mov_b32 v184, v180
  v_mov_b32 v185, v181
  v_mov_b32 v186, v182
  v_mov_b32 v187, v183
  v_permlane16_swap_b32 v184, v180
  v_permlane16_swap_b32 v185, v181
  v_permlane16_swap_b32 v186, v182
  v_permlane16_swap_b32 v187, v183
  v_max_f32 v180, v184, v180
  v_max_f32 v181, v185, v181
  v_max_f32 v182, v186, v182
  v_max_f32 v183, v187, v183
  s_mov_b32 s40, 0xc2200000
  v_sub_f32 v160, s40, v180
  v_sub_f32 v164, s40, v181
  v_sub_f32 v168, s40, v182
  v_sub_f32 v172, s40, v183
  v_mov_b32 v161, v160
  v_mov_b32 v165, v164
  v_mov_b32 v169, v168
  v_mov_b32 v173, v172
  v_mov_b64 v[162:163], v[160:161]
  v_mov_b64 v[166:167], v[164:165]
  v_mov_b64 v[170:171], v[168:169]
  v_mov_b64 v[174:175], v[172:173]
  v_mov_b64 v[176:177], 0
  v_mov_b64 v[178:179], 0
  v_pk_add_f32 v[96:97], v[96:97], v[160:161]
  v_pk_add_f32 v[98:99], v[98:99], v[160:161]
  v_pk_add_f32 v[100:101], v[100:101], v[164:165]
  v_pk_add_f32 v[102:103], v[102:103], v[164:165]
  v_pk_add_f32 v[104:105], v[104:105], v[168:169]
  v_pk_add_f32 v[106:107], v[106:107], v[168:169]
  v_pk_add_f32 v[108:109], v[108:109], v[172:173]
  v_pk_add_f32 v[110:111], v[110:111], v[172:173]
  v_pk_add_f32 v[112:113], v[112:113], v[160:161]
  v_pk_add_f32 v[114:115], v[114:115], v[160:161]
  v_pk_add_f32 v[116:117], v[116:117], v[164:165]
  v_pk_add_f32 v[118:119], v[118:119], v[164:165]
  v_pk_add_f32 v[120:121], v[120:121], v[168:169]
  v_pk_add_f32 v[122:123], v[122:123], v[168:169]
  v_pk_add_f32 v[124:125], v[124:125], v[172:173]
  v_pk_add_f32 v[126:127], v[126:127], v[172:173]
  v_exp_f32 v96, v96
  v_exp_f32 v97, v97
  v_exp_f32 v98, v98
  v_exp_f32 v99, v99
  v_exp_f32 v100, v100
  v_exp_f32 v101, v101
  v_exp_f32 v102, v102
  v_exp_f32 v103, v103
  v_exp_f32 v104, v104
  v_exp_f32 v105, v105
  v_exp_f32 v106, v106
  v_exp_f32 v107, v107
  v_exp_f32 v108, v108
  v_exp_f32 v109, v109
  v_exp_f32 v110, v110
  v_exp_f32 v111, v111
  v_exp_f32 v112, v112
  v_exp_f32 v113, v113
  v_exp_f32 v114, v114
  v_exp_f32 v115, v115
  v_exp_f32 v116, v116
  v_exp_f32 v117, v117
  v_exp_f32 v118, v118
  v_exp_f32 v119, v119
  v_exp_f32 v120, v120
  v_exp_f32 v121, v121
  v_exp_f32 v122, v122
  v_exp_f32 v123, v123
  v_exp_f32 v124, v124
  v_exp_f32 v125, v125
  v_exp_f32 v126, v126
  v_exp_f32 v127, v127
  s_nop 0
  v_add_f32 v176, v96, v176
  v_add_f32 v176, v97, v176
  v_cvt_pk_bf16_f32 v128, v96, v97
  v_add_f32 v176, v98, v176
  v_add_f32 v176, v99, v176
  v_cvt_pk_bf16_f32 v129, v98, v99
  v_add_f32 v177, v100, v177
  v_add_f32 v177, v101, v177
  v_cvt_pk_bf16_f32 v132, v100, v101
  v_add_f32 v177, v102, v177
  v_add_f32 v177, v103, v177
  v_cvt_pk_bf16_f32 v133, v102, v103
  v_add_f32 v178, v104, v178
  v_add_f32 v178, v105, v178
  v_cvt_pk_bf16_f32 v136, v104, v105
  v_add_f32 v178, v106, v178
  v_add_f32 v178, v107, v178
  v_cvt_pk_bf16_f32 v137, v106, v107
  v_add_f32 v179, v108, v179
  v_add_f32 v179, v109, v179
  v_cvt_pk_bf16_f32 v140, v108, v109
  v_add_f32 v179, v110, v179
  v_add_f32 v179, v111, v179
  v_cvt_pk_bf16_f32 v141, v110, v111
  s_waitcnt lgkmcnt(3)
  s_mov_b32 s35, 7
adaLN_cond__sliding_block_cached__glu_gated_swiglu__prompt_kernel_c_att:
  v_mfma_f32_16x16x32_bf16 v[96:99], a[192:195], v[0:3], v[160:163]
  ds_read_b128 a[208:211], v198 offset:256
  v_add_f32 v176, v112, v176
  v_mfma_f32_16x16x32_bf16 v[100:103], a[192:195], v[24:27], v[164:167]
  buffer_load_dwordx4 v192, s[4:7], s28 offen lds
  v_mfma_f32_16x16x32_bf16 v[104:107], a[192:195], v[48:51], v[168:171]
  v_add_f32 v176, v113, v176
  v_cvt_pk_bf16_f32 v130, v112, v113
  v_mfma_f32_16x16x32_bf16 v[108:111], a[192:195], v[72:75], v[172:175]
  s_waitcnt lgkmcnt(3)
  v_add_f32 v176, v114, v176
  v_add_f32 v176, v115, v176
  v_mfma_f32_16x16x32_bf16 v[96:99], a[196:199], v[4:7], v[96:99]
  ds_read_b128 a[212:215], v199 offset:256
  v_cvt_pk_bf16_f32 v131, v114, v115
  v_mfma_f32_16x16x32_bf16 v[100:103], a[196:199], v[28:31], v[100:103]
  v_add_f32 v177, v116, v177
  v_add_f32 v177, v117, v177
  v_mfma_f32_16x16x32_bf16 v[104:107], a[196:199], v[52:55], v[104:107]
  v_cvt_pk_bf16_f32 v134, v116, v117
  v_add_f32 v177, v118, v177
  v_mfma_f32_16x16x32_bf16 v[108:111], a[196:199], v[76:79], v[108:111]
  s_waitcnt lgkmcnt(3)
  v_add_f32 v177, v119, v177
  v_cvt_pk_bf16_f32 v135, v118, v119
  v_mfma_f32_16x16x32_bf16 v[96:99], a[200:203], v[8:11], v[96:99]
  ds_read_b128 a[216:219], v198 offset:6144
  v_add_f32 v178, v120, v178
  v_mfma_f32_16x16x32_bf16 v[100:103], a[200:203], v[32:35], v[100:103]
  buffer_load_dwordx4 v193, s[4:7], s28 offen offset:1024 lds
  v_mfma_f32_16x16x32_bf16 v[104:107], a[200:203], v[56:59], v[104:107]
  v_add_f32 v178, v121, v178
  v_cvt_pk_bf16_f32 v138, v120, v121
  v_mfma_f32_16x16x32_bf16 v[108:111], a[200:203], v[80:83], v[108:111]
  s_waitcnt lgkmcnt(3)
  v_add_f32 v178, v122, v178
  v_add_f32 v178, v123, v178
  v_mfma_f32_16x16x32_bf16 v[96:99], a[204:207], v[12:15], v[96:99]
  ds_read_b128 a[220:223], v199 offset:6144
  v_cvt_pk_bf16_f32 v139, v122, v123
  v_mfma_f32_16x16x32_bf16 v[100:103], a[204:207], v[36:39], v[100:103]
  v_add_f32 v179, v124, v179
  v_add_f32 v179, v125, v179
  v_mfma_f32_16x16x32_bf16 v[104:107], a[204:207], v[60:63], v[104:107]
  v_cvt_pk_bf16_f32 v142, v124, v125
  v_add_f32 v179, v126, v179
  v_mfma_f32_16x16x32_bf16 v[108:111], a[204:207], v[84:87], v[108:111]
  s_waitcnt lgkmcnt(3)
  v_add_f32 v179, v127, v179
  v_cvt_pk_bf16_f32 v143, v126, v127
  v_mfma_f32_16x16x32_bf16 v[96:99], a[208:211], v[16:19], v[96:99]
  ds_read_b128 a[192:195], v198 offset:6272
  v_mfma_f32_16x16x32_bf16 v[100:103], a[208:211], v[40:43], v[100:103]
  buffer_load_dwordx4 v194, s[4:7], s28 offen offset:2048 lds
  v_mfma_f32_16x16x32_bf16 v[104:107], a[208:211], v[64:67], v[104:107]
  s_add_u32 m0, s31, 12288
  v_mfma_f32_16x16x32_bf16 v[108:111], a[208:211], v[88:91], v[108:111]
  s_waitcnt lgkmcnt(3)
  v_mfma_f32_16x16x32_bf16 v[96:99], a[212:215], v[20:23], v[96:99]
  ds_read_b128 a[196:199], v199 offset:6272
  v_mfma_f32_16x16x32_bf16 v[100:103], a[212:215], v[44:47], v[100:103]
  v_mfma_f32_16x16x32_bf16 v[104:107], a[212:215], v[68:71], v[104:107]
  v_mfma_f32_16x16x32_bf16 v[108:111], a[212:215], v[92:95], v[108:111]
  s_waitcnt lgkmcnt(3)
  v_mfma_f32_16x16x32_bf16 v[112:115], a[216:219], v[0:3], v[160:163]
  ds_read_b128 a[200:203], v198 offset:6400
  v_mfma_f32_16x16x32_bf16 v[116:119], a[216:219], v[24:27], v[164:167]
  buffer_load_dwordx4 v195, s[8:11], s29 offen lds
  v_mfma_f32_16x16x32_bf16 v[120:123], a[216:219], v[48:51], v[168:171]
  v_mfma_f32_16x16x32_bf16 v[124:127], a[216:219], v[72:75], v[172:175]
  s_waitcnt lgkmcnt(3)
  v_mfma_f32_16x16x32_bf16 v[112:115], a[220:223], v[4:7], v[112:115]
  s_add_u32 s28, s28, s30
  ds_read_b128 a[204:207], v199 offset:6400
  v_mfma_f32_16x16x32_bf16 v[116:119], a[220:223], v[28:31], v[116:119]
  s_add_u32 s34, s34, 1
  v_exp_f32 v96, v96
  v_mfma_f32_16x16x32_bf16 v[120:123], a[220:223], v[52:55], v[120:123]
  s_cmp_eq_u32 s34, 6
  v_exp_f32 v97, v97
  v_mfma_f32_16x16x32_bf16 v[124:127], a[220:223], v[76:79], v[124:127]
  s_waitcnt lgkmcnt(3)
  s_cselect_b32 s33, s42, s43
  v_mfma_f32_16x16x32_bf16 v[112:115], a[192:195], v[8:11], v[112:115]
  s_cselect_b32 s34, 0, s34
  ds_read_b64_tr_b16 a[224:225], v200 offset:12288
  v_add_f32 v176, v96, v176
  v_mfma_f32_16x16x32_bf16 v[116:119], a[192:195], v[32:35], v[116:119]
  buffer_load_dwordx4 v196, s[8:11], s29 offen offset:1024 lds
  v_mfma_f32_16x16x32_bf16 v[120:123], a[192:195], v[56:59], v[120:123]
  ds_read_b64_tr_b16 a[226:227], v200 offset:18432
  v_add_f32 v176, v97, v176
  v_mfma_f32_16x16x32_bf16 v[124:127], a[192:195], v[80:83], v[124:127]
  s_waitcnt lgkmcnt(4)
  v_exp_f32 v98, v98
  v_mfma_f32_16x16x32_bf16 v[112:115], a[196:199], v[12:15], v[112:115]
  ds_read_b64_tr_b16 a[228:229], v201 offset:12288
  v_cvt_pk_bf16_f32 v144, v96, v97
  v_mfma_f32_16x16x32_bf16 v[116:119], a[196:199], v[36:39], v[116:119]
  v_exp_f32 v99, v99
  v_mfma_f32_16x16x32_bf16 v[120:123], a[196:199], v[60:63], v[120:123]
  ds_read_b64_tr_b16 a[230:231], v201 offset:18432
  v_add_f32 v176, v98, v176
  v_mfma_f32_16x16x32_bf16 v[124:127], a[196:199], v[84:87], v[124:127]
  s_waitcnt lgkmcnt(5)
  v_exp_f32 v100, v100
  v_mfma_f32_16x16x32_bf16 v[112:115], a[200:203], v[16:19], v[112:115]
  ds_read_b64_tr_b16 a[232:233], v202 offset:12288
  v_add_f32 v176, v99, v176
  v_mfma_f32_16x16x32_bf16 v[116:119], a[200:203], v[40:43], v[116:119]
  buffer_load_dwordx4 v197, s[8:11], s29 offen offset:2048 lds
  v_mfma_f32_16x16x32_bf16 v[120:123], a[200:203], v[64:67], v[120:123]
  ds_read_b64_tr_b16 a[234:235], v202 offset:18432
  v_cvt_pk_bf16_f32 v145, v98, v99
  v_mfma_f32_16x16x32_bf16 v[124:127], a[200:203], v[88:91], v[124:127]
  s_waitcnt lgkmcnt(6)
  v_exp_f32 v101, v101
  v_mfma_f32_16x16x32_bf16 v[112:115], a[204:207], v[20:23], v[112:115]
  ds_read_b64_tr_b16 a[236:237], v203 offset:12288
  v_add_f32 v177, v100, v177
  v_mfma_f32_16x16x32_bf16 v[116:119], a[204:207], v[44:47], v[116:119]
  v_exp_f32 v102, v102
  v_mfma_f32_16x16x32_bf16 v[120:123], a[204:207], v[68:71], v[120:123]
  s_mov_b32 m0, s91
  ds_read_b64_tr_b16 a[238:239], v203 offset:18432
  v_add_f32 v177, v101, v177
  v_mfma_f32_16x16x32_bf16 v[124:127], a[204:207], v[92:95], v[124:127]
  s_waitcnt lgkmcnt(6)
  v_exp_f32 v103, v103
  v_mfma_f32_16x16x32_bf16 a[0:3], a[224:227], v[128:131], a[0:3]
  ds_read_b64_tr_b16 a[240:241], v200 offset:12416
  v_add_u32 v198, s33, v198
  v_mfma_f32_16x16x32_bf16 a[4:7], a[224:227], v[132:135], a[4:7]
  buffer_load_dwordx4 v216, s[84:87], s89 offen lds
  v_mfma_f32_16x16x32_bf16 a[8:11], a[224:227], v[136:139], a[8:11]
  s_add_u32 s29, s29, s30
  ds_read_b64_tr_b16 a[242:243], v200 offset:18560
  v_add_u32 v199, s33, v199
  v_mfma_f32_16x16x32_bf16 a[12:15], a[224:227], v[140:143], a[12:15]
  s_waitcnt lgkmcnt(6)
  s_add_u32 s32, s32, 1
  v_mfma_f32_16x16x32_bf16 a[16:19], a[228:231], v[128:131], a[16:19]
  s_cmp_eq_u32 s32, 6
  ds_read_b64_tr_b16 a[244:245], v201 offset:12416
  v_cvt_pk_bf16_f32 v148, v100, v101
  v_mfma_f32_16x16x32_bf16 a[20:23], a[228:231], v[132:135], a[20:23]
  s_cselect_b32 s40, s42, s43
  v_exp_f32 v104, v104
  v_mfma_f32_16x16x32_bf16 a[24:27], a[228:231], v[136:139], a[24:27]
  s_cselect_b32 s32, 0, s32
  ds_read_b64_tr_b16 a[246:247], v201 offset:18560
  v_add_f32 v177, v102, v177
  v_mfma_f32_16x16x32_bf16 a[28:31], a[228:231], v[140:143], a[28:31]
  s_waitcnt lgkmcnt(6)
  s_add_u32 s31, s31, s40
  v_mfma_f32_16x16x32_bf16 a[32:35], a[232:235], v[128:131], a[32:35]
  s_add_u32 s89, s89, 1024
  ds_read_b64_tr_b16 a[248:249], v202 offset:12416
  v_add_f32 v177, v103, v177
  v_mfma_f32_16x16x32_bf16 a[36:39], a[232:235], v[132:135], a[36:39]
  v_exp_f32 v105, v105
  v_mfma_f32_16x16x32_bf16 a[40:43], a[232:235], v[136:139], a[40:43]
  ds_read_b64_tr_b16 a[250:251], v202 offset:18560
  v_cvt_pk_bf16_f32 v149, v102, v103
  v_mfma_f32_16x16x32_bf16 a[44:47], a[232:235], v[140:143], a[44:47]
  s_waitcnt lgkmcnt(6)
  v_exp_f32 v106, v106
  v_mfma_f32_16x16x32_bf16 a[48:51], a[236:239], v[128:131], a[48:51]
  ds_read_b64_tr_b16 a[252:253], v203 offset:12416
  v_add_f32 v178, v104, v178
  v_mfma_f32_16x16x32_bf16 a[52:55], a[236:239], v[132:135], a[52:55]
  v_exp_f32 v107, v107
  v_mfma_f32_16x16x32_bf16 a[56:59], a[236:239], v[136:139], a[56:59]
  ds_read_b64_tr_b16 a[254:255], v203 offset:18560
  v_add_f32 v178, v105, v178
  v_mfma_f32_16x16x32_bf16 a[60:63], a[236:239], v[140:143], a[60:63]
  s_waitcnt lgkmcnt(6)
  v_exp_f32 v108, v108
  v_mfma_f32_16x16x32_bf16 a[64:67], a[240:243], v[128:131], a[64:67]
  ds_read_b64_tr_b16 a[224:225], v200 offset:12544
  v_cvt_pk_bf16_f32 v152, v104, v105
  v_mfma_f32_16x16x32_bf16 a[68:71], a[240:243], v[132:135], a[68:71]
  v_exp_f32 v109, v109
  v_mfma_f32_16x16x32_bf16 a[72:75], a[240:243], v[136:139], a[72:75]
  ds_read_b64_tr_b16 a[226:227], v200 offset:18688
  v_add_u32 v200, s33, v200
  v_mfma_f32_16x16x32_bf16 a[76:79], a[240:243], v[140:143], a[76:79]
  s_waitcnt lgkmcnt(6)
  v_exp_f32 v110, v110
  v_mfma_f32_16x16x32_bf16 a[80:83], a[244:247], v[128:131], a[80:83]
  ds_read_b64_tr_b16 a[228:229], v201 offset:12544
  v_add_f32 v178, v106, v178
  v_mfma_f32_16x16x32_bf16 a[84:87], a[244:247], v[132:135], a[84:87]
  v_exp_f32 v111, v111
  v_mfma_f32_16x16x32_bf16 a[88:91], a[244:247], v[136:139], a[88:91]
  ds_read_b64_tr_b16 a[230:231], v201 offset:18688
  v_add_u32 v201, s33, v201
  v_mfma_f32_16x16x32_bf16 a[92:95], a[244:247], v[140:143], a[92:95]
  s_waitcnt lgkmcnt(6)
  v_exp_f32 v112, v112
  v_mfma_f32_16x16x32_bf16 a[96:99], a[248:251], v[128:131], a[96:99]
  ds_read_b64_tr_b16 a[232:233], v202 offset:12544
  v_add_f32 v178, v107, v178
  v_mfma_f32_16x16x32_bf16 a[100:103], a[248:251], v[132:135], a[100:103]
  v_exp_f32 v113, v113
  v_mfma_f32_16x16x32_bf16 a[104:107], a[248:251], v[136:139], a[104:107]
  ds_read_b64_tr_b16 a[234:235], v202 offset:18688
  v_add_u32 v202, s33, v202
  v_mfma_f32_16x16x32_bf16 a[108:111], a[248:251], v[140:143], a[108:111]
  s_waitcnt lgkmcnt(6)
  v_exp_f32 v114, v114
  v_mfma_f32_16x16x32_bf16 a[112:115], a[252:255], v[128:131], a[112:115]
  s_waitcnt vmcnt(21)
  ds_read_b64_tr_b16 a[236:237], v203 offset:12544
  v_cvt_pk_bf16_f32 v153, v106, v107
  v_mfma_f32_16x16x32_bf16 a[116:119], a[252:255], v[132:135], a[116:119]
  v_exp_f32 v115, v115
  v_mfma_f32_16x16x32_bf16 a[120:123], a[252:255], v[136:139], a[120:123]
  s_barrier
  ds_read_b64_tr_b16 a[238:239], v203 offset:18688
  v_add_u32 v203, s33, v203
  v_mfma_f32_16x16x32_bf16 a[124:127], a[252:255], v[140:143], a[124:127]
  s_waitcnt lgkmcnt(6)
  v_exp_f32 v116, v116
  v_mfma_f32_16x16x32_bf16 a[128:131], a[224:227], v[128:131], a[128:131]
  ds_read_b128 a[208:211], v198 offset:0
  v_add_f32 v179, v108, v179
  v_mfma_f32_16x16x32_bf16 a[132:135], a[224:227], v[132:135], a[132:135]
  v_exp_f32 v117, v117
  v_mfma_f32_16x16x32_bf16 a[136:139], a[224:227], v[136:139], a[136:139]
  v_exp_f32 v118, v118
  v_mfma_f32_16x16x32_bf16 a[140:143], a[224:227], v[140:143], a[140:143]
  s_waitcnt lgkmcnt(5)
  v_exp_f32 v119, v119
  v_mfma_f32_16x16x32_bf16 a[144:147], a[228:231], v[128:131], a[144:147]
  ds_read_b128 a[212:215], v199 offset:0
  v_add_f32 v179, v109, v179
  v_mfma_f32_16x16x32_bf16 a[148:151], a[228:231], v[132:135], a[148:151]
  v_exp_f32 v120, v120
  v_mfma_f32_16x16x32_bf16 a[152:155], a[228:231], v[136:139], a[152:155]
  v_exp_f32 v121, v121
  v_mfma_f32_16x16x32_bf16 a[156:159], a[228:231], v[140:143], a[156:159]
  s_waitcnt lgkmcnt(4)
  v_exp_f32 v122, v122
  v_mfma_f32_16x16x32_bf16 a[160:163], a[232:235], v[128:131], a[160:163]
  ds_read_b128 a[216:219], v198 offset:128
  v_cvt_pk_bf16_f32 v156, v108, v109
  v_mfma_f32_16x16x32_bf16 a[164:167], a[232:235], v[132:135], a[164:167]
  v_exp_f32 v123, v123
  v_mfma_f32_16x16x32_bf16 a[168:171], a[232:235], v[136:139], a[168:171]
  v_exp_f32 v124, v124
  v_mfma_f32_16x16x32_bf16 a[172:175], a[232:235], v[140:143], a[172:175]
  s_waitcnt lgkmcnt(3)
  v_exp_f32 v125, v125
  v_mfma_f32_16x16x32_bf16 a[176:179], a[236:239], v[128:131], a[176:179]
  ds_read_b128 a[220:223], v199 offset:128
  v_add_f32 v179, v110, v179
  v_mfma_f32_16x16x32_bf16 a[180:183], a[236:239], v[132:135], a[180:183]
  v_exp_f32 v126, v126
  v_mfma_f32_16x16x32_bf16 a[184:187], a[236:239], v[136:139], a[184:187]
  s_mov_b32 m0, s31
  v_exp_f32 v127, v127
  v_mfma_f32_16x16x32_bf16 a[188:191], a[236:239], v[140:143], a[188:191]
  s_waitcnt lgkmcnt(3)
  v_add_f32 v179, v111, v179
  v_cvt_pk_bf16_f32 v157, v110, v111
  v_mfma_f32_16x16x32_bf16 v[96:99], a[208:211], v[0:3], v[160:163]
  ds_read_b128 a[192:195], v198 offset:256
  v_add_f32 v176, v112, v176
  v_mfma_f32_16x16x32_bf16 v[100:103], a[208:211], v[24:27], v[164:167]
  buffer_load_dwordx4 v192, s[4:7], s28 offen lds
  v_mfma_f32_16x16x32_bf16 v[104:107], a[208:211], v[48:51], v[168:171]
  v_add_f32 v176, v113, v176
  v_cvt_pk_bf16_f32 v146, v112, v113
  v_mfma_f32_16x16x32_bf16 v[108:111], a[208:211], v[72:75], v[172:175]
  s_waitcnt lgkmcnt(3)
  v_add_f32 v176, v114, v176
  v_add_f32 v176, v115, v176
  v_mfma_f32_16x16x32_bf16 v[96:99], a[212:215], v[4:7], v[96:99]
  ds_read_b128 a[196:199], v199 offset:256
  v_cvt_pk_bf16_f32 v147, v114, v115
  v_mfma_f32_16x16x32_bf16 v[100:103], a[212:215], v[28:31], v[100:103]
  v_add_f32 v177, v116, v177
  v_add_f32 v177, v117, v177
  v_mfma_f32_16x16x32_bf16 v[104:107], a[212:215], v[52:55], v[104:107]
  v_cvt_pk_bf16_f32 v150, v116, v117
  v_add_f32 v177, v118, v177
  v_mfma_f32_16x16x32_bf16 v[108:111], a[212:215], v[76:79], v[108:111]
  s_waitcnt lgkmcnt(3)
  v_add_f32 v177, v119, v177
  v_cvt_pk_bf16_f32 v151, v118, v119
  v_mfma_f32_16x16x32_bf16 v[96:99], a[216:219], v[8:11], v[96:99]
  ds_read_b128 a[200:203], v198 offset:6144
  v_add_f32 v178, v120, v178
  v_mfma_f32_16x16x32_bf16 v[100:103], a[216:219], v[32:35], v[100:103]
  buffer_load_dwordx4 v193, s[4:7], s28 offen offset:1024 lds
  v_mfma_f32_16x16x32_bf16 v[104:107], a[216:219], v[56:59], v[104:107]
  v_add_f32 v178, v121, v178
  v_cvt_pk_bf16_f32 v154, v120, v121
  v_mfma_f32_16x16x32_bf16 v[108:111], a[216:219], v[80:83], v[108:111]
  s_waitcnt lgkmcnt(3)
  v_add_f32 v178, v122, v178
  v_add_f32 v178, v123, v178
  v_mfma_f32_16x16x32_bf16 v[96:99], a[220:223], v[12:15], v[96:99]
  ds_read_b128 a[204:207], v199 offset:6144
  v_cvt_pk_bf16_f32 v155, v122, v123
  v_mfma_f32_16x16x32_bf16 v[100:103], a[220:223], v[36:39], v[100:103]
  v_add_f32 v179, v124, v179
  v_add_f32 v179, v125, v179
  v_mfma_f32_16x16x32_bf16 v[104:107], a[220:223], v[60:63], v[104:107]
  v_cvt_pk_bf16_f32 v158, v124, v125
  v_add_f32 v179, v126, v179
  v_mfma_f32_16x16x32_bf16 v[108:111], a[220:223], v[84:87], v[108:111]
  s_waitcnt lgkmcnt(3)
  v_add_f32 v179, v127, v179
  v_cvt_pk_bf16_f32 v159, v126, v127
  v_mfma_f32_16x16x32_bf16 v[96:99], a[192:195], v[16:19], v[96:99]
  ds_read_b128 a[208:211], v198 offset:6272
  v_mfma_f32_16x16x32_bf16 v[100:103], a[192:195], v[40:43], v[100:103]
  buffer_load_dwordx4 v194, s[4:7], s28 offen offset:2048 lds
  v_mfma_f32_16x16x32_bf16 v[104:107], a[192:195], v[64:67], v[104:107]
  s_add_u32 m0, s31, 12288
  v_mfma_f32_16x16x32_bf16 v[108:111], a[192:195], v[88:91], v[108:111]
  s_waitcnt lgkmcnt(3)
  v_mfma_f32_16x16x32_bf16 v[96:99], a[196:199], v[20:23], v[96:99]
  ds_read_b128 a[212:215], v199 offset:6272
  v_mfma_f32_16x16x32_bf16 v[100:103], a[196:199], v[44:47], v[100:103]
  v_mfma_f32_16x16x32_bf16 v[104:107], a[196:199], v[68:71], v[104:107]
  v_mfma_f32_16x16x32_bf16 v[108:111], a[196:199], v[92:95], v[108:111]
  s_waitcnt lgkmcnt(3)
  v_mfma_f32_16x16x32_bf16 v[112:115], a[200:203], v[0:3], v[160:163]
  ds_read_b128 a[216:219], v198 offset:6400
  v_mfma_f32_16x16x32_bf16 v[116:119], a[200:203], v[24:27], v[164:167]
  buffer_load_dwordx4 v195, s[8:11], s29 offen lds
  v_mfma_f32_16x16x32_bf16 v[120:123], a[200:203], v[48:51], v[168:171]
  v_mfma_f32_16x16x32_bf16 v[124:127], a[200:203], v[72:75], v[172:175]
  s_waitcnt lgkmcnt(3)
  v_mfma_f32_16x16x32_bf16 v[112:115], a[204:207], v[4:7], v[112:115]
  s_add_u32 s28, s28, s30
  ds_read_b128 a[220:223], v199 offset:6400
  v_mfma_f32_16x16x32_bf16 v[116:119], a[204:207], v[28:31], v[116:119]
  s_add_u32 s34, s34, 1
  v_exp_f32 v96, v96
  v_mfma_f32_16x16x32_bf16 v[120:123], a[204:207], v[52:55], v[120:123]
  s_cmp_eq_u32 s34, 6
  v_exp_f32 v97, v97
  v_mfma_f32_16x16x32_bf16 v[124:127], a[204:207], v[76:79], v[124:127]
  s_waitcnt lgkmcnt(3)
  s_cselect_b32 s33, s42, s43
  v_mfma_f32_16x16x32_bf16 v[112:115], a[208:211], v[8:11], v[112:115]
  s_cselect_b32 s34, 0, s34
  ds_read_b64_tr_b16 a[240:241], v200 offset:12288
  v_add_f32 v176, v96, v176
  v_mfma_f32_16x16x32_bf16 v[116:119], a[208:211], v[32:35], v[116:119]
  buffer_load_dwordx4 v196, s[8:11], s29 offen offset:1024 lds
  v_mfma_f32_16x16x32_bf16 v[120:123], a[208:211], v[56:59], v[120:123]
  ds_read_b64_tr_b16 a[242:243], v200 offset:18432
  v_add_f32 v176, v97, v176
  v_mfma_f32_16x16x32_bf16 v[124:127], a[208:211], v[80:83], v[124:127]
  s_waitcnt lgkmcnt(4)
  v_exp_f32 v98, v98
  v_mfma_f32_16x16x32_bf16 v[112:115], a[212:215], v[12:15], v[112:115]
  ds_read_b64_tr_b16 a[244:245], v201 offset:12288
  v_cvt_pk_bf16_f32 v128, v96, v97
  v_mfma_f32_16x16x32_bf16 v[116:119], a[212:215], v[36:39], v[116:119]
  v_exp_f32 v99, v99
  v_mfma_f32_16x16x32_bf16 v[120:123], a[212:215], v[60:63], v[120:123]
  ds_read_b64_tr_b16 a[246:247], v201 offset:18432
  v_add_f32 v176, v98, v176
  v_mfma_f32_16x16x32_bf16 v[124:127], a[212:215], v[84:87], v[124:127]
  s_waitcnt lgkmcnt(5)
  v_exp_f32 v100, v100
  v_mfma_f32_16x16x32_bf16 v[112:115], a[216:219], v[16:19], v[112:115]
  ds_read_b64_tr_b16 a[248:249], v202 offset:12288
  v_add_f32 v176, v99, v176
  v_mfma_f32_16x16x32_bf16 v[116:119], a[216:219], v[40:43], v[116:119]
  buffer_load_dwordx4 v197, s[8:11], s29 offen offset:2048 lds
  v_mfma_f32_16x16x32_bf16 v[120:123], a[216:219], v[64:67], v[120:123]
  ds_read_b64_tr_b16 a[250:251], v202 offset:18432
  v_cvt_pk_bf16_f32 v129, v98, v99
  v_mfma_f32_16x16x32_bf16 v[124:127], a[216:219], v[88:91], v[124:127]
  s_waitcnt lgkmcnt(6)
  v_exp_f32 v101, v101
  v_mfma_f32_16x16x32_bf16 v[112:115], a[220:223], v[20:23], v[112:115]
  ds_read_b64_tr_b16 a[252:253], v203 offset:12288
  v_add_f32 v177, v100, v177
  v_mfma_f32_16x16x32_bf16 v[116:119], a[220:223], v[44:47], v[116:119]
  v_exp_f32 v102, v102
  v_mfma_f32_16x16x32_bf16 v[120:123], a[220:223], v[68:71], v[120:123]
  s_mov_b32 m0, s91
  ds_read_b64_tr_b16 a[254:255], v203 offset:18432
  v_add_f32 v177, v101, v177
  v_mfma_f32_16x16x32_bf16 v[124:127], a[220:223], v[92:95], v[124:127]
  s_waitcnt lgkmcnt(6)
  v_exp_f32 v103, v103
  v_mfma_f32_16x16x32_bf16 a[0:3], a[240:243], v[144:147], a[0:3]
  ds_read_b64_tr_b16 a[224:225], v200 offset:12416
  v_add_u32 v198, s33, v198
  v_mfma_f32_16x16x32_bf16 a[4:7], a[240:243], v[148:151], a[4:7]
  buffer_load_dwordx4 v216, s[84:87], s89 offen lds
  v_mfma_f32_16x16x32_bf16 a[8:11], a[240:243], v[152:155], a[8:11]
  s_add_u32 s29, s29, s30
  ds_read_b64_tr_b16 a[226:227], v200 offset:18560
  v_add_u32 v199, s33, v199
  v_mfma_f32_16x16x32_bf16 a[12:15], a[240:243], v[156:159], a[12:15]
  s_waitcnt lgkmcnt(6)
  s_add_u32 s32, s32, 1
  v_mfma_f32_16x16x32_bf16 a[16:19], a[244:247], v[144:147], a[16:19]
  s_cmp_eq_u32 s32, 6
  ds_read_b64_tr_b16 a[228:229], v201 offset:12416
  v_cvt_pk_bf16_f32 v132, v100, v101
  v_mfma_f32_16x16x32_bf16 a[20:23], a[244:247], v[148:151], a[20:23]
  s_cselect_b32 s40, s42, s43
  v_exp_f32 v104, v104
  v_mfma_f32_16x16x32_bf16 a[24:27], a[244:247], v[152:155], a[24:27]
  s_cselect_b32 s32, 0, s32
  ds_read_b64_tr_b16 a[230:231], v201 offset:18560
  v_add_f32 v177, v102, v177
  v_mfma_f32_16x16x32_bf16 a[28:31], a[244:247], v[156:159], a[28:31]
  s_waitcnt lgkmcnt(6)
  s_add_u32 s31, s31, s40
  v_mfma_f32_16x16x32_bf16 a[32:35], a[248:251], v[144:147], a[32:35]
  s_add_u32 s89, s89, 1024
  ds_read_b64_tr_b16 a[232:233], v202 offset:12416
  v_add_f32 v177, v103, v177
  v_mfma_f32_16x16x32_bf16 a[36:39], a[248:251], v[148:151], a[36:39]
  v_exp_f32 v105, v105
  v_mfma_f32_16x16x32_bf16 a[40:43], a[248:251], v[152:155], a[40:43]
  ds_read_b64_tr_b16 a[234:235], v202 offset:18560
  v_cvt_pk_bf16_f32 v133, v102, v103
  v_mfma_f32_16x16x32_bf16 a[44:47], a[248:251], v[156:159], a[44:47]
  s_waitcnt lgkmcnt(6)
  v_exp_f32 v106, v106
  v_mfma_f32_16x16x32_bf16 a[48:51], a[252:255], v[144:147], a[48:51]
  ds_read_b64_tr_b16 a[236:237], v203 offset:12416
  v_add_f32 v178, v104, v178
  v_mfma_f32_16x16x32_bf16 a[52:55], a[252:255], v[148:151], a[52:55]
  v_exp_f32 v107, v107
  v_mfma_f32_16x16x32_bf16 a[56:59], a[252:255], v[152:155], a[56:59]
  ds_read_b64_tr_b16 a[238:239], v203 offset:18560
  v_add_f32 v178, v105, v178
  v_mfma_f32_16x16x32_bf16 a[60:63], a[252:255], v[156:159], a[60:63]
  s_waitcnt lgkmcnt(6)
  v_exp_f32 v108, v108
  v_mfma_f32_16x16x32_bf16 a[64:67], a[224:227], v[144:147], a[64:67]
  ds_read_b64_tr_b16 a[240:241], v200 offset:12544
  v_cvt_pk_bf16_f32 v136, v104, v105
  v_mfma_f32_16x16x32_bf16 a[68:71], a[224:227], v[148:151], a[68:71]
  v_exp_f32 v109, v109
  v_mfma_f32_16x16x32_bf16 a[72:75], a[224:227], v[152:155], a[72:75]
  ds_read_b64_tr_b16 a[242:243], v200 offset:18688
  v_add_u32 v200, s33, v200
  v_mfma_f32_16x16x32_bf16 a[76:79], a[224:227], v[156:159], a[76:79]
  s_waitcnt lgkmcnt(6)
  v_exp_f32 v110, v110
  v_mfma_f32_16x16x32_bf16 a[80:83], a[228:231], v[144:147], a[80:83]
  ds_read_b64_tr_b16 a[244:245], v201 offset:12544
  v_add_f32 v178, v106, v178
  v_mfma_f32_16x16x32_bf16 a[84:87], a[228:231], v[148:151], a[84:87]
  v_exp_f32 v111, v111
  v_mfma_f32_16x16x32_bf16 a[88:91], a[228:231], v[152:155], a[88:91]
  ds_read_b64_tr_b16 a[246:247], v201 offset:18688
  v_add_u32 v201, s33, v201
  v_mfma_f32_16x16x32_bf16 a[92:95], a[228:231], v[156:159], a[92:95]
  s_waitcnt lgkmcnt(6)
  v_exp_f32 v112, v112
  v_mfma_f32_16x16x32_bf16 a[96:99], a[232:235], v[144:147], a[96:99]
  ds_read_b64_tr_b16 a[248:249], v202 offset:12544
  v_add_f32 v178, v107, v178
  v_mfma_f32_16x16x32_bf16 a[100:103], a[232:235], v[148:151], a[100:103]
  v_exp_f32 v113, v113
  v_mfma_f32_16x16x32_bf16 a[104:107], a[232:235], v[152:155], a[104:107]
  ds_read_b64_tr_b16 a[250:251], v202 offset:18688
  v_add_u32 v202, s33, v202
  v_mfma_f32_16x16x32_bf16 a[108:111], a[232:235], v[156:159], a[108:111]
  s_waitcnt lgkmcnt(6)
  v_exp_f32 v114, v114
  v_mfma_f32_16x16x32_bf16 a[112:115], a[236:239], v[144:147], a[112:115]
  s_waitcnt vmcnt(20)
  ds_read_b64_tr_b16 a[252:253], v203 offset:12544
  v_cvt_pk_bf16_f32 v137, v106, v107
  v_mfma_f32_16x16x32_bf16 a[116:119], a[236:239], v[148:151], a[116:119]
  s_sub_u32 s35, s35, 1
  v_exp_f32 v115, v115
  v_mfma_f32_16x16x32_bf16 a[120:123], a[236:239], v[152:155], a[120:123]
  s_barrier
  ds_read_b64_tr_b16 a[254:255], v203 offset:18688
  v_add_u32 v203, s33, v203
  v_mfma_f32_16x16x32_bf16 a[124:127], a[236:239], v[156:159], a[124:127]
  s_waitcnt lgkmcnt(6)
  v_exp_f32 v116, v116
  v_mfma_f32_16x16x32_bf16 a[128:131], a[240:243], v[144:147], a[128:131]
  s_cmp_le_u32 s35, 3
  ds_read_b128 a[192:195], v198 offset:0
  v_add_f32 v179, v108, v179
  v_mfma_f32_16x16x32_bf16 a[132:135], a[240:243], v[148:151], a[132:135]
  s_cselect_b32 s89, s90, s89
  v_exp_f32 v117, v117
  v_mfma_f32_16x16x32_bf16 a[136:139], a[240:243], v[152:155], a[136:139]
  s_cselect_b32 s86, s88, s86
  v_exp_f32 v118, v118
  v_mfma_f32_16x16x32_bf16 a[140:143], a[240:243], v[156:159], a[140:143]
  s_waitcnt lgkmcnt(5)
  v_exp_f32 v119, v119
  v_mfma_f32_16x16x32_bf16 a[144:147], a[244:247], v[144:147], a[144:147]
  s_cmp_eq_u32 s35, 3
  ds_read_b128 a[196:199], v199 offset:0
  v_add_f32 v179, v109, v179
  v_mfma_f32_16x16x32_bf16 a[148:151], a[244:247], v[148:151], a[148:151]
  s_cselect_b32 s84, s56, s84
  v_exp_f32 v120, v120
  v_mfma_f32_16x16x32_bf16 a[152:155], a[244:247], v[152:155], a[152:155]
  s_cselect_b32 s85, s57, s85
  v_exp_f32 v121, v121
  v_mfma_f32_16x16x32_bf16 a[156:159], a[244:247], v[156:159], a[156:159]
  s_waitcnt lgkmcnt(4)
  v_exp_f32 v122, v122
  v_mfma_f32_16x16x32_bf16 a[160:163], a[248:251], v[144:147], a[160:163]
  s_cmp_eq_u32 s35, 2
  ds_read_b128 a[200:203], v198 offset:128
  v_cvt_pk_bf16_f32 v140, v108, v109
  v_mfma_f32_16x16x32_bf16 a[164:167], a[248:251], v[148:151], a[164:167]
  s_cselect_b32 s84, s58, s84
  v_exp_f32 v123, v123
  v_mfma_f32_16x16x32_bf16 a[168:171], a[248:251], v[152:155], a[168:171]
  s_cselect_b32 s85, s59, s85
  v_exp_f32 v124, v124
  v_mfma_f32_16x16x32_bf16 a[172:175], a[248:251], v[156:159], a[172:175]
  s_waitcnt lgkmcnt(3)
  v_exp_f32 v125, v125
  v_mfma_f32_16x16x32_bf16 a[176:179], a[252:255], v[144:147], a[176:179]
  s_cmp_lg_u32 s35, 0
  ds_read_b128 a[204:207], v199 offset:128
  v_add_f32 v179, v110, v179
  v_mfma_f32_16x16x32_bf16 a[180:183], a[252:255], v[148:151], a[180:183]
  v_exp_f32 v126, v126
  v_mfma_f32_16x16x32_bf16 a[184:187], a[252:255], v[152:155], a[184:187]
  s_mov_b32 m0, s31
  v_exp_f32 v127, v127
  v_mfma_f32_16x16x32_bf16 a[188:191], a[252:255], v[156:159], a[188:191]
  s_waitcnt lgkmcnt(3)
  v_add_f32 v179, v111, v179
  v_cvt_pk_bf16_f32 v141, v110, v111
  s_cbranch_scc1 adaLN_cond__sliding_block_cached__glu_gated_swiglu__prompt_kernel_c_att
  v_mfma_f32_16x16x32_bf16 v[96:99], a[192:195], v[0:3], v[160:163]
  ds_read_b128 a[208:211], v198 offset:256
  v_add_f32 v176, v112, v176
  v_mfma_f32_16x16x32_bf16 v[100:103], a[192:195], v[24:27], v[164:167]
  buffer_load_dwordx4 v192, s[4:7], s28 offen lds
  v_mfma_f32_16x16x32_bf16 v[104:107], a[192:195], v[48:51], v[168:171]
  v_add_f32 v176, v113, v176
  v_cvt_pk_bf16_f32 v130, v112, v113
  v_mfma_f32_16x16x32_bf16 v[108:111], a[192:195], v[72:75], v[172:175]
  s_waitcnt lgkmcnt(3)
  v_add_f32 v176, v114, v176
  v_add_f32 v176, v115, v176
  v_mfma_f32_16x16x32_bf16 v[96:99], a[196:199], v[4:7], v[96:99]
  ds_read_b128 a[212:215], v199 offset:256
  v_cvt_pk_bf16_f32 v131, v114, v115
  v_mfma_f32_16x16x32_bf16 v[100:103], a[196:199], v[28:31], v[100:103]
  v_add_f32 v177, v116, v177
  v_add_f32 v177, v117, v177
  v_mfma_f32_16x16x32_bf16 v[104:107], a[196:199], v[52:55], v[104:107]
  v_cvt_pk_bf16_f32 v134, v116, v117
  v_add_f32 v177, v118, v177
  v_mfma_f32_16x16x32_bf16 v[108:111], a[196:199], v[76:79], v[108:111]
  s_waitcnt lgkmcnt(3)
  v_add_f32 v177, v119, v177
  v_cvt_pk_bf16_f32 v135, v118, v119
  v_mfma_f32_16x16x32_bf16 v[96:99], a[200:203], v[8:11], v[96:99]
  ds_read_b128 a[216:219], v198 offset:6144
  v_add_f32 v178, v120, v178
  v_mfma_f32_16x16x32_bf16 v[100:103], a[200:203], v[32:35], v[100:103]
  buffer_load_dwordx4 v193, s[4:7], s28 offen offset:1024 lds
  v_mfma_f32_16x16x32_bf16 v[104:107], a[200:203], v[56:59], v[104:107]
  v_add_f32 v178, v121, v178
  v_cvt_pk_bf16_f32 v138, v120, v121
  v_mfma_f32_16x16x32_bf16 v[108:111], a[200:203], v[80:83], v[108:111]
  s_waitcnt lgkmcnt(3)
  v_add_f32 v178, v122, v178
  v_add_f32 v178, v123, v178
  v_mfma_f32_16x16x32_bf16 v[96:99], a[204:207], v[12:15], v[96:99]
  ds_read_b128 a[220:223], v199 offset:6144
  v_cvt_pk_bf16_f32 v139, v122, v123
  v_mfma_f32_16x16x32_bf16 v[100:103], a[204:207], v[36:39], v[100:103]
  v_add_f32 v179, v124, v179
  v_add_f32 v179, v125, v179
  v_mfma_f32_16x16x32_bf16 v[104:107], a[204:207], v[60:63], v[104:107]
  v_cvt_pk_bf16_f32 v142, v124, v125
  v_add_f32 v179, v126, v179
  v_mfma_f32_16x16x32_bf16 v[108:111], a[204:207], v[84:87], v[108:111]
  s_waitcnt lgkmcnt(3)
  v_add_f32 v179, v127, v179
  v_cvt_pk_bf16_f32 v143, v126, v127
  v_mfma_f32_16x16x32_bf16 v[96:99], a[208:211], v[16:19], v[96:99]
  ds_read_b128 a[192:195], v198 offset:6272
  v_mfma_f32_16x16x32_bf16 v[100:103], a[208:211], v[40:43], v[100:103]
  buffer_load_dwordx4 v194, s[4:7], s28 offen offset:2048 lds
  v_mfma_f32_16x16x32_bf16 v[104:107], a[208:211], v[64:67], v[104:107]
  s_add_u32 m0, s31, 12288
  v_mfma_f32_16x16x32_bf16 v[108:111], a[208:211], v[88:91], v[108:111]
  s_waitcnt lgkmcnt(3)
  v_mfma_f32_16x16x32_bf16 v[96:99], a[212:215], v[20:23], v[96:99]
  ds_read_b128 a[196:199], v199 offset:6272
  v_mfma_f32_16x16x32_bf16 v[100:103], a[212:215], v[44:47], v[100:103]
  v_mfma_f32_16x16x32_bf16 v[104:107], a[212:215], v[68:71], v[104:107]
  v_mfma_f32_16x16x32_bf16 v[108:111], a[212:215], v[92:95], v[108:111]
  s_waitcnt lgkmcnt(3)
  v_mfma_f32_16x16x32_bf16 v[112:115], a[216:219], v[0:3], v[160:163]
  ds_read_b128 a[200:203], v198 offset:6400
  v_mfma_f32_16x16x32_bf16 v[116:119], a[216:219], v[24:27], v[164:167]
  buffer_load_dwordx4 v195, s[8:11], s29 offen lds
  v_mfma_f32_16x16x32_bf16 v[120:123], a[216:219], v[48:51], v[168:171]
  v_mfma_f32_16x16x32_bf16 v[124:127], a[216:219], v[72:75], v[172:175]
  s_waitcnt lgkmcnt(3)
  v_mfma_f32_16x16x32_bf16 v[112:115], a[220:223], v[4:7], v[112:115]
  s_add_u32 s28, s28, s30
  ds_read_b128 a[204:207], v199 offset:6400
  v_mfma_f32_16x16x32_bf16 v[116:119], a[220:223], v[28:31], v[116:119]
  s_add_u32 s34, s34, 1
  v_exp_f32 v96, v96
  v_mfma_f32_16x16x32_bf16 v[120:123], a[220:223], v[52:55], v[120:123]
  s_cmp_eq_u32 s34, 6
  v_exp_f32 v97, v97
  v_mfma_f32_16x16x32_bf16 v[124:127], a[220:223], v[76:79], v[124:127]
  s_waitcnt lgkmcnt(3)
  s_cselect_b32 s33, s42, s43
  v_mfma_f32_16x16x32_bf16 v[112:115], a[192:195], v[8:11], v[112:115]
  s_cselect_b32 s34, 0, s34
  ds_read_b64_tr_b16 a[224:225], v200 offset:12288
  v_add_f32 v176, v96, v176
  v_mfma_f32_16x16x32_bf16 v[116:119], a[192:195], v[32:35], v[116:119]
  buffer_load_dwordx4 v196, s[8:11], s29 offen offset:1024 lds
  v_mfma_f32_16x16x32_bf16 v[120:123], a[192:195], v[56:59], v[120:123]
  ds_read_b64_tr_b16 a[226:227], v200 offset:18432
  v_add_f32 v176, v97, v176
  v_mfma_f32_16x16x32_bf16 v[124:127], a[192:195], v[80:83], v[124:127]
  s_waitcnt lgkmcnt(4)
  v_exp_f32 v98, v98
  v_mfma_f32_16x16x32_bf16 v[112:115], a[196:199], v[12:15], v[112:115]
  ds_read_b64_tr_b16 a[228:229], v201 offset:12288
  v_cvt_pk_bf16_f32 v144, v96, v97
  v_mfma_f32_16x16x32_bf16 v[116:119], a[196:199], v[36:39], v[116:119]
  v_exp_f32 v99, v99
  v_mfma_f32_16x16x32_bf16 v[120:123], a[196:199], v[60:63], v[120:123]
  ds_read_b64_tr_b16 a[230:231], v201 offset:18432
  v_add_f32 v176, v98, v176
  v_mfma_f32_16x16x32_bf16 v[124:127], a[196:199], v[84:87], v[124:127]
  s_waitcnt lgkmcnt(5)
  v_exp_f32 v100, v100
  v_mfma_f32_16x16x32_bf16 v[112:115], a[200:203], v[16:19], v[112:115]
  ds_read_b64_tr_b16 a[232:233], v202 offset:12288
  v_add_f32 v176, v99, v176
  v_mfma_f32_16x16x32_bf16 v[116:119], a[200:203], v[40:43], v[116:119]
  buffer_load_dwordx4 v197, s[8:11], s29 offen offset:2048 lds
  v_mfma_f32_16x16x32_bf16 v[120:123], a[200:203], v[64:67], v[120:123]
  ds_read_b64_tr_b16 a[234:235], v202 offset:18432
  v_cvt_pk_bf16_f32 v145, v98, v99
  v_mfma_f32_16x16x32_bf16 v[124:127], a[200:203], v[88:91], v[124:127]
  s_waitcnt lgkmcnt(6)
  v_exp_f32 v101, v101
  v_mfma_f32_16x16x32_bf16 v[112:115], a[204:207], v[20:23], v[112:115]
  ds_read_b64_tr_b16 a[236:237], v203 offset:12288
  v_add_f32 v177, v100, v177
  v_mfma_f32_16x16x32_bf16 v[116:119], a[204:207], v[44:47], v[116:119]
  v_exp_f32 v102, v102
  v_mfma_f32_16x16x32_bf16 v[120:123], a[204:207], v[68:71], v[120:123]
  s_mov_b32 m0, s91
  ds_read_b64_tr_b16 a[238:239], v203 offset:18432
  v_add_f32 v177, v101, v177
  v_mfma_f32_16x16x32_bf16 v[124:127], a[204:207], v[92:95], v[124:127]
  s_waitcnt lgkmcnt(6)
  v_exp_f32 v103, v103
  v_mfma_f32_16x16x32_bf16 a[0:3], a[224:227], v[128:131], a[0:3]
  ds_read_b64_tr_b16 a[240:241], v200 offset:12416
  v_add_u32 v198, s33, v198
  v_mfma_f32_16x16x32_bf16 a[4:7], a[224:227], v[132:135], a[4:7]
  s_nop 0
  v_mfma_f32_16x16x32_bf16 a[8:11], a[224:227], v[136:139], a[8:11]
  s_add_u32 s29, s29, s30
  ds_read_b64_tr_b16 a[242:243], v200 offset:18560
  v_add_u32 v199, s33, v199
  v_mfma_f32_16x16x32_bf16 a[12:15], a[224:227], v[140:143], a[12:15]
  s_waitcnt lgkmcnt(6)
  s_add_u32 s32, s32, 1
  v_mfma_f32_16x16x32_bf16 a[16:19], a[228:231], v[128:131], a[16:19]
  s_cmp_eq_u32 s32, 6
  ds_read_b64_tr_b16 a[244:245], v201 offset:12416
  v_cvt_pk_bf16_f32 v148, v100, v101
  v_mfma_f32_16x16x32_bf16 a[20:23], a[228:231], v[132:135], a[20:23]
  s_cselect_b32 s40, s42, s43
  v_exp_f32 v104, v104
  v_mfma_f32_16x16x32_bf16 a[24:27], a[228:231], v[136:139], a[24:27]
  s_cselect_b32 s32, 0, s32
  ds_read_b64_tr_b16 a[246:247], v201 offset:18560
  v_add_f32 v177, v102, v177
  v_mfma_f32_16x16x32_bf16 a[28:31], a[228:231], v[140:143], a[28:31]
  s_waitcnt lgkmcnt(6)
  s_add_u32 s31, s31, s40
  v_mfma_f32_16x16x32_bf16 a[32:35], a[232:235], v[128:131], a[32:35]
  s_add_u32 s89, s89, 1024
  ds_read_b64_tr_b16 a[248:249], v202 offset:12416
  v_add_f32 v177, v103, v177
  v_mfma_f32_16x16x32_bf16 a[36:39], a[232:235], v[132:135], a[36:39]
  v_exp_f32 v105, v105
  v_mfma_f32_16x16x32_bf16 a[40:43], a[232:235], v[136:139], a[40:43]
  ds_read_b64_tr_b16 a[250:251], v202 offset:18560
  v_cvt_pk_bf16_f32 v149, v102, v103
  v_mfma_f32_16x16x32_bf16 a[44:47], a[232:235], v[140:143], a[44:47]
  s_waitcnt lgkmcnt(6)
  v_exp_f32 v106, v106
  v_mfma_f32_16x16x32_bf16 a[48:51], a[236:239], v[128:131], a[48:51]
  ds_read_b64_tr_b16 a[252:253], v203 offset:12416
  v_add_f32 v178, v104, v178
  v_mfma_f32_16x16x32_bf16 a[52:55], a[236:239], v[132:135], a[52:55]
  v_exp_f32 v107, v107
  v_mfma_f32_16x16x32_bf16 a[56:59], a[236:239], v[136:139], a[56:59]
  ds_read_b64_tr_b16 a[254:255], v203 offset:18560
  v_add_f32 v178, v105, v178
  v_mfma_f32_16x16x32_bf16 a[60:63], a[236:239], v[140:143], a[60:63]
  s_waitcnt lgkmcnt(6)
  v_exp_f32 v108, v108
  v_mfma_f32_16x16x32_bf16 a[64:67], a[240:243], v[128:131], a[64:67]
  ds_read_b64_tr_b16 a[224:225], v200 offset:12544
  v_cvt_pk_bf16_f32 v152, v104, v105
  v_mfma_f32_16x16x32_bf16 a[68:71], a[240:243], v[132:135], a[68:71]
  v_exp_f32 v109, v109
  v_mfma_f32_16x16x32_bf16 a[72:75], a[240:243], v[136:139], a[72:75]
  ds_read_b64_tr_b16 a[226:227], v200 offset:18688
  v_add_u32 v200, s33, v200
  v_mfma_f32_16x16x32_bf16 a[76:79], a[240:243], v[140:143], a[76:79]
  s_waitcnt lgkmcnt(6)
  v_exp_f32 v110, v110
  v_mfma_f32_16x16x32_bf16 a[80:83], a[244:247], v[128:131], a[80:83]
  ds_read_b64_tr_b16 a[228:229], v201 offset:12544
  v_add_f32 v178, v106, v178
  v_mfma_f32_16x16x32_bf16 a[84:87], a[244:247], v[132:135], a[84:87]
  v_exp_f32 v111, v111
  v_mfma_f32_16x16x32_bf16 a[88:91], a[244:247], v[136:139], a[88:91]
  ds_read_b64_tr_b16 a[230:231], v201 offset:18688
  v_add_u32 v201, s33, v201
  v_mfma_f32_16x16x32_bf16 a[92:95], a[244:247], v[140:143], a[92:95]
  s_waitcnt lgkmcnt(6)
  v_exp_f32 v112, v112
  v_mfma_f32_16x16x32_bf16 a[96:99], a[248:251], v[128:131], a[96:99]
  ds_read_b64_tr_b16 a[232:233], v202 offset:12544
  v_add_f32 v178, v107, v178
  v_mfma_f32_16x16x32_bf16 a[100:103], a[248:251], v[132:135], a[100:103]
  v_exp_f32 v113, v113
  v_mfma_f32_16x16x32_bf16 a[104:107], a[248:251], v[136:139], a[104:107]
  ds_read_b64_tr_b16 a[234:235], v202 offset:18688
  v_add_u32 v202, s33, v202
  v_mfma_f32_16x16x32_bf16 a[108:111], a[248:251], v[140:143], a[108:111]
  s_waitcnt lgkmcnt(6)
  v_exp_f32 v114, v114
  v_mfma_f32_16x16x32_bf16 a[112:115], a[252:255], v[128:131], a[112:115]
  s_waitcnt vmcnt(21)
  ds_read_b64_tr_b16 a[236:237], v203 offset:12544
  v_cvt_pk_bf16_f32 v153, v106, v107
  v_mfma_f32_16x16x32_bf16 a[116:119], a[252:255], v[132:135], a[116:119]
  v_exp_f32 v115, v115
  v_mfma_f32_16x16x32_bf16 a[120:123], a[252:255], v[136:139], a[120:123]
  s_barrier
  ds_read_b64_tr_b16 a[238:239], v203 offset:18688
  v_add_u32 v203, s33, v203
  v_mfma_f32_16x16x32_bf16 a[124:127], a[252:255], v[140:143], a[124:127]
  s_waitcnt lgkmcnt(6)
  v_exp_f32 v116, v116
  v_mfma_f32_16x16x32_bf16 a[128:131], a[224:227], v[128:131], a[128:131]
  v_add_f32 v179, v108, v179
  v_mfma_f32_16x16x32_bf16 a[132:135], a[224:227], v[132:135], a[132:135]
  v_exp_f32 v117, v117
  v_mfma_f32_16x16x32_bf16 a[136:139], a[224:227], v[136:139], a[136:139]
  v_exp_f32 v118, v118
  v_mfma_f32_16x16x32_bf16 a[140:143], a[224:227], v[140:143], a[140:143]
  s_waitcnt lgkmcnt(4)
  v_exp_f32 v119, v119
  v_mfma_f32_16x16x32_bf16 a[144:147], a[228:231], v[128:131], a[144:147]
  v_add_f32 v179, v109, v179
  v_mfma_f32_16x16x32_bf16 a[148:151], a[228:231], v[132:135], a[148:151]
  v_exp_f32 v120, v120
  v_mfma_f32_16x16x32_bf16 a[152:155], a[228:231], v[136:139], a[152:155]
  v_exp_f32 v121, v121
  v_mfma_f32_16x16x32_bf16 a[156:159], a[228:231], v[140:143], a[156:159]
  s_waitcnt lgkmcnt(2)
  v_exp_f32 v122, v122
  v_mfma_f32_16x16x32_bf16 a[160:163], a[232:235], v[128:131], a[160:163]
  v_cvt_pk_bf16_f32 v156, v108, v109
  v_mfma_f32_16x16x32_bf16 a[164:167], a[232:235], v[132:135], a[164:167]
  v_exp_f32 v123, v123
  v_mfma_f32_16x16x32_bf16 a[168:171], a[232:235], v[136:139], a[168:171]
  v_exp_f32 v124, v124
  v_mfma_f32_16x16x32_bf16 a[172:175], a[232:235], v[140:143], a[172:175]
  s_waitcnt lgkmcnt(0)
  v_exp_f32 v125, v125
  v_mfma_f32_16x16x32_bf16 a[176:179], a[236:239], v[128:131], a[176:179]
  v_add_f32 v179, v110, v179
  v_mfma_f32_16x16x32_bf16 a[180:183], a[236:239], v[132:135], a[180:183]
  v_exp_f32 v126, v126
  v_mfma_f32_16x16x32_bf16 a[184:187], a[236:239], v[136:139], a[184:187]
  s_mov_b32 m0, s31
  v_exp_f32 v127, v127
  v_mfma_f32_16x16x32_bf16 a[188:191], a[236:239], v[140:143], a[188:191]
  v_add_f32 v179, v111, v179
  v_cvt_pk_bf16_f32 v157, v110, v111
  ds_read_b64_tr_b16 a[240:241], v200 offset:12288
  ds_read_b64_tr_b16 a[242:243], v200 offset:18432
  ds_read_b64_tr_b16 a[244:245], v201 offset:12288
  ds_read_b64_tr_b16 a[246:247], v201 offset:18432
  ds_read_b64_tr_b16 a[248:249], v202 offset:12288
  ds_read_b64_tr_b16 a[250:251], v202 offset:18432
  ds_read_b64_tr_b16 a[252:253], v203 offset:12288
  ds_read_b64_tr_b16 a[254:255], v203 offset:18432
  v_add_f32 v176, v112, v176
  v_add_f32 v176, v113, v176
  v_cvt_pk_bf16_f32 v146, v112, v113
  v_add_f32 v176, v114, v176
  v_add_f32 v176, v115, v176
  v_cvt_pk_bf16_f32 v147, v114, v115
  v_add_f32 v177, v116, v177
  v_add_f32 v177, v117, v177
  v_cvt_pk_bf16_f32 v150, v116, v117
  v_add_f32 v177, v118, v177
  v_add_f32 v177, v119, v177
  v_cvt_pk_bf16_f32 v151, v118, v119
  v_add_f32 v178, v120, v178
  v_add_f32 v178, v121, v178
  v_cvt_pk_bf16_f32 v154, v120, v121
  v_add_f32 v178, v122, v178
  v_add_f32 v178, v123, v178
  v_cvt_pk_bf16_f32 v155, v122, v123
  v_add_f32 v179, v124, v179
  v_add_f32 v179, v125, v179
  v_cvt_pk_bf16_f32 v158, v124, v125
  v_add_f32 v179, v126, v179
  v_add_f32 v179, v127, v179
  v_cvt_pk_bf16_f32 v159, v126, v127
  s_mov_b32 s40, 0x5d800000
  s_lshl_b32 s41, s82, 2
  s_add_u32 s41, s41, 151792
  v_mov_b32 v189, s41
  s_waitcnt lgkmcnt(6)
  v_mfma_f32_16x16x32_bf16 a[0:3], a[240:243], v[144:147], a[0:3]
  ds_read_b64_tr_b16 a[224:225], v200 offset:12416
  v_mov_b32 v184, v176
  v_mfma_f32_16x16x32_bf16 a[4:7], a[240:243], v[148:151], a[4:7]
  v_mov_b32 v185, v177
  v_mfma_f32_16x16x32_bf16 a[8:11], a[240:243], v[152:155], a[8:11]
  ds_read_b64_tr_b16 a[226:227], v200 offset:18560
  v_mov_b32 v186, v178
  v_mfma_f32_16x16x32_bf16 a[12:15], a[240:243], v[156:159], a[12:15]
  s_waitcnt lgkmcnt(6)
  v_mov_b32 v187, v179
  v_mfma_f32_16x16x32_bf16 a[16:19], a[244:247], v[144:147], a[16:19]
  ds_read_b64_tr_b16 a[228:229], v201 offset:12416
  v_permlane32_swap_b32 v184, v176
  v_mfma_f32_16x16x32_bf16 a[20:23], a[244:247], v[148:151], a[20:23]
  v_permlane32_swap_b32 v185, v177
  v_mfma_f32_16x16x32_bf16 a[24:27], a[244:247], v[152:155], a[24:27]
  ds_read_b64_tr_b16 a[230:231], v201 offset:18560
  v_permlane32_swap_b32 v186, v178
  v_mfma_f32_16x16x32_bf16 a[28:31], a[244:247], v[156:159], a[28:31]
  s_waitcnt lgkmcnt(6)
  v_permlane32_swap_b32 v187, v179
  v_mfma_f32_16x16x32_bf16 a[32:35], a[248:251], v[144:147], a[32:35]
  ds_read_b64_tr_b16 a[232:233], v202 offset:12416
  v_add_f32 v176, v184, v176
  v_mfma_f32_16x16x32_bf16 a[36:39], a[248:251], v[148:151], a[36:39]
  v_add_f32 v177, v185, v177
  v_mfma_f32_16x16x32_bf16 a[40:43], a[248:251], v[152:155], a[40:43]
  ds_read_b64_tr_b16 a[234:235], v202 offset:18560
  v_add_f32 v178, v186, v178
  v_mfma_f32_16x16x32_bf16 a[44:47], a[248:251], v[156:159], a[44:47]
  s_waitcnt lgkmcnt(6)
  v_add_f32 v179, v187, v179
  v_mfma_f32_16x16x32_bf16 a[48:51], a[252:255], v[144:147], a[48:51]
  ds_read_b64_tr_b16 a[236:237], v203 offset:12416
  v_mov_b32 v184, v176
  v_mfma_f32_16x16x32_bf16 a[52:55], a[252:255], v[148:151], a[52:55]
  v_mov_b32 v185, v177
  v_mfma_f32_16x16x32_bf16 a[56:59], a[252:255], v[152:155], a[56:59]
  ds_read_b64_tr_b16 a[238:239], v203 offset:18560
  v_mov_b32 v186, v178
  v_mfma_f32_16x16x32_bf16 a[60:63], a[252:255], v[156:159], a[60:63]
  s_waitcnt lgkmcnt(6)
  v_mov_b32 v187, v179
  v_mfma_f32_16x16x32_bf16 a[64:67], a[224:227], v[144:147], a[64:67]
  ds_read_b64_tr_b16 a[240:241], v200 offset:12544
  v_permlane16_swap_b32 v184, v176
  v_mfma_f32_16x16x32_bf16 a[68:71], a[224:227], v[148:151], a[68:71]
  v_permlane16_swap_b32 v185, v177
  v_mfma_f32_16x16x32_bf16 a[72:75], a[224:227], v[152:155], a[72:75]
  ds_read_b64_tr_b16 a[242:243], v200 offset:18688
  v_permlane16_swap_b32 v186, v178
  v_mfma_f32_16x16x32_bf16 a[76:79], a[224:227], v[156:159], a[76:79]
  s_waitcnt lgkmcnt(6)
  v_permlane16_swap_b32 v187, v179
  v_mfma_f32_16x16x32_bf16 a[80:83], a[228:231], v[144:147], a[80:83]
  ds_read_b64_tr_b16 a[244:245], v201 offset:12544
  v_add_f32 v176, v184, v176
  v_mfma_f32_16x16x32_bf16 a[84:87], a[228:231], v[148:151], a[84:87]
  v_add_f32 v177, v185, v177
  v_mfma_f32_16x16x32_bf16 a[88:91], a[228:231], v[152:155], a[88:91]
  ds_read_b64_tr_b16 a[246:247], v201 offset:18688
  v_add_f32 v178, v186, v178
  v_mfma_f32_16x16x32_bf16 a[92:95], a[228:231], v[156:159], a[92:95]
  s_waitcnt lgkmcnt(6)
  v_add_f32 v179, v187, v179
  v_mfma_f32_16x16x32_bf16 a[96:99], a[232:235], v[144:147], a[96:99]
  ds_read_b64_tr_b16 a[248:249], v202 offset:12544
  v_cmp_ngt_f32 vcc, s40, v176
  v_mfma_f32_16x16x32_bf16 a[100:103], a[232:235], v[148:151], a[100:103]
  v_cmp_ngt_f32 s[12:13], s40, v177
  v_mfma_f32_16x16x32_bf16 a[104:107], a[232:235], v[152:155], a[104:107]
  ds_read_b64_tr_b16 a[250:251], v202 offset:18688
  v_cmp_ngt_f32 s[14:15], s40, v178
  v_mfma_f32_16x16x32_bf16 a[108:111], a[232:235], v[156:159], a[108:111]
  s_waitcnt lgkmcnt(6)
  v_cmp_ngt_f32 s[16:17], s40, v179
  v_mfma_f32_16x16x32_bf16 a[112:115], a[236:239], v[144:147], a[112:115]
  ds_read_b64_tr_b16 a[252:253], v203 offset:12544
  v_mfma_f32_16x16x32_bf16 a[116:119], a[236:239], v[148:151], a[116:119]
  s_or_b64 vcc, vcc, s[12:13]
  v_mfma_f32_16x16x32_bf16 a[120:123], a[236:239], v[152:155], a[120:123]
  s_or_b64 s[14:15], s[14:15], s[16:17]
  ds_read_b64_tr_b16 a[254:255], v203 offset:18688
  v_mfma_f32_16x16x32_bf16 a[124:127], a[236:239], v[156:159], a[124:127]
  s_waitcnt lgkmcnt(6)
  s_or_b64 vcc, vcc, s[14:15]
  v_mfma_f32_16x16x32_bf16 a[128:131], a[240:243], v[144:147], a[128:131]
  s_cmp_lg_u64 vcc, 0
  v_mfma_f32_16x16x32_bf16 a[132:135], a[240:243], v[148:151], a[132:135]
  s_cselect_b32 s40, 1, 0
  v_mfma_f32_16x16x32_bf16 a[136:139], a[240:243], v[152:155], a[136:139]
  v_mfma_f32_16x16x32_bf16 a[140:143], a[240:243], v[156:159], a[140:143]
  s_waitcnt lgkmcnt(4)
  v_mfma_f32_16x16x32_bf16 a[144:147], a[244:247], v[144:147], a[144:147]
  v_mfma_f32_16x16x32_bf16 a[148:151], a[244:247], v[148:151], a[148:151]
  v_mfma_f32_16x16x32_bf16 a[152:155], a[244:247], v[152:155], a[152:155]
  v_mfma_f32_16x16x32_bf16 a[156:159], a[244:247], v[156:159], a[156:159]
  s_waitcnt lgkmcnt(2)
  v_mfma_f32_16x16x32_bf16 a[160:163], a[248:251], v[144:147], a[160:163]
  v_mfma_f32_16x16x32_bf16 a[164:167], a[248:251], v[148:151], a[164:167]
  v_mfma_f32_16x16x32_bf16 a[168:171], a[248:251], v[152:155], a[168:171]
  v_mfma_f32_16x16x32_bf16 a[172:175], a[248:251], v[156:159], a[172:175]
  s_waitcnt lgkmcnt(0)
  v_mfma_f32_16x16x32_bf16 a[176:179], a[252:255], v[144:147], a[176:179]
  v_mfma_f32_16x16x32_bf16 a[180:183], a[252:255], v[148:151], a[180:183]
  v_mfma_f32_16x16x32_bf16 a[184:187], a[252:255], v[152:155], a[184:187]
  v_mfma_f32_16x16x32_bf16 a[188:191], a[252:255], v[156:159], a[188:191]
  v_mov_b32 v188, s40
  ds_write_b32 v189, v188
  s_waitcnt lgkmcnt(0)
  s_barrier
  v_mov_b32 v189, 151792
  ds_read_b128 v[180:183], v189
  s_waitcnt lgkmcnt(0)
  v_or_b32 v180, v180, v181
  v_or_b32 v182, v182, v183
  v_or_b32 v180, v180, v182
  s_nop 0
  v_readfirstlane_b32 s40, v180
  s_nop 0
  s_cmp_lg_u32 s40, 0
  s_cbranch_scc1 adaLN_cond__sliding_block_cached__glu_gated_swiglu__prompt_kernel_c_redo
adaLN_cond__sliding_block_cached__glu_gated_swiglu__prompt_kernel_c_rows_done:
  v_rcp_f32 v176, v176
  v_rcp_f32 v177, v177
  v_rcp_f32 v178, v178
  v_rcp_f32 v179, v179
  v_lshlrev_b32 v218, 4, v255
  s_lshl_b32 s40, s38, 4
  s_lshl_b32 s41, s82, 2
  s_add_u32 s40, s40, s41
  s_mul_i32 s40, s40, 192
  s_mul_i32 s41, s37, 6
  s_add_u32 s40, s40, s41
  s_lshl_b32 s93, s40, 10
  s_add_u32 s94, s38, 16
  s_lshl_b32 s94, s94, 7
  s_lshl_b32 s95, s37, 2
  s_add_u32 s95, s95, s94
  v_mov_b32 v208, s95
  v_mov_b32 v209, 1
  s_and_b32 s95, s2, 7
  s_lshl_b32 s95, s95, 4
  s_add_u32 s94, s94, s95
  v_and_b32 v210, 3, v255
  v_lshlrev_b32 v210, 2, v210
  v_add_u32 v210, s94, v210
  v_subrev_u32 v212, 4, v255
  v_cmp_gt_u32 vcc, 8, v212
  v_lshlrev_b32 v212, 7, v212
  v_add_u32 v212, 1024, v212
  v_cndmask_b32 v210, v210, v212, vcc
  v_mov_b32 v211, 1
  v_mov_b32 v212, 32
  v_cndmask_b32 v211, v211, v212, vcc
  v_accvgpr_read_b32 v160, a0
  v_accvgpr_read_b32 v161, a1
  v_accvgpr_read_b32 v162, a2
  v_accvgpr_read_b32 v163, a3
  v_accvgpr_read_b32 v164, a16
  v_accvgpr_read_b32 v165, a17
  v_accvgpr_read_b32 v166, a18
  v_accvgpr_read_b32 v167, a19
  v_pk_mul_f32 v[160:161], v[160:161], v[176:177] op_sel:[0,0] op_sel_hi:[1,0]
  v_pk_mul_f32 v[162:163], v[162:163], v[176:177] op_sel:[0,0] op_sel_hi:[1,0]
  v_pk_mul_f32 v[164:165], v[164:165], v[176:177] op_sel:[0,0] op_sel_hi:[1,0]
  v_pk_mul_f32 v[166:167], v[166:167], v[176:177] op_sel:[0,0] op_sel_hi:[1,0]
  v_cvt_pk_bf16_f32 v168, v160, v161
  v_cvt_pk_bf16_f32 v169, v162, v163
  v_cvt_pk_bf16_f32 v170, v164, v165
  v_cvt_pk_bf16_f32 v171, v166, v167
  buffer_store_dwordx4 v[168:171], v218, s[24:27], s93 offen sc1
  v_accvgpr_write_b32 a0, v168
  v_accvgpr_write_b32 a1, v169
  v_accvgpr_write_b32 a2, v170
  v_accvgpr_write_b32 a3, v171
  s_and_b32 s35, s2, 7
  s_bfe_u32 s36, s2, 0x20003
  s_lshr_b32 s37, s2, 5
  s_mov_b32 s4, s54
  s_mov_b32 s5, s55
  s_mov_b32 s6, 7864320
  s_mov_b32 s7, 0x20000
  s_add_u32 s8, s50, 3145728
  s_addc_u32 s9, s51, 0
  s_mov_b32 s10, 25165824
  s_mov_b32 s11, 0x20000
  s_add_u32 s12, s50, 28311552
  s_addc_u32 s13, s51, 0
  s_mov_b32 s14, 20971520
  s_mov_b32 s15, 0x20000
  s_add_u32 s20, s50, 62914560
  s_addc_u32 s21, s51, 0
  s_mov_b32 s22, 9728
  s_mov_b32 s23, 0x20000
  s_add_u32 s84, s50, 62914560
  s_addc_u32 s85, s51, 0
  s_mov_b32 s86, 9728
  s_mov_b32 s87, 0x20000
  s_cmp_eq_u32 s82, 0
  s_cselect_b32 s86, s86, 0
  s_mov_b32 s41, -102400
  s_mov_b32 s42, 20480
  s_mov_b32 s30, 0
  s_mov_b32 s32, 0
  s_mov_b32 s91, 7864320
  s_mov_b32 s92, 983040
  s_mov_b32 s90, 0
  s_mul_i32 s28, s35, 983040
  s_add_u32 s38, s28, 983040
  s_mul_i32 s40, s36, 246080
  s_add_u32 s28, s28, s40
  s_mul_i32 s29, s82, 5120
  s_lshl_b32 s39, s37, 4
  s_lshl_b32 s40, s82, 2
  s_add_u32 s39, s39, s40
  s_mul_i32 s34, s39, 192
  s_mul_i32 s40, s35, 24
  s_add_u32 s34, s34, s40
  s_lshl_b32 s88, s34, 10
  s_add_u32 s89, s36, 1
  s_and_b32 s89, s89, 3
  s_mul_i32 s34, s89, 6144
  s_add_u32 s34, s34, s88
  s_mov_b32 s43, 25165824
  s_mov_b32 m0, s29
  s_nop 0
  buffer_load_dwordx4 v232, s[4:7], s28 offen lds
  v_accvgpr_read_b32 v180, a32
  v_accvgpr_read_b32 v181, a33
  v_accvgpr_read_b32 v182, a34
  v_accvgpr_read_b32 v183, a35
  v_accvgpr_read_b32 v184, a48
  v_accvgpr_read_b32 v185, a49
  v_accvgpr_read_b32 v186, a50
  v_accvgpr_read_b32 v187, a51
  v_pk_mul_f32 v[180:181], v[180:181], v[176:177] op_sel:[0,0] op_sel_hi:[1,0]
  v_pk_mul_f32 v[182:183], v[182:183], v[176:177] op_sel:[0,0] op_sel_hi:[1,0]
  v_pk_mul_f32 v[184:185], v[184:185], v[176:177] op_sel:[0,0] op_sel_hi:[1,0]
  v_pk_mul_f32 v[186:187], v[186:187], v[176:177] op_sel:[0,0] op_sel_hi:[1,0]
  v_cvt_pk_bf16_f32 v188, v180, v181
  v_cvt_pk_bf16_f32 v189, v182, v183
  v_cvt_pk_bf16_f32 v190, v184, v185
  v_cvt_pk_bf16_f32 v191, v186, v187
  buffer_store_dwordx4 v[188:191], v218, s[24:27], s93 offen offset:1024 sc1
  v_accvgpr_write_b32 a32, v188
  v_accvgpr_write_b32 a33, v189
  v_accvgpr_write_b32 a34, v190
  v_accvgpr_write_b32 a35, v191
  buffer_load_dwordx4 v233, s[4:7], s28 offen offset:1024 lds
  buffer_load_dwordx4 v234, s[4:7], s28 offen offset:2048 lds
  v_accvgpr_read_b32 v160, a64
  v_accvgpr_read_b32 v161, a65
  v_accvgpr_read_b32 v162, a66
  v_accvgpr_read_b32 v163, a67
  v_accvgpr_read_b32 v164, a80
  v_accvgpr_read_b32 v165, a81
  v_accvgpr_read_b32 v166, a82
  v_accvgpr_read_b32 v167, a83
  v_pk_mul_f32 v[160:161], v[160:161], v[176:177] op_sel:[0,0] op_sel_hi:[1,0]
  v_pk_mul_f32 v[162:163], v[162:163], v[176:177] op_sel:[0,0] op_sel_hi:[1,0]
  v_pk_mul_f32 v[164:165], v[164:165], v[176:177] op_sel:[0,0] op_sel_hi:[1,0]
  v_pk_mul_f32 v[166:167], v[166:167], v[176:177] op_sel:[0,0] op_sel_hi:[1,0]
  v_cvt_pk_bf16_f32 v168, v160, v161
  v_cvt_pk_bf16_f32 v169, v162, v163
  v_cvt_pk_bf16_f32 v170, v164, v165
  v_cvt_pk_bf16_f32 v171, v166, v167
  buffer_store_dwordx4 v[168:171], v218, s[24:27], s93 offen offset:2048 sc1
  v_accvgpr_write_b32 a64, v168
  v_accvgpr_write_b32 a65, v169
  v_accvgpr_write_b32 a66, v170
  v_accvgpr_write_b32 a67, v171
  buffer_load_dwordx4 v235, s[4:7], s28 offen offset:3072 lds
  s_add_u32 m0, s29, 4096
  s_nop 0
  buffer_load_dwordx4 v236, s[4:7], s28 offen lds
  s_add_u32 s28, s28, 81920
  s_cmp_ge_u32 s28, s38
  s_cselect_b32 s40, s92, 0
  s_sub_u32 s28, s28, s40
  s_add_u32 s90, s90, 1
  s_cmp_lt_u32 s90, 12
  s_cselect_b32 s6, s91, 0
  s_add_u32 s30, s30, 1
  s_cmp_eq_u32 s30, 6
  s_cselect_b32 s39, s41, s42
  s_cselect_b32 s30, 0, s30
  s_add_u32 s29, s29, s39
  v_accvgpr_read_b32 v180, a96
  v_accvgpr_read_b32 v181, a97
  v_accvgpr_read_b32 v182, a98
  v_accvgpr_read_b32 v183, a99
  v_accvgpr_read_b32 v184, a112
  v_accvgpr_read_b32 v185, a113
  v_accvgpr_read_b32 v186, a114
  v_accvgpr_read_b32 v187, a115
  v_pk_mul_f32 v[180:181], v[180:181], v[176:177] op_sel:[0,0] op_sel_hi:[1,0]
  v_pk_mul_f32 v[182:183], v[182:183], v[176:177] op_sel:[0,0] op_sel_hi:[1,0]
  v_pk_mul_f32 v[184:185], v[184:185], v[176:177] op_sel:[0,0] op_sel_hi:[1,0]
  v_pk_mul_f32 v[186:187], v[186:187], v[176:177] op_sel:[0,0] op_sel_hi:[1,0]
  v_cvt_pk_bf16_f32 v188, v180, v181
  v_cvt_pk_bf16_f32 v189, v182, v183
  v_cvt_pk_bf16_f32 v190, v184, v185
  v_cvt_pk_bf16_f32 v191, v186, v187
  buffer_store_dwordx4 v[188:191], v218, s[24:27], s93 offen offset:3072 sc1
  v_accvgpr_write_b32 a96, v188
  v_accvgpr_write_b32 a97, v189
  v_accvgpr_write_b32 a98, v190
  v_accvgpr_write_b32 a99, v191
  s_mov_b32 m0, s29
  s_nop 0
  buffer_load_dwordx4 v232, s[4:7], s28 offen lds
  buffer_load_dwordx4 v233, s[4:7], s28 offen offset:1024 lds
  v_accvgpr_read_b32 v160, a128
  v_accvgpr_read_b32 v161, a129
  v_accvgpr_read_b32 v162, a130
  v_accvgpr_read_b32 v163, a131
  v_accvgpr_read_b32 v164, a144
  v_accvgpr_read_b32 v165, a145
  v_accvgpr_read_b32 v166, a146
  v_accvgpr_read_b32 v167, a147
  v_pk_mul_f32 v[160:161], v[160:161], v[176:177] op_sel:[0,0] op_sel_hi:[1,0]
  v_pk_mul_f32 v[162:163], v[162:163], v[176:177] op_sel:[0,0] op_sel_hi:[1,0]
  v_pk_mul_f32 v[164:165], v[164:165], v[176:177] op_sel:[0,0] op_sel_hi:[1,0]
  v_pk_mul_f32 v[166:167], v[166:167], v[176:177] op_sel:[0,0] op_sel_hi:[1,0]
  v_cvt_pk_bf16_f32 v168, v160, v161
  v_cvt_pk_bf16_f32 v169, v162, v163
  v_cvt_pk_bf16_f32 v170, v164, v165
  v_cvt_pk_bf16_f32 v171, v166, v167
  s_add_u32 s93, s93, 4096
  buffer_store_dwordx4 v[168:171], v218, s[24:27], s93 offen sc1
  v_accvgpr_write_b32 a128, v168
  v_accvgpr_write_b32 a129, v169
  v_accvgpr_write_b32 a130, v170
  v_accvgpr_write_b32 a131, v171
  buffer_load_dwordx4 v234, s[4:7], s28 offen offset:2048 lds
  buffer_load_dwordx4 v235, s[4:7], s28 offen offset:3072 lds
  v_accvgpr_read_b32 v180, a160
  v_accvgpr_read_b32 v181, a161
  v_accvgpr_read_b32 v182, a162
  v_accvgpr_read_b32 v183, a163
  v_accvgpr_read_b32 v184, a176
  v_accvgpr_read_b32 v185, a177
  v_accvgpr_read_b32 v186, a178
  v_accvgpr_read_b32 v187, a179
  v_pk_mul_f32 v[180:181], v[180:181], v[176:177] op_sel:[0,0] op_sel_hi:[1,0]
  v_pk_mul_f32 v[182:183], v[182:183], v[176:177] op_sel:[0,0] op_sel_hi:[1,0]
  v_pk_mul_f32 v[184:185], v[184:185], v[176:177] op_sel:[0,0] op_sel_hi:[1,0]
  v_pk_mul_f32 v[186:187], v[186:187], v[176:177] op_sel:[0,0] op_sel_hi:[1,0]
  v_cvt_pk_bf16_f32 v188, v180, v181
  v_cvt_pk_bf16_f32 v189, v182, v183
  v_cvt_pk_bf16_f32 v190, v184, v185
  v_cvt_pk_bf16_f32 v191, v186, v187
  buffer_store_dwordx4 v[188:191], v218, s[24:27], s93 offen offset:1024 sc1
  v_accvgpr_write_b32 a160, v188
  v_accvgpr_write_b32 a161, v189
  v_accvgpr_write_b32 a162, v190
  v_accvgpr_write_b32 a163, v191
  s_add_u32 m0, s29, 4096
  s_nop 0
  buffer_load_dwordx4 v236, s[4:7], s28 offen lds
  s_add_u32 s28, s28, 81920
  s_cmp_ge_u32 s28, s38
  s_cselect_b32 s40, s92, 0
  s_sub_u32 s28, s28, s40
  s_add_u32 s90, s90, 1
  s_cmp_lt_u32 s90, 12
  s_cselect_b32 s6, s91, 0
  s_add_u32 s30, s30, 1
  s_cmp_eq_u32 s30, 6
  s_cselect_b32 s39, s41, s42
  s_cselect_b32 s30, 0, s30
  s_add_u32 s29, s29, s39
  s_mov_b32 m0, s29
  s_nop 0
  buffer_load_dwordx4 v232, s[4:7], s28 offen lds
  s_add_u32 s93, s93, 192512
  v_accvgpr_read_b32 v160, a4
  v_accvgpr_read_b32 v161, a5
  v_accvgpr_read_b32 v162, a6
  v_accvgpr_read_b32 v163, a7
  v_accvgpr_read_b32 v164, a20
  v_accvgpr_read_b32 v165, a21
  v_accvgpr_read_b32 v166, a22
  v_accvgpr_read_b32 v167, a23
  v_pk_mul_f32 v[160:161], v[160:161], v[176:177] op_sel:[0,1] op_sel_hi:[1,1]
  v_pk_mul_f32 v[162:163], v[162:163], v[176:177] op_sel:[0,1] op_sel_hi:[1,1]
  v_pk_mul_f32 v[164:165], v[164:165], v[176:177] op_sel:[0,1] op_sel_hi:[1,1]
  v_pk_mul_f32 v[166:167], v[166:167], v[176:177] op_sel:[0,1] op_sel_hi:[1,1]
  v_cvt_pk_bf16_f32 v168, v160, v161
  v_cvt_pk_bf16_f32 v169, v162, v163
  v_cvt_pk_bf16_f32 v170, v164, v165
  v_cvt_pk_bf16_f32 v171, v166, v167
  buffer_store_dwordx4 v[168:171], v218, s[24:27], s93 offen sc1
  v_accvgpr_write_b32 a4, v168
  v_accvgpr_write_b32 a5, v169
  v_accvgpr_write_b32 a6, v170
  v_accvgpr_write_b32 a7, v171
  buffer_load_dwordx4 v233, s[4:7], s28 offen offset:1024 lds
  buffer_load_dwordx4 v234, s[4:7], s28 offen offset:2048 lds
  v_accvgpr_read_b32 v180, a36
  v_accvgpr_read_b32 v181, a37
  v_accvgpr_read_b32 v182, a38
  v_accvgpr_read_b32 v183, a39
  v_accvgpr_read_b32 v184, a52
  v_accvgpr_read_b32 v185, a53
  v_accvgpr_read_b32 v186, a54
  v_accvgpr_read_b32 v187, a55
  v_pk_mul_f32 v[180:181], v[180:181], v[176:177] op_sel:[0,1] op_sel_hi:[1,1]
  v_pk_mul_f32 v[182:183], v[182:183], v[176:177] op_sel:[0,1] op_sel_hi:[1,1]
  v_pk_mul_f32 v[184:185], v[184:185], v[176:177] op_sel:[0,1] op_sel_hi:[1,1]
  v_pk_mul_f32 v[186:187], v[186:187], v[176:177] op_sel:[0,1] op_sel_hi:[1,1]
  v_cvt_pk_bf16_f32 v188, v180, v181
  v_cvt_pk_bf16_f32 v189, v182, v183
  v_cvt_pk_bf16_f32 v190, v184, v185
  v_cvt_pk_bf16_f32 v191, v186, v187
  buffer_store_dwordx4 v[188:191], v218, s[24:27], s93 offen offset:1024 sc1
  v_accvgpr_write_b32 a36, v188
  v_accvgpr_write_b32 a37, v189
  v_accvgpr_write_b32 a38, v190
  v_accvgpr_write_b32 a39, v191
  buffer_load_dwordx4 v235, s[4:7], s28 offen offset:3072 lds
  s_add_u32 m0, s29, 4096
  s_nop 0
  buffer_load_dwordx4 v236, s[4:7], s28 offen lds
  s_add_u32 s28, s28, 81920
  s_cmp_ge_u32 s28, s38
  s_cselect_b32 s40, s92, 0
  s_sub_u32 s28, s28, s40
  s_add_u32 s90, s90, 1
  s_cmp_lt_u32 s90, 12
  s_cselect_b32 s6, s91, 0
  s_add_u32 s30, s30, 1
  s_cmp_eq_u32 s30, 6
  s_cselect_b32 s39, s41, s42
  s_cselect_b32 s30, 0, s30
  s_add_u32 s29, s29, s39
  v_accvgpr_read_b32 v160, a68
  v_accvgpr_read_b32 v161, a69
  v_accvgpr_read_b32 v162, a70
  v_accvgpr_read_b32 v163, a71
  v_accvgpr_read_b32 v164, a84
  v_accvgpr_read_b32 v165, a85
  v_accvgpr_read_b32 v166, a86
  v_accvgpr_read_b32 v167, a87
  v_pk_mul_f32 v[160:161], v[160:161], v[176:177] op_sel:[0,1] op_sel_hi:[1,1]
  v_pk_mul_f32 v[162:163], v[162:163], v[176:177] op_sel:[0,1] op_sel_hi:[1,1]
  v_pk_mul_f32 v[164:165], v[164:165], v[176:177] op_sel:[0,1] op_sel_hi:[1,1]
  v_pk_mul_f32 v[166:167], v[166:167], v[176:177] op_sel:[0,1] op_sel_hi:[1,1]
  v_cvt_pk_bf16_f32 v168, v160, v161
  v_cvt_pk_bf16_f32 v169, v162, v163
  v_cvt_pk_bf16_f32 v170, v164, v165
  v_cvt_pk_bf16_f32 v171, v166, v167
  buffer_store_dwordx4 v[168:171], v218, s[24:27], s93 offen offset:2048 sc1
  v_accvgpr_write_b32 a68, v168
  v_accvgpr_write_b32 a69, v169
  v_accvgpr_write_b32 a70, v170
  v_accvgpr_write_b32 a71, v171
  s_mov_b32 m0, s29
  s_nop 0
  buffer_load_dwordx4 v232, s[4:7], s28 offen lds
  buffer_load_dwordx4 v233, s[4:7], s28 offen offset:1024 lds
  v_accvgpr_read_b32 v180, a100
  v_accvgpr_read_b32 v181, a101
  v_accvgpr_read_b32 v182, a102
  v_accvgpr_read_b32 v183, a103
  v_accvgpr_read_b32 v184, a116
  v_accvgpr_read_b32 v185, a117
  v_accvgpr_read_b32 v186, a118
  v_accvgpr_read_b32 v187, a119
  v_pk_mul_f32 v[180:181], v[180:181], v[176:177] op_sel:[0,1] op_sel_hi:[1,1]
  v_pk_mul_f32 v[182:183], v[182:183], v[176:177] op_sel:[0,1] op_sel_hi:[1,1]
  v_pk_mul_f32 v[184:185], v[184:185], v[176:177] op_sel:[0,1] op_sel_hi:[1,1]
  v_pk_mul_f32 v[186:187], v[186:187], v[176:177] op_sel:[0,1] op_sel_hi:[1,1]
  v_cvt_pk_bf16_f32 v188, v180, v181
  v_cvt_pk_bf16_f32 v189, v182, v183
  v_cvt_pk_bf16_f32 v190, v184, v185
  v_cvt_pk_bf16_f32 v191, v186, v187
  buffer_store_dwordx4 v[188:191], v218, s[24:27], s93 offen offset:3072 sc1
  v_accvgpr_write_b32 a100, v188
  v_accvgpr_write_b32 a101, v189
  v_accvgpr_write_b32 a102, v190
  v_accvgpr_write_b32 a103, v191
  buffer_load_dwordx4 v234, s[4:7], s28 offen offset:2048 lds
  buffer_load_dwordx4 v235, s[4:7], s28 offen offset:3072 lds
  v_accvgpr_read_b32 v160, a132
  v_accvgpr_read_b32 v161, a133
  v_accvgpr_read_b32 v162, a134
  v_accvgpr_read_b32 v163, a135
  v_accvgpr_read_b32 v164, a148
  v_accvgpr_read_b32 v165, a149
  v_accvgpr_read_b32 v166, a150
  v_accvgpr_read_b32 v167, a151
  v_pk_mul_f32 v[160:161], v[160:161], v[176:177] op_sel:[0,1] op_sel_hi:[1,1]
  v_pk_mul_f32 v[162:163], v[162:163], v[176:177] op_sel:[0,1] op_sel_hi:[1,1]
  v_pk_mul_f32 v[164:165], v[164:165], v[176:177] op_sel:[0,1] op_sel_hi:[1,1]
  v_pk_mul_f32 v[166:167], v[166:167], v[176:177] op_sel:[0,1] op_sel_hi:[1,1]
  v_cvt_pk_bf16_f32 v168, v160, v161
  v_cvt_pk_bf16_f32 v169, v162, v163
  v_cvt_pk_bf16_f32 v170, v164, v165
  v_cvt_pk_bf16_f32 v171, v166, v167
  s_add_u32 s93, s93, 4096
  buffer_store_dwordx4 v[168:171], v218, s[24:27], s93 offen sc1
  v_accvgpr_write_b32 a132, v168
  v_accvgpr_write_b32 a133, v169
  v_accvgpr_write_b32 a134, v170
  v_accvgpr_write_b32 a135, v171
  s_add_u32 m0, s29, 4096
  s_nop 0
  buffer_load_dwordx4 v236, s[4:7], s28 offen lds
  s_add_u32 s28, s28, 81920
  s_cmp_ge_u32 s28, s38
  s_cselect_b32 s40, s92, 0
  s_sub_u32 s28, s28, s40
  s_add_u32 s90, s90, 1
  s_cmp_lt_u32 s90, 12
  s_cselect_b32 s6, s91, 0
  s_add_u32 s30, s30, 1
  s_cmp_eq_u32 s30, 6
  s_cselect_b32 s39, s41, s42
  s_cselect_b32 s30, 0, s30
  s_add_u32 s29, s29, s39
  v_lshlrev_b32 v204, 4, v255
  v_lshlrev_b32 v205, 4, v255
  v_add_u32 v205, 196608, v205
  v_lshlrev_b32 v206, 4, v255
  v_add_u32 v206, 393216, v206
  v_lshlrev_b32 v207, 4, v255
  v_add_u32 v207, 589824, v207
  v_and_b32 v219, 15, v255
  v_lshrrev_b32 v220, 4, v255
  v_lshrrev_b32 v222, 2, v219
  v_lshl_add_u32 v222, v220, 2, v222
  v_mul_u32_u24 v221, 320, v222
  v_bfe_u32 v222, v219, 1, 1
  v_lshl_add_u32 v221, v222, 4, v221
  v_and_b32 v222, 1, v219
  v_lshl_add_u32 v221, v222, 3, v221
  v_and_b32 v222, 1, v220
  v_xor_b32 v223, 0, v222
  v_lshl_add_u32 v198, v223, 5, v221
  v_xor_b32 v223, 1, v222
  v_lshl_add_u32 v199, v223, 5, v221
  v_accvgpr_read_b32 v180, a164
  v_accvgpr_read_b32 v181, a165
  v_accvgpr_read_b32 v182, a166
  v_accvgpr_read_b32 v183, a167
  v_accvgpr_read_b32 v184, a180
  v_accvgpr_read_b32 v185, a181
  v_accvgpr_read_b32 v186, a182
  v_accvgpr_read_b32 v187, a183
  v_pk_mul_f32 v[180:181], v[180:181], v[176:177] op_sel:[0,1] op_sel_hi:[1,1]
  v_pk_mul_f32 v[182:183], v[182:183], v[176:177] op_sel:[0,1] op_sel_hi:[1,1]
  v_pk_mul_f32 v[184:185], v[184:185], v[176:177] op_sel:[0,1] op_sel_hi:[1,1]
  v_pk_mul_f32 v[186:187], v[186:187], v[176:177] op_sel:[0,1] op_sel_hi:[1,1]
  v_cvt_pk_bf16_f32 v188, v180, v181
  v_cvt_pk_bf16_f32 v189, v182, v183
  v_cvt_pk_bf16_f32 v190, v184, v185
  v_cvt_pk_bf16_f32 v191, v186, v187
  buffer_store_dwordx4 v[188:191], v218, s[24:27], s93 offen offset:1024 sc1
  v_accvgpr_write_b32 a164, v188
  v_accvgpr_write_b32 a165, v189
  v_accvgpr_write_b32 a166, v190
  v_accvgpr_write_b32 a167, v191
  v_mov_b64 v[0:1], 0
  v_mov_b64 v[2:3], 0
  v_mov_b64 v[4:5], 0
  v_mov_b64 v[6:7], 0
  v_mov_b64 v[8:9], 0
  v_mov_b64 v[10:11], 0
  v_mov_b64 v[12:13], 0
  v_mov_b64 v[14:15], 0
  v_mov_b64 v[16:17], 0
  v_mov_b64 v[18:19], 0
  v_mov_b64 v[20:21], 0
  v_mov_b64 v[22:23], 0
  v_mov_b64 v[24:25], 0
  v_mov_b64 v[26:27], 0
  v_mov_b64 v[28:29], 0
  v_mov_b64 v[30:31], 0
  s_add_u32 s93, s93, 192512
  v_accvgpr_read_b32 v160, a8
  v_accvgpr_read_b32 v161, a9
  v_accvgpr_read_b32 v162, a10
  v_accvgpr_read_b32 v163, a11
  v_accvgpr_read_b32 v164, a24
  v_accvgpr_read_b32 v165, a25
  v_accvgpr_read_b32 v166, a26
  v_accvgpr_read_b32 v167, a27
  v_pk_mul_f32 v[160:161], v[160:161], v[178:179] op_sel:[0,0] op_sel_hi:[1,0]
  v_pk_mul_f32 v[162:163], v[162:163], v[178:179] op_sel:[0,0] op_sel_hi:[1,0]
  v_pk_mul_f32 v[164:165], v[164:165], v[178:179] op_sel:[0,0] op_sel_hi:[1,0]
  v_pk_mul_f32 v[166:167], v[166:167], v[178:179] op_sel:[0,0] op_sel_hi:[1,0]
  v_cvt_pk_bf16_f32 v168, v160, v161
  v_cvt_pk_bf16_f32 v169, v162, v163
  v_cvt_pk_bf16_f32 v170, v164, v165
  v_cvt_pk_bf16_f32 v171, v166, v167
  buffer_store_dwordx4 v[168:171], v218, s[24:27], s93 offen sc1
  v_accvgpr_write_b32 a8, v168
  v_accvgpr_write_b32 a9, v169
  v_accvgpr_write_b32 a10, v170
  v_accvgpr_write_b32 a11, v171
  v_mov_b64 v[32:33], 0
  v_mov_b64 v[34:35], 0
  v_mov_b64 v[36:37], 0
  v_mov_b64 v[38:39], 0
  v_mov_b64 v[40:41], 0
  v_mov_b64 v[42:43], 0
  v_mov_b64 v[44:45], 0
  v_mov_b64 v[46:47], 0
  v_mov_b64 v[48:49], 0
  v_mov_b64 v[50:51], 0
  v_mov_b64 v[52:53], 0
  v_mov_b64 v[54:55], 0
  v_mov_b64 v[56:57], 0
  v_mov_b64 v[58:59], 0
  v_mov_b64 v[60:61], 0
  v_mov_b64 v[62:63], 0
  v_accvgpr_read_b32 v180, a40
  v_accvgpr_read_b32 v181, a41
  v_accvgpr_read_b32 v182, a42
  v_accvgpr_read_b32 v183, a43
  v_accvgpr_read_b32 v184, a56
  v_accvgpr_read_b32 v185, a57
  v_accvgpr_read_b32 v186, a58
  v_accvgpr_read_b32 v187, a59
  v_pk_mul_f32 v[180:181], v[180:181], v[178:179] op_sel:[0,0] op_sel_hi:[1,0]
  v_pk_mul_f32 v[182:183], v[182:183], v[178:179] op_sel:[0,0] op_sel_hi:[1,0]
  v_pk_mul_f32 v[184:185], v[184:185], v[178:179] op_sel:[0,0] op_sel_hi:[1,0]
  v_pk_mul_f32 v[186:187], v[186:187], v[178:179] op_sel:[0,0] op_sel_hi:[1,0]
  v_cvt_pk_bf16_f32 v188, v180, v181
  v_cvt_pk_bf16_f32 v189, v182, v183
  v_cvt_pk_bf16_f32 v190, v184, v185
  v_cvt_pk_bf16_f32 v191, v186, v187
  buffer_store_dwordx4 v[188:191], v218, s[24:27], s93 offen offset:1024 sc1
  v_accvgpr_write_b32 a40, v188
  v_accvgpr_write_b32 a41, v189
  v_accvgpr_write_b32 a42, v190
  v_accvgpr_write_b32 a43, v191
  v_mov_b64 v[64:65], 0
  v_mov_b64 v[66:67], 0
  v_mov_b64 v[68:69], 0
  v_mov_b64 v[70:71], 0
  v_mov_b64 v[72:73], 0
  v_mov_b64 v[74:75], 0
  v_mov_b64 v[76:77], 0
  v_mov_b64 v[78:79], 0
  v_mov_b64 v[80:81], 0
  v_mov_b64 v[82:83], 0
  v_mov_b64 v[84:85], 0
  v_mov_b64 v[86:87], 0
  v_mov_b64 v[88:89], 0
  v_mov_b64 v[90:91], 0
  v_mov_b64 v[92:93], 0
  v_mov_b64 v[94:95], 0
  v_accvgpr_read_b32 v160, a72
  v_accvgpr_read_b32 v161, a73
  v_accvgpr_read_b32 v162, a74
  v_accvgpr_read_b32 v163, a75
  v_accvgpr_read_b32 v164, a88
  v_accvgpr_read_b32 v165, a89
  v_accvgpr_read_b32 v166, a90
  v_accvgpr_read_b32 v167, a91
  v_pk_mul_f32 v[160:161], v[160:161], v[178:179] op_sel:[0,0] op_sel_hi:[1,0]
  v_pk_mul_f32 v[162:163], v[162:163], v[178:179] op_sel:[0,0] op_sel_hi:[1,0]
  v_pk_mul_f32 v[164:165], v[164:165], v[178:179] op_sel:[0,0] op_sel_hi:[1,0]
  v_pk_mul_f32 v[166:167], v[166:167], v[178:179] op_sel:[0,0] op_sel_hi:[1,0]
  v_cvt_pk_bf16_f32 v168, v160, v161
  v_cvt_pk_bf16_f32 v169, v162, v163
  v_cvt_pk_bf16_f32 v170, v164, v165
  v_cvt_pk_bf16_f32 v171, v166, v167
  buffer_store_dwordx4 v[168:171], v218, s[24:27], s93 offen offset:2048 sc1
  v_accvgpr_write_b32 a72, v168
  v_accvgpr_write_b32 a73, v169
  v_accvgpr_write_b32 a74, v170
  v_accvgpr_write_b32 a75, v171
  v_mov_b64 v[96:97], 0
  v_mov_b64 v[98:99], 0
  v_mov_b64 v[100:101], 0
  v_mov_b64 v[102:103], 0
  v_mov_b64 v[104:105], 0
  v_mov_b64 v[106:107], 0
  v_mov_b64 v[108:109], 0
  v_mov_b64 v[110:111], 0
  v_mov_b64 v[112:113], 0
  v_mov_b64 v[114:115], 0
  v_mov_b64 v[116:117], 0
  v_mov_b64 v[118:119], 0
  v_mov_b64 v[120:121], 0
  v_mov_b64 v[122:123], 0
  v_mov_b64 v[124:125], 0
  v_mov_b64 v[126:127], 0
  v_accvgpr_read_b32 v180, a104
  v_accvgpr_read_b32 v181, a105
  v_accvgpr_read_b32 v182, a106
  v_accvgpr_read_b32 v183, a107
  v_accvgpr_read_b32 v184, a120
  v_accvgpr_read_b32 v185, a121
  v_accvgpr_read_b32 v186, a122
  v_accvgpr_read_b32 v187, a123
  v_pk_mul_f32 v[180:181], v[180:181], v[178:179] op_sel:[0,0] op_sel_hi:[1,0]
  v_pk_mul_f32 v[182:183], v[182:183], v[178:179] op_sel:[0,0] op_sel_hi:[1,0]
  v_pk_mul_f32 v[184:185], v[184:185], v[178:179] op_sel:[0,0] op_sel_hi:[1,0]
  v_pk_mul_f32 v[186:187], v[186:187], v[178:179] op_sel:[0,0] op_sel_hi:[1,0]
  v_cvt_pk_bf16_f32 v188, v180, v181
  v_cvt_pk_bf16_f32 v189, v182, v183
  v_cvt_pk_bf16_f32 v190, v184, v185
  v_cvt_pk_bf16_f32 v191, v186, v187
  buffer_store_dwordx4 v[188:191], v218, s[24:27], s93 offen offset:3072 sc1
  v_accvgpr_write_b32 a104, v188
  v_accvgpr_write_b32 a105, v189
  v_accvgpr_write_b32 a106, v190
  v_accvgpr_write_b32 a107, v191
  v_mov_b64 v[128:129], 0
  v_mov_b64 v[130:131], 0
  v_mov_b64 v[132:133], 0
  v_mov_b64 v[134:135], 0
  v_mov_b64 v[136:137], 0
  v_mov_b64 v[138:139], 0
  v_mov_b64 v[140:141], 0
  v_mov_b64 v[142:143], 0
  v_mov_b64 v[144:145], 0
  v_mov_b64 v[146:147], 0
  v_mov_b64 v[148:149], 0
  v_mov_b64 v[150:151], 0
  v_mov_b64 v[152:153], 0
  v_mov_b64 v[154:155], 0
  v_mov_b64 v[156:157], 0
  v_mov_b64 v[158:159], 0
  v_accvgpr_read_b32 v160, a136
  v_accvgpr_read_b32 v161, a137
  v_accvgpr_read_b32 v162, a138
  v_accvgpr_read_b32 v163, a139
  v_accvgpr_read_b32 v164, a152
  v_accvgpr_read_b32 v165, a153
  v_accvgpr_read_b32 v166, a154
  v_accvgpr_read_b32 v167, a155
  v_pk_mul_f32 v[160:161], v[160:161], v[178:179] op_sel:[0,0] op_sel_hi:[1,0]
  v_pk_mul_f32 v[162:163], v[162:163], v[178:179] op_sel:[0,0] op_sel_hi:[1,0]
  v_pk_mul_f32 v[164:165], v[164:165], v[178:179] op_sel:[0,0] op_sel_hi:[1,0]
  v_pk_mul_f32 v[166:167], v[166:167], v[178:179] op_sel:[0,0] op_sel_hi:[1,0]
  v_cvt_pk_bf16_f32 v168, v160, v161
  v_cvt_pk_bf16_f32 v169, v162, v163
  v_cvt_pk_bf16_f32 v170, v164, v165
  v_cvt_pk_bf16_f32 v171, v166, v167
  s_add_u32 s93, s93, 4096
  buffer_store_dwordx4 v[168:171], v218, s[24:27], s93 offen sc1
  v_accvgpr_write_b32 a136, v168
  v_accvgpr_write_b32 a137, v169
  v_accvgpr_write_b32 a138, v170
  v_accvgpr_write_b32 a139, v171
  v_accvgpr_read_b32 v180, a168
  v_accvgpr_read_b32 v181, a169
  v_accvgpr_read_b32 v182, a170
  v_accvgpr_read_b32 v183, a171
  v_accvgpr_read_b32 v184, a184
  v_accvgpr_read_b32 v185, a185
  v_accvgpr_read_b32 v186, a186
  v_accvgpr_read_b32 v187, a187
  v_pk_mul_f32 v[180:181], v[180:181], v[178:179] op_sel:[0,0] op_sel_hi:[1,0]
  v_pk_mul_f32 v[182:183], v[182:183], v[178:179] op_sel:[0,0] op_sel_hi:[1,0]
  v_pk_mul_f32 v[184:185], v[184:185], v[178:179] op_sel:[0,0] op_sel_hi:[1,0]
  v_pk_mul_f32 v[186:187], v[186:187], v[178:179] op_sel:[0,0] op_sel_hi:[1,0]
  v_cvt_pk_bf16_f32 v188, v180, v181
  v_cvt_pk_bf16_f32 v189, v182, v183
  v_cvt_pk_bf16_f32 v190, v184, v185
  v_cvt_pk_bf16_f32 v191, v186, v187
  buffer_store_dwordx4 v[188:191], v218, s[24:27], s93 offen offset:1024 sc1
  v_accvgpr_write_b32 a168, v188
  v_accvgpr_write_b32 a169, v189
  v_accvgpr_write_b32 a170, v190
  v_accvgpr_write_b32 a171, v191
  s_add_u32 s93, s93, 192512
  v_accvgpr_read_b32 v160, a12
  v_accvgpr_read_b32 v161, a13
  v_accvgpr_read_b32 v162, a14
  v_accvgpr_read_b32 v163, a15
  v_accvgpr_read_b32 v164, a28
  v_accvgpr_read_b32 v165, a29
  v_accvgpr_read_b32 v166, a30
  v_accvgpr_read_b32 v167, a31
  v_pk_mul_f32 v[160:161], v[160:161], v[178:179] op_sel:[0,1] op_sel_hi:[1,1]
  v_pk_mul_f32 v[162:163], v[162:163], v[178:179] op_sel:[0,1] op_sel_hi:[1,1]
  v_pk_mul_f32 v[164:165], v[164:165], v[178:179] op_sel:[0,1] op_sel_hi:[1,1]
  v_pk_mul_f32 v[166:167], v[166:167], v[178:179] op_sel:[0,1] op_sel_hi:[1,1]
  v_cvt_pk_bf16_f32 v168, v160, v161
  v_cvt_pk_bf16_f32 v169, v162, v163
  v_cvt_pk_bf16_f32 v170, v164, v165
  v_cvt_pk_bf16_f32 v171, v166, v167
  buffer_store_dwordx4 v[168:171], v218, s[24:27], s93 offen sc1
  v_accvgpr_write_b32 a12, v168
  v_accvgpr_write_b32 a13, v169
  v_accvgpr_write_b32 a14, v170
  v_accvgpr_write_b32 a15, v171
  v_accvgpr_read_b32 v180, a44
  v_accvgpr_read_b32 v181, a45
  v_accvgpr_read_b32 v182, a46
  v_accvgpr_read_b32 v183, a47
  v_accvgpr_read_b32 v184, a60
  v_accvgpr_read_b32 v185, a61
  v_accvgpr_read_b32 v186, a62
  v_accvgpr_read_b32 v187, a63
  v_pk_mul_f32 v[180:181], v[180:181], v[178:179] op_sel:[0,1] op_sel_hi:[1,1]
  v_pk_mul_f32 v[182:183], v[182:183], v[178:179] op_sel:[0,1] op_sel_hi:[1,1]
  v_pk_mul_f32 v[184:185], v[184:185], v[178:179] op_sel:[0,1] op_sel_hi:[1,1]
  v_pk_mul_f32 v[186:187], v[186:187], v[178:179] op_sel:[0,1] op_sel_hi:[1,1]
  v_cvt_pk_bf16_f32 v188, v180, v181
  v_cvt_pk_bf16_f32 v189, v182, v183
  v_cvt_pk_bf16_f32 v190, v184, v185
  v_cvt_pk_bf16_f32 v191, v186, v187
  buffer_store_dwordx4 v[188:191], v218, s[24:27], s93 offen offset:1024 sc1
  v_accvgpr_write_b32 a44, v188
  v_accvgpr_write_b32 a45, v189
  v_accvgpr_write_b32 a46, v190
  v_accvgpr_write_b32 a47, v191
  v_accvgpr_read_b32 v160, a76
  v_accvgpr_read_b32 v161, a77
  v_accvgpr_read_b32 v162, a78
  v_accvgpr_read_b32 v163, a79
  v_accvgpr_read_b32 v164, a92
  v_accvgpr_read_b32 v165, a93
  v_accvgpr_read_b32 v166, a94
  v_accvgpr_read_b32 v167, a95
  v_pk_mul_f32 v[160:161], v[160:161], v[178:179] op_sel:[0,1] op_sel_hi:[1,1]
  v_pk_mul_f32 v[162:163], v[162:163], v[178:179] op_sel:[0,1] op_sel_hi:[1,1]
  v_pk_mul_f32 v[164:165], v[164:165], v[178:179] op_sel:[0,1] op_sel_hi:[1,1]
  v_pk_mul_f32 v[166:167], v[166:167], v[178:179] op_sel:[0,1] op_sel_hi:[1,1]
  v_cvt_pk_bf16_f32 v168, v160, v161
  v_cvt_pk_bf16_f32 v169, v162, v163
  v_cvt_pk_bf16_f32 v170, v164, v165
  v_cvt_pk_bf16_f32 v171, v166, v167
  buffer_store_dwordx4 v[168:171], v218, s[24:27], s93 offen offset:2048 sc1
  v_accvgpr_write_b32 a76, v168
  v_accvgpr_write_b32 a77, v169
  v_accvgpr_write_b32 a78, v170
  v_accvgpr_write_b32 a79, v171
  v_accvgpr_read_b32 v180, a108
  v_accvgpr_read_b32 v181, a109
  v_accvgpr_read_b32 v182, a110
  v_accvgpr_read_b32 v183, a111
  v_accvgpr_read_b32 v184, a124
  v_accvgpr_read_b32 v185, a125
  v_accvgpr_read_b32 v186, a126
  v_accvgpr_read_b32 v187, a127
  v_pk_mul_f32 v[180:181], v[180:181], v[178:179] op_sel:[0,1] op_sel_hi:[1,1]
  v_pk_mul_f32 v[182:183], v[182:183], v[178:179] op_sel:[0,1] op_sel_hi:[1,1]
  v_pk_mul_f32 v[184:185], v[184:185], v[178:179] op_sel:[0,1] op_sel_hi:[1,1]
  v_pk_mul_f32 v[186:187], v[186:187], v[178:179] op_sel:[0,1] op_sel_hi:[1,1]
  v_cvt_pk_bf16_f32 v188, v180, v181
  v_cvt_pk_bf16_f32 v189, v182, v183
  v_cvt_pk_bf16_f32 v190, v184, v185
  v_cvt_pk_bf16_f32 v191, v186, v187
  buffer_store_dwordx4 v[188:191], v218, s[24:27], s93 offen offset:3072 sc1
  v_accvgpr_write_b32 a108, v188
  v_accvgpr_write_b32 a109, v189
  v_accvgpr_write_b32 a110, v190
  v_accvgpr_write_b32 a111, v191
  v_accvgpr_read_b32 v160, a140
  v_accvgpr_read_b32 v161, a141
  v_accvgpr_read_b32 v162, a142
  v_accvgpr_read_b32 v163, a143
  v_accvgpr_read_b32 v164, a156
  v_accvgpr_read_b32 v165, a157
  v_accvgpr_read_b32 v166, a158
  v_accvgpr_read_b32 v167, a159
  v_pk_mul_f32 v[160:161], v[160:161], v[178:179] op_sel:[0,1] op_sel_hi:[1,1]
  v_pk_mul_f32 v[162:163], v[162:163], v[178:179] op_sel:[0,1] op_sel_hi:[1,1]
  v_pk_mul_f32 v[164:165], v[164:165], v[178:179] op_sel:[0,1] op_sel_hi:[1,1]
  v_pk_mul_f32 v[166:167], v[166:167], v[178:179] op_sel:[0,1] op_sel_hi:[1,1]
  v_cvt_pk_bf16_f32 v168, v160, v161
  v_cvt_pk_bf16_f32 v169, v162, v163
  v_cvt_pk_bf16_f32 v170, v164, v165
  v_cvt_pk_bf16_f32 v171, v166, v167
  s_add_u32 s93, s93, 4096
  buffer_store_dwordx4 v[168:171], v218, s[24:27], s93 offen sc1
  v_accvgpr_write_b32 a140, v168
  v_accvgpr_write_b32 a141, v169
  v_accvgpr_write_b32 a142, v170
  v_accvgpr_write_b32 a143, v171
  v_accvgpr_read_b32 v180, a172
  v_accvgpr_read_b32 v181, a173
  v_accvgpr_read_b32 v182, a174
  v_accvgpr_read_b32 v183, a175
  v_accvgpr_read_b32 v184, a188
  v_accvgpr_read_b32 v185, a189
  v_accvgpr_read_b32 v186, a190
  v_accvgpr_read_b32 v187, a191
  v_pk_mul_f32 v[180:181], v[180:181], v[178:179] op_sel:[0,1] op_sel_hi:[1,1]
  v_pk_mul_f32 v[182:183], v[182:183], v[178:179] op_sel:[0,1] op_sel_hi:[1,1]
  v_pk_mul_f32 v[184:185], v[184:185], v[178:179] op_sel:[0,1] op_sel_hi:[1,1]
  v_pk_mul_f32 v[186:187], v[186:187], v[178:179] op_sel:[0,1] op_sel_hi:[1,1]
  v_cvt_pk_bf16_f32 v188, v180, v181
  v_cvt_pk_bf16_f32 v189, v182, v183
  v_cvt_pk_bf16_f32 v190, v184, v185
  v_cvt_pk_bf16_f32 v191, v186, v187
  buffer_store_dwordx4 v[188:191], v218, s[24:27], s93 offen offset:1024 sc1
  v_accvgpr_write_b32 a172, v188
  v_accvgpr_write_b32 a173, v189
  v_accvgpr_write_b32 a174, v190
  v_accvgpr_write_b32 a175, v191
  s_add_u32 s93, s93, 192512
  s_waitcnt vmcnt(36)
  s_barrier
  ds_read_b64_tr_b16 a[192:193], v198 offset:0
  ds_read_b64_tr_b16 a[194:195], v198 offset:5120
  ds_read_b64_tr_b16 a[196:197], v199 offset:0
  ds_read_b64_tr_b16 a[198:199], v199 offset:5120
  ds_read_b64_tr_b16 a[200:201], v198 offset:64
  ds_read_b64_tr_b16 a[202:203], v198 offset:5184
  ds_read_b64_tr_b16 a[204:205], v199 offset:64
  ds_read_b64_tr_b16 a[206:207], v199 offset:5184
  s_waitcnt lgkmcnt(6)
  v_mfma_f32_16x16x32_bf16 v[0:3], a[192:195], a[0:3], v[0:3]
  ds_read_b64_tr_b16 a[208:209], v198 offset:128
  v_mfma_f32_16x16x32_bf16 v[40:43], a[192:195], a[4:7], v[40:43]
  v_mfma_f32_16x16x32_bf16 v[80:83], a[192:195], a[8:11], v[80:83]
  s_waitcnt lgkmcnt(5)
  ds_read_b64_tr_b16 a[210:211], v198 offset:5248
  v_mfma_f32_16x16x32_bf16 v[120:123], a[192:195], a[12:15], v[120:123]
  s_mov_b32 m0, s29
  v_mfma_f32_16x16x32_bf16 v[4:7], a[196:199], a[0:3], v[4:7]
  ds_read_b64_tr_b16 a[212:213], v199 offset:128
  v_mfma_f32_16x16x32_bf16 v[44:47], a[196:199], a[4:7], v[44:47]
  v_mfma_f32_16x16x32_bf16 v[84:87], a[196:199], a[8:11], v[84:87]
  s_waitcnt lgkmcnt(5)
  ds_read_b64_tr_b16 a[214:215], v199 offset:5248
  v_mfma_f32_16x16x32_bf16 v[124:127], a[196:199], a[12:15], v[124:127]
  v_mfma_f32_16x16x32_bf16 v[8:11], a[200:203], a[0:3], v[8:11]
  ds_read_b64_tr_b16 a[216:217], v198 offset:192
  v_mfma_f32_16x16x32_bf16 v[48:51], a[200:203], a[4:7], v[48:51]
  buffer_load_dwordx4 v232, s[4:7], s28 offen lds
  v_mfma_f32_16x16x32_bf16 v[88:91], a[200:203], a[8:11], v[88:91]
  s_waitcnt lgkmcnt(5)
  ds_read_b64_tr_b16 a[218:219], v198 offset:5312
  v_mfma_f32_16x16x32_bf16 v[128:131], a[200:203], a[12:15], v[128:131]
  v_mfma_f32_16x16x32_bf16 v[12:15], a[204:207], a[0:3], v[12:15]
  s_add_u32 s32, s32, 1
  ds_read_b64_tr_b16 a[220:221], v199 offset:192
  v_mfma_f32_16x16x32_bf16 v[52:55], a[204:207], a[4:7], v[52:55]
  s_cmp_eq_u32 s32, 6
  s_cselect_b32 s31, s41, s42
  v_mfma_f32_16x16x32_bf16 v[92:95], a[204:207], a[8:11], v[92:95]
  s_waitcnt lgkmcnt(5)
  ds_read_b64_tr_b16 a[222:223], v199 offset:5312
  v_mfma_f32_16x16x32_bf16 v[132:135], a[204:207], a[12:15], v[132:135]
  s_cselect_b32 s32, 0, s32
  v_mfma_f32_16x16x32_bf16 v[16:19], a[208:211], a[0:3], v[16:19]
  ds_read_b64_tr_b16 a[224:225], v198 offset:256
  v_mfma_f32_16x16x32_bf16 v[56:59], a[208:211], a[4:7], v[56:59]
  v_mfma_f32_16x16x32_bf16 v[96:99], a[208:211], a[8:11], v[96:99]
  s_waitcnt lgkmcnt(5)
  ds_read_b64_tr_b16 a[226:227], v198 offset:5376
  v_mfma_f32_16x16x32_bf16 v[136:139], a[208:211], a[12:15], v[136:139]
  buffer_load_dwordx4 v233, s[4:7], s28 offen offset:1024 lds
  v_mfma_f32_16x16x32_bf16 v[20:23], a[212:215], a[0:3], v[20:23]
  ds_read_b64_tr_b16 a[228:229], v199 offset:256
  v_mfma_f32_16x16x32_bf16 v[60:63], a[212:215], a[4:7], v[60:63]
  v_mfma_f32_16x16x32_bf16 v[100:103], a[212:215], a[8:11], v[100:103]
  s_waitcnt lgkmcnt(5)
  ds_read_b64_tr_b16 a[230:231], v199 offset:5376
  v_mfma_f32_16x16x32_bf16 v[140:143], a[212:215], a[12:15], v[140:143]
  v_mfma_f32_16x16x32_bf16 v[24:27], a[216:219], a[0:3], v[24:27]
  ds_read_b64_tr_b16 a[232:233], v198 offset:10240
  v_mfma_f32_16x16x32_bf16 v[64:67], a[216:219], a[4:7], v[64:67]
  v_mfma_f32_16x16x32_bf16 v[104:107], a[216:219], a[8:11], v[104:107]
  s_waitcnt lgkmcnt(5)
  ds_read_b64_tr_b16 a[234:235], v198 offset:15360
  v_mfma_f32_16x16x32_bf16 v[144:147], a[216:219], a[12:15], v[144:147]
  v_mfma_f32_16x16x32_bf16 v[28:31], a[220:223], a[0:3], v[28:31]
  ds_read_b64_tr_b16 a[236:237], v199 offset:10240
  v_mfma_f32_16x16x32_bf16 v[68:71], a[220:223], a[4:7], v[68:71]
  buffer_load_dwordx4 v234, s[4:7], s28 offen offset:2048 lds
  v_mfma_f32_16x16x32_bf16 v[108:111], a[220:223], a[8:11], v[108:111]
  s_waitcnt lgkmcnt(5)
  ds_read_b64_tr_b16 a[238:239], v199 offset:15360
  v_mfma_f32_16x16x32_bf16 v[148:151], a[220:223], a[12:15], v[148:151]
  v_mfma_f32_16x16x32_bf16 v[32:35], a[224:227], a[0:3], v[32:35]
  ds_read_b64_tr_b16 a[192:193], v198 offset:10304
  v_mfma_f32_16x16x32_bf16 v[72:75], a[224:227], a[4:7], v[72:75]
  v_mfma_f32_16x16x32_bf16 v[112:115], a[224:227], a[8:11], v[112:115]
  s_waitcnt lgkmcnt(5)
  ds_read_b64_tr_b16 a[194:195], v198 offset:15424
  v_mfma_f32_16x16x32_bf16 v[152:155], a[224:227], a[12:15], v[152:155]
  v_mfma_f32_16x16x32_bf16 v[36:39], a[228:231], a[0:3], v[36:39]
  ds_read_b64_tr_b16 a[196:197], v199 offset:10304
  v_mfma_f32_16x16x32_bf16 v[76:79], a[228:231], a[4:7], v[76:79]
  v_mfma_f32_16x16x32_bf16 v[116:119], a[228:231], a[8:11], v[116:119]
  s_waitcnt lgkmcnt(5)
  ds_read_b64_tr_b16 a[198:199], v199 offset:15424
  v_mfma_f32_16x16x32_bf16 v[156:159], a[228:231], a[12:15], v[156:159]
  buffer_load_dwordx4 v235, s[4:7], s28 offen offset:3072 lds
  v_mfma_f32_16x16x32_bf16 v[0:3], a[232:235], a[32:35], v[0:3]
  s_add_u32 m0, s29, 4096
  ds_read_b64_tr_b16 a[200:201], v198 offset:10368
  v_mfma_f32_16x16x32_bf16 v[40:43], a[232:235], a[36:39], v[40:43]
  v_mfma_f32_16x16x32_bf16 v[80:83], a[232:235], a[40:43], v[80:83]
  s_waitcnt lgkmcnt(5)
  ds_read_b64_tr_b16 a[202:203], v198 offset:15488
  v_mfma_f32_16x16x32_bf16 v[120:123], a[232:235], a[44:47], v[120:123]
  v_mfma_f32_16x16x32_bf16 v[4:7], a[236:239], a[32:35], v[4:7]
  ds_read_b64_tr_b16 a[204:205], v199 offset:10368
  v_mfma_f32_16x16x32_bf16 v[44:47], a[236:239], a[36:39], v[44:47]
  v_mfma_f32_16x16x32_bf16 v[84:87], a[236:239], a[40:43], v[84:87]
  s_waitcnt lgkmcnt(5)
  ds_read_b64_tr_b16 a[206:207], v199 offset:15488
  v_mfma_f32_16x16x32_bf16 v[124:127], a[236:239], a[44:47], v[124:127]
  v_mfma_f32_16x16x32_bf16 v[8:11], a[192:195], a[32:35], v[8:11]
  ds_read_b64_tr_b16 a[208:209], v198 offset:10432
  v_mfma_f32_16x16x32_bf16 v[48:51], a[192:195], a[36:39], v[48:51]
  buffer_load_dwordx4 v236, s[4:7], s28 offen lds
  v_mfma_f32_16x16x32_bf16 v[88:91], a[192:195], a[40:43], v[88:91]
  s_waitcnt lgkmcnt(5)
  ds_read_b64_tr_b16 a[210:211], v198 offset:15552
  v_mfma_f32_16x16x32_bf16 v[128:131], a[192:195], a[44:47], v[128:131]
  s_add_u32 s28, s28, 81920
  s_cmp_ge_u32 s28, s38
  v_mfma_f32_16x16x32_bf16 v[12:15], a[196:199], a[32:35], v[12:15]
  s_cselect_b32 s40, s92, 0
  ds_read_b64_tr_b16 a[212:213], v199 offset:10432
  v_mfma_f32_16x16x32_bf16 v[52:55], a[196:199], a[36:39], v[52:55]
  s_sub_u32 s28, s28, s40
  s_add_u32 s90, s90, 1
  v_mfma_f32_16x16x32_bf16 v[92:95], a[196:199], a[40:43], v[92:95]
  s_waitcnt lgkmcnt(5)
  ds_read_b64_tr_b16 a[214:215], v199 offset:15552
  v_mfma_f32_16x16x32_bf16 v[132:135], a[196:199], a[44:47], v[132:135]
  s_cmp_lt_u32 s90, 12
  s_cselect_b32 s6, s91, 0
  v_mfma_f32_16x16x32_bf16 v[16:19], a[200:203], a[32:35], v[16:19]
  s_waitcnt vmcnt(5)
  ds_read_b64_tr_b16 a[216:217], v198 offset:10496
  v_mfma_f32_16x16x32_bf16 v[56:59], a[200:203], a[36:39], v[56:59]
  s_add_u32 s30, s30, 1
  s_cmp_eq_u32 s30, 6
  v_mfma_f32_16x16x32_bf16 v[96:99], a[200:203], a[40:43], v[96:99]
  s_waitcnt lgkmcnt(5)
  ds_read_b64_tr_b16 a[218:219], v198 offset:15616
  v_add_u32 v198, s31, v198
  v_mfma_f32_16x16x32_bf16 v[136:139], a[200:203], a[44:47], v[136:139]
  s_cselect_b32 s39, s41, s42
  s_cselect_b32 s30, 0, s30
  v_mfma_f32_16x16x32_bf16 v[20:23], a[204:207], a[32:35], v[20:23]
  s_barrier
  ds_read_b64_tr_b16 a[220:221], v199 offset:10496
  v_mfma_f32_16x16x32_bf16 v[60:63], a[204:207], a[36:39], v[60:63]
  s_add_u32 s29, s29, s39
  v_mfma_f32_16x16x32_bf16 v[100:103], a[204:207], a[40:43], v[100:103]
  s_waitcnt lgkmcnt(5)
  ds_read_b64_tr_b16 a[222:223], v199 offset:15616
  v_add_u32 v199, s31, v199
  v_mfma_f32_16x16x32_bf16 v[140:143], a[204:207], a[44:47], v[140:143]
  v_mfma_f32_16x16x32_bf16 v[24:27], a[208:211], a[32:35], v[24:27]
  ds_read_b64_tr_b16 a[224:225], v198 offset:0
  v_mfma_f32_16x16x32_bf16 v[64:67], a[208:211], a[36:39], v[64:67]
  buffer_store_dword v209, v208, s[84:87], 0 offen sc1
  v_mfma_f32_16x16x32_bf16 v[104:107], a[208:211], a[40:43], v[104:107]
  s_waitcnt lgkmcnt(5)
  ds_read_b64_tr_b16 a[226:227], v198 offset:5120
  v_mfma_f32_16x16x32_bf16 v[144:147], a[208:211], a[44:47], v[144:147]
  v_mfma_f32_16x16x32_bf16 v[28:31], a[212:215], a[32:35], v[28:31]
  ds_read_b64_tr_b16 a[228:229], v199 offset:0
  v_mfma_f32_16x16x32_bf16 v[68:71], a[212:215], a[36:39], v[68:71]
  v_mfma_f32_16x16x32_bf16 v[108:111], a[212:215], a[40:43], v[108:111]
  s_waitcnt lgkmcnt(5)
  ds_read_b64_tr_b16 a[230:231], v199 offset:5120
  v_mfma_f32_16x16x32_bf16 v[148:151], a[212:215], a[44:47], v[148:151]
  v_mfma_f32_16x16x32_bf16 v[32:35], a[216:219], a[32:35], v[32:35]
  ds_read_b64_tr_b16 a[232:233], v198 offset:64
  v_mfma_f32_16x16x32_bf16 v[72:75], a[216:219], a[36:39], v[72:75]
  v_mfma_f32_16x16x32_bf16 v[112:115], a[216:219], a[40:43], v[112:115]
  s_waitcnt lgkmcnt(5)
  ds_read_b64_tr_b16 a[234:235], v198 offset:5184
  v_mfma_f32_16x16x32_bf16 v[152:155], a[216:219], a[44:47], v[152:155]
  v_mfma_f32_16x16x32_bf16 v[36:39], a[220:223], a[32:35], v[36:39]
  ds_read_b64_tr_b16 a[236:237], v199 offset:64
  v_mfma_f32_16x16x32_bf16 v[76:79], a[220:223], a[36:39], v[76:79]
  v_mfma_f32_16x16x32_bf16 v[116:119], a[220:223], a[40:43], v[116:119]
  s_waitcnt lgkmcnt(5)
  ds_read_b64_tr_b16 a[238:239], v199 offset:5184
  v_mfma_f32_16x16x32_bf16 v[156:159], a[220:223], a[44:47], v[156:159]
  v_mfma_f32_16x16x32_bf16 v[0:3], a[224:227], a[64:67], v[0:3]
  ds_read_b64_tr_b16 a[192:193], v198 offset:128
  v_mfma_f32_16x16x32_bf16 v[40:43], a[224:227], a[68:71], v[40:43]
  v_mfma_f32_16x16x32_bf16 v[80:83], a[224:227], a[72:75], v[80:83]
  s_waitcnt lgkmcnt(5)
  ds_read_b64_tr_b16 a[194:195], v198 offset:5248
  v_mfma_f32_16x16x32_bf16 v[120:123], a[224:227], a[76:79], v[120:123]
  s_mov_b32 m0, s29
  v_mfma_f32_16x16x32_bf16 v[4:7], a[228:231], a[64:67], v[4:7]
  ds_read_b64_tr_b16 a[196:197], v199 offset:128
  v_mfma_f32_16x16x32_bf16 v[44:47], a[228:231], a[68:71], v[44:47]
  v_mfma_f32_16x16x32_bf16 v[84:87], a[228:231], a[72:75], v[84:87]
  s_waitcnt lgkmcnt(5)
  ds_read_b64_tr_b16 a[198:199], v199 offset:5248
  v_mfma_f32_16x16x32_bf16 v[124:127], a[228:231], a[76:79], v[124:127]
  v_mfma_f32_16x16x32_bf16 v[8:11], a[232:235], a[64:67], v[8:11]
  ds_read_b64_tr_b16 a[200:201], v198 offset:192
  v_mfma_f32_16x16x32_bf16 v[48:51], a[232:235], a[68:71], v[48:51]
  buffer_load_dwordx4 v232, s[4:7], s28 offen lds
  v_mfma_f32_16x16x32_bf16 v[88:91], a[232:235], a[72:75], v[88:91]
  s_waitcnt lgkmcnt(5)
  ds_read_b64_tr_b16 a[202:203], v198 offset:5312
  v_mfma_f32_16x16x32_bf16 v[128:131], a[232:235], a[76:79], v[128:131]
  v_mfma_f32_16x16x32_bf16 v[12:15], a[236:239], a[64:67], v[12:15]
  s_add_u32 s32, s32, 1
  ds_read_b64_tr_b16 a[204:205], v199 offset:192
  v_mfma_f32_16x16x32_bf16 v[52:55], a[236:239], a[68:71], v[52:55]
  s_cmp_eq_u32 s32, 6
  s_cselect_b32 s31, s41, s42
  v_mfma_f32_16x16x32_bf16 v[92:95], a[236:239], a[72:75], v[92:95]
  s_waitcnt lgkmcnt(5)
  ds_read_b64_tr_b16 a[206:207], v199 offset:5312
  v_mfma_f32_16x16x32_bf16 v[132:135], a[236:239], a[76:79], v[132:135]
  s_cselect_b32 s32, 0, s32
  v_mfma_f32_16x16x32_bf16 v[16:19], a[192:195], a[64:67], v[16:19]
  ds_read_b64_tr_b16 a[208:209], v198 offset:256
  v_mfma_f32_16x16x32_bf16 v[56:59], a[192:195], a[68:71], v[56:59]
  v_mfma_f32_16x16x32_bf16 v[96:99], a[192:195], a[72:75], v[96:99]
  s_waitcnt lgkmcnt(5)
  ds_read_b64_tr_b16 a[210:211], v198 offset:5376
  v_mfma_f32_16x16x32_bf16 v[136:139], a[192:195], a[76:79], v[136:139]
  buffer_load_dwordx4 v233, s[4:7], s28 offen offset:1024 lds
  v_mfma_f32_16x16x32_bf16 v[20:23], a[196:199], a[64:67], v[20:23]
  ds_read_b64_tr_b16 a[212:213], v199 offset:256
  v_mfma_f32_16x16x32_bf16 v[60:63], a[196:199], a[68:71], v[60:63]
  v_mfma_f32_16x16x32_bf16 v[100:103], a[196:199], a[72:75], v[100:103]
  s_waitcnt lgkmcnt(5)
  ds_read_b64_tr_b16 a[214:215], v199 offset:5376
  v_mfma_f32_16x16x32_bf16 v[140:143], a[196:199], a[76:79], v[140:143]
  v_mfma_f32_16x16x32_bf16 v[24:27], a[200:203], a[64:67], v[24:27]
  ds_read_b64_tr_b16 a[216:217], v198 offset:10240
  v_mfma_f32_16x16x32_bf16 v[64:67], a[200:203], a[68:71], v[64:67]
  v_mfma_f32_16x16x32_bf16 v[104:107], a[200:203], a[72:75], v[104:107]
  s_waitcnt lgkmcnt(5)
  ds_read_b64_tr_b16 a[218:219], v198 offset:15360
  v_mfma_f32_16x16x32_bf16 v[144:147], a[200:203], a[76:79], v[144:147]
  v_mfma_f32_16x16x32_bf16 v[28:31], a[204:207], a[64:67], v[28:31]
  ds_read_b64_tr_b16 a[220:221], v199 offset:10240
  v_mfma_f32_16x16x32_bf16 v[68:71], a[204:207], a[68:71], v[68:71]
  buffer_load_dwordx4 v234, s[4:7], s28 offen offset:2048 lds
  v_mfma_f32_16x16x32_bf16 v[108:111], a[204:207], a[72:75], v[108:111]
  s_waitcnt lgkmcnt(5)
  ds_read_b64_tr_b16 a[222:223], v199 offset:15360
  v_mfma_f32_16x16x32_bf16 v[148:151], a[204:207], a[76:79], v[148:151]
  v_mfma_f32_16x16x32_bf16 v[32:35], a[208:211], a[64:67], v[32:35]
  ds_read_b64_tr_b16 a[224:225], v198 offset:10304
  v_mfma_f32_16x16x32_bf16 v[72:75], a[208:211], a[68:71], v[72:75]
  v_mfma_f32_16x16x32_bf16 v[112:115], a[208:211], a[72:75], v[112:115]
  s_waitcnt lgkmcnt(5)
  ds_read_b64_tr_b16 a[226:227], v198 offset:15424
  v_mfma_f32_16x16x32_bf16 v[152:155], a[208:211], a[76:79], v[152:155]
  v_mfma_f32_16x16x32_bf16 v[36:39], a[212:215], a[64:67], v[36:39]
  ds_read_b64_tr_b16 a[228:229], v199 offset:10304
  v_mfma_f32_16x16x32_bf16 v[76:79], a[212:215], a[68:71], v[76:79]
  v_mfma_f32_16x16x32_bf16 v[116:119], a[212:215], a[72:75], v[116:119]
  s_waitcnt lgkmcnt(5)
  ds_read_b64_tr_b16 a[230:231], v199 offset:15424
  v_mfma_f32_16x16x32_bf16 v[156:159], a[212:215], a[76:79], v[156:159]
  buffer_load_dwordx4 v235, s[4:7], s28 offen offset:3072 lds
  v_mfma_f32_16x16x32_bf16 v[0:3], a[216:219], a[96:99], v[0:3]
  s_add_u32 m0, s29, 4096
  ds_read_b64_tr_b16 a[232:233], v198 offset:10368
  v_mfma_f32_16x16x32_bf16 v[40:43], a[216:219], a[100:103], v[40:43]
  v_mfma_f32_16x16x32_bf16 v[80:83], a[216:219], a[104:107], v[80:83]
  s_waitcnt lgkmcnt(5)
  ds_read_b64_tr_b16 a[234:235], v198 offset:15488
  v_mfma_f32_16x16x32_bf16 v[120:123], a[216:219], a[108:111], v[120:123]
  v_mfma_f32_16x16x32_bf16 v[4:7], a[220:223], a[96:99], v[4:7]
  ds_read_b64_tr_b16 a[236:237], v199 offset:10368
  v_mfma_f32_16x16x32_bf16 v[44:47], a[220:223], a[100:103], v[44:47]
  v_mfma_f32_16x16x32_bf16 v[84:87], a[220:223], a[104:107], v[84:87]
  s_waitcnt lgkmcnt(5)
  ds_read_b64_tr_b16 a[238:239], v199 offset:15488
  v_mfma_f32_16x16x32_bf16 v[124:127], a[220:223], a[108:111], v[124:127]
  v_mfma_f32_16x16x32_bf16 v[8:11], a[224:227], a[96:99], v[8:11]
  ds_read_b64_tr_b16 a[192:193], v198 offset:10432
  v_mfma_f32_16x16x32_bf16 v[48:51], a[224:227], a[100:103], v[48:51]
  buffer_load_dwordx4 v236, s[4:7], s28 offen lds
  v_mfma_f32_16x16x32_bf16 v[88:91], a[224:227], a[104:107], v[88:91]
  s_waitcnt lgkmcnt(5)
  ds_read_b64_tr_b16 a[194:195], v198 offset:15552
  v_mfma_f32_16x16x32_bf16 v[128:131], a[224:227], a[108:111], v[128:131]
  s_add_u32 s28, s28, 81920
  s_cmp_ge_u32 s28, s38
  v_mfma_f32_16x16x32_bf16 v[12:15], a[228:231], a[96:99], v[12:15]
  s_cselect_b32 s40, s92, 0
  ds_read_b64_tr_b16 a[196:197], v199 offset:10432
  v_mfma_f32_16x16x32_bf16 v[52:55], a[228:231], a[100:103], v[52:55]
  s_sub_u32 s28, s28, s40
  s_add_u32 s90, s90, 1
  v_mfma_f32_16x16x32_bf16 v[92:95], a[228:231], a[104:107], v[92:95]
  s_waitcnt lgkmcnt(5)
  ds_read_b64_tr_b16 a[198:199], v199 offset:15552
  v_mfma_f32_16x16x32_bf16 v[132:135], a[228:231], a[108:111], v[132:135]
  s_cmp_lt_u32 s90, 12
  s_cselect_b32 s6, s91, 0
  v_mfma_f32_16x16x32_bf16 v[16:19], a[232:235], a[96:99], v[16:19]
  ds_read_b64_tr_b16 a[200:201], v198 offset:10496
  v_mfma_f32_16x16x32_bf16 v[56:59], a[232:235], a[100:103], v[56:59]
  s_add_u32 s30, s30, 1
  s_cmp_eq_u32 s30, 6
  v_mfma_f32_16x16x32_bf16 v[96:99], a[232:235], a[104:107], v[96:99]
  s_waitcnt lgkmcnt(5)
  ds_read_b64_tr_b16 a[202:203], v198 offset:15616
  v_add_u32 v198, s31, v198
  v_mfma_f32_16x16x32_bf16 v[136:139], a[232:235], a[108:111], v[136:139]
  s_cselect_b32 s39, s41, s42
  s_cselect_b32 s30, 0, s30
  v_mfma_f32_16x16x32_bf16 v[20:23], a[236:239], a[96:99], v[20:23]
  s_barrier
  ds_read_b64_tr_b16 a[204:205], v199 offset:10496
  v_mfma_f32_16x16x32_bf16 v[60:63], a[236:239], a[100:103], v[60:63]
  s_add_u32 s29, s29, s39
  v_mfma_f32_16x16x32_bf16 v[100:103], a[236:239], a[104:107], v[100:103]
  s_waitcnt lgkmcnt(5)
  ds_read_b64_tr_b16 a[206:207], v199 offset:15616
  v_add_u32 v199, s31, v199
  v_mfma_f32_16x16x32_bf16 v[140:143], a[236:239], a[108:111], v[140:143]
  v_mfma_f32_16x16x32_bf16 v[24:27], a[192:195], a[96:99], v[24:27]
  ds_read_b64_tr_b16 a[208:209], v198 offset:0
  v_mfma_f32_16x16x32_bf16 v[64:67], a[192:195], a[100:103], v[64:67]
  v_mfma_f32_16x16x32_bf16 v[104:107], a[192:195], a[104:107], v[104:107]
  s_waitcnt lgkmcnt(5)
  ds_read_b64_tr_b16 a[210:211], v198 offset:5120
  v_mfma_f32_16x16x32_bf16 v[144:147], a[192:195], a[108:111], v[144:147]
  v_mfma_f32_16x16x32_bf16 v[28:31], a[196:199], a[96:99], v[28:31]
  ds_read_b64_tr_b16 a[212:213], v199 offset:0
  v_mfma_f32_16x16x32_bf16 v[68:71], a[196:199], a[100:103], v[68:71]
  v_mfma_f32_16x16x32_bf16 v[108:111], a[196:199], a[104:107], v[108:111]
  s_waitcnt lgkmcnt(5)
  ds_read_b64_tr_b16 a[214:215], v199 offset:5120
  v_mfma_f32_16x16x32_bf16 v[148:151], a[196:199], a[108:111], v[148:151]
  v_mfma_f32_16x16x32_bf16 v[32:35], a[200:203], a[96:99], v[32:35]
  ds_read_b64_tr_b16 a[216:217], v198 offset:64
  v_mfma_f32_16x16x32_bf16 v[72:75], a[200:203], a[100:103], v[72:75]
  v_mfma_f32_16x16x32_bf16 v[112:115], a[200:203], a[104:107], v[112:115]
  s_waitcnt lgkmcnt(5)
  ds_read_b64_tr_b16 a[218:219], v198 offset:5184
  v_mfma_f32_16x16x32_bf16 v[152:155], a[200:203], a[108:111], v[152:155]
  v_mfma_f32_16x16x32_bf16 v[36:39], a[204:207], a[96:99], v[36:39]
  ds_read_b64_tr_b16 a[220:221], v199 offset:64
  v_mfma_f32_16x16x32_bf16 v[76:79], a[204:207], a[100:103], v[76:79]
  s_mov_b32 m0, s29
  v_mfma_f32_16x16x32_bf16 v[116:119], a[204:207], a[104:107], v[116:119]
  s_waitcnt lgkmcnt(5)
  ds_read_b64_tr_b16 a[222:223], v199 offset:5184
  v_mfma_f32_16x16x32_bf16 v[156:159], a[204:207], a[108:111], v[156:159]
  v_mfma_f32_16x16x32_bf16 v[0:3], a[208:211], a[128:131], v[0:3]
  ds_read_b64_tr_b16 a[224:225], v198 offset:128
  v_mfma_f32_16x16x32_bf16 v[40:43], a[208:211], a[132:135], v[40:43]
  v_mfma_f32_16x16x32_bf16 v[80:83], a[208:211], a[136:139], v[80:83]
  s_waitcnt lgkmcnt(5)
  ds_read_b64_tr_b16 a[226:227], v198 offset:5248
  v_mfma_f32_16x16x32_bf16 v[120:123], a[208:211], a[140:143], v[120:123]
  buffer_load_dwordx4 v232, s[4:7], s28 offen lds
  v_mfma_f32_16x16x32_bf16 v[4:7], a[212:215], a[128:131], v[4:7]
  ds_read_b64_tr_b16 a[228:229], v199 offset:128
  v_mfma_f32_16x16x32_bf16 v[44:47], a[212:215], a[132:135], v[44:47]
  v_mfma_f32_16x16x32_bf16 v[84:87], a[212:215], a[136:139], v[84:87]
  s_waitcnt lgkmcnt(5)
  ds_read_b64_tr_b16 a[230:231], v199 offset:5248
  v_mfma_f32_16x16x32_bf16 v[124:127], a[212:215], a[140:143], v[124:127]
  v_mfma_f32_16x16x32_bf16 v[8:11], a[216:219], a[128:131], v[8:11]
  ds_read_b64_tr_b16 a[232:233], v198 offset:192
  v_mfma_f32_16x16x32_bf16 v[48:51], a[216:219], a[132:135], v[48:51]
  buffer_load_dwordx4 v233, s[4:7], s28 offen offset:1024 lds
  v_mfma_f32_16x16x32_bf16 v[88:91], a[216:219], a[136:139], v[88:91]
  s_waitcnt lgkmcnt(5)
  ds_read_b64_tr_b16 a[234:235], v198 offset:5312
  v_mfma_f32_16x16x32_bf16 v[128:131], a[216:219], a[140:143], v[128:131]
  v_mfma_f32_16x16x32_bf16 v[12:15], a[220:223], a[128:131], v[12:15]
  s_add_u32 s32, s32, 1
  ds_read_b64_tr_b16 a[236:237], v199 offset:192
  v_mfma_f32_16x16x32_bf16 v[52:55], a[220:223], a[132:135], v[52:55]
  s_cmp_eq_u32 s32, 6
  s_cselect_b32 s31, s41, s42
  v_mfma_f32_16x16x32_bf16 v[92:95], a[220:223], a[136:139], v[92:95]
  s_waitcnt lgkmcnt(5)
  ds_read_b64_tr_b16 a[238:239], v199 offset:5312
  v_mfma_f32_16x16x32_bf16 v[132:135], a[220:223], a[140:143], v[132:135]
  buffer_load_dwordx4 v234, s[4:7], s28 offen offset:2048 lds
  v_mfma_f32_16x16x32_bf16 v[16:19], a[224:227], a[128:131], v[16:19]
  s_cselect_b32 s32, 0, s32
  ds_read_b64_tr_b16 a[192:193], v198 offset:256
  v_mfma_f32_16x16x32_bf16 v[56:59], a[224:227], a[132:135], v[56:59]
  v_mfma_f32_16x16x32_bf16 v[96:99], a[224:227], a[136:139], v[96:99]
  s_waitcnt lgkmcnt(5)
  ds_read_b64_tr_b16 a[194:195], v198 offset:5376
  v_mfma_f32_16x16x32_bf16 v[136:139], a[224:227], a[140:143], v[136:139]
  buffer_load_dword v212, v210, s[20:23], 0 offen sc1
  v_mfma_f32_16x16x32_bf16 v[20:23], a[228:231], a[128:131], v[20:23]
  ds_read_b64_tr_b16 a[196:197], v199 offset:256
  v_mfma_f32_16x16x32_bf16 v[60:63], a[228:231], a[132:135], v[60:63]
  v_mfma_f32_16x16x32_bf16 v[100:103], a[228:231], a[136:139], v[100:103]
  s_waitcnt lgkmcnt(5)
  ds_read_b64_tr_b16 a[198:199], v199 offset:5376
  v_mfma_f32_16x16x32_bf16 v[140:143], a[228:231], a[140:143], v[140:143]
  v_mfma_f32_16x16x32_bf16 v[24:27], a[232:235], a[128:131], v[24:27]
  ds_read_b64_tr_b16 a[200:201], v198 offset:10240
  v_mfma_f32_16x16x32_bf16 v[64:67], a[232:235], a[132:135], v[64:67]
  buffer_load_dwordx4 v235, s[4:7], s28 offen offset:3072 lds
  v_mfma_f32_16x16x32_bf16 v[104:107], a[232:235], a[136:139], v[104:107]
  s_waitcnt lgkmcnt(5)
  ds_read_b64_tr_b16 a[202:203], v198 offset:15360
  v_mfma_f32_16x16x32_bf16 v[144:147], a[232:235], a[140:143], v[144:147]
  s_add_u32 m0, s29, 4096
  v_mfma_f32_16x16x32_bf16 v[28:31], a[236:239], a[128:131], v[28:31]
  ds_read_b64_tr_b16 a[204:205], v199 offset:10240
  v_mfma_f32_16x16x32_bf16 v[68:71], a[236:239], a[132:135], v[68:71]
  v_mfma_f32_16x16x32_bf16 v[108:111], a[236:239], a[136:139], v[108:111]
  s_waitcnt lgkmcnt(5)
  ds_read_b64_tr_b16 a[206:207], v199 offset:15360
  v_mfma_f32_16x16x32_bf16 v[148:151], a[236:239], a[140:143], v[148:151]
  buffer_load_dwordx4 v236, s[4:7], s28 offen lds
  v_mfma_f32_16x16x32_bf16 v[32:35], a[192:195], a[128:131], v[32:35]
  s_waitcnt vmcnt(2)
  ds_read_b64_tr_b16 a[208:209], v198 offset:10304
  v_cmp_ne_u32 vcc, v211, v212
  v_mfma_f32_16x16x32_bf16 v[72:75], a[192:195], a[132:135], v[72:75]
  s_add_u32 s28, s28, 81920
  s_cmp_ge_u32 s28, s38
  v_mfma_f32_16x16x32_bf16 v[112:115], a[192:195], a[136:139], v[112:115]
  s_waitcnt lgkmcnt(5)
  ds_read_b64_tr_b16 a[210:211], v198 offset:15424
  v_mfma_f32_16x16x32_bf16 v[152:155], a[192:195], a[140:143], v[152:155]
  s_cselect_b32 s40, s92, 0
  s_sub_u32 s28, s28, s40
  v_mfma_f32_16x16x32_bf16 v[36:39], a[196:199], a[128:131], v[36:39]
  s_add_u32 s90, s90, 1
  ds_read_b64_tr_b16 a[212:213], v199 offset:10304
  v_mfma_f32_16x16x32_bf16 v[76:79], a[196:199], a[132:135], v[76:79]
  s_cmp_lt_u32 s90, 12
  s_cselect_b32 s6, s91, 0
  v_mfma_f32_16x16x32_bf16 v[116:119], a[196:199], a[136:139], v[116:119]
  s_waitcnt lgkmcnt(5)
  ds_read_b64_tr_b16 a[214:215], v199 offset:15424
  v_mfma_f32_16x16x32_bf16 v[156:159], a[196:199], a[140:143], v[156:159]
  s_cmp_lg_u64 vcc, 0
  s_cbranch_scc1 adaLN_cond__sliding_block_cached__glu_gated_swiglu__prompt_kernel_d_slow
adaLN_cond__sliding_block_cached__glu_gated_swiglu__prompt_kernel_d_back:
  v_mfma_f32_16x16x32_bf16 v[0:3], a[200:203], a[160:163], v[0:3]
  ds_read_b64_tr_b16 a[216:217], v198 offset:10368
  v_mfma_f32_16x16x32_bf16 v[40:43], a[200:203], a[164:167], v[40:43]
  v_mfma_f32_16x16x32_bf16 v[80:83], a[200:203], a[168:171], v[80:83]
  s_waitcnt lgkmcnt(5)
  ds_read_b64_tr_b16 a[218:219], v198 offset:15488
  v_mfma_f32_16x16x32_bf16 v[120:123], a[200:203], a[172:175], v[120:123]
  v_mfma_f32_16x16x32_bf16 v[4:7], a[204:207], a[160:163], v[4:7]
  ds_read_b64_tr_b16 a[220:221], v199 offset:10368
  v_mfma_f32_16x16x32_bf16 v[44:47], a[204:207], a[164:167], v[44:47]
  buffer_load_dwordx4 a[16:19], v204, s[8:11], s34 offen sc1
  v_mfma_f32_16x16x32_bf16 v[84:87], a[204:207], a[168:171], v[84:87]
  s_waitcnt lgkmcnt(5)
  ds_read_b64_tr_b16 a[222:223], v199 offset:15488
  v_mfma_f32_16x16x32_bf16 v[124:127], a[204:207], a[172:175], v[124:127]
  buffer_load_dwordx4 a[20:23], v205, s[8:11], s34 offen sc1
  v_mfma_f32_16x16x32_bf16 v[8:11], a[208:211], a[160:163], v[8:11]
  ds_read_b64_tr_b16 a[224:225], v198 offset:10432
  v_mfma_f32_16x16x32_bf16 v[48:51], a[208:211], a[164:167], v[48:51]
  buffer_load_dwordx4 a[24:27], v206, s[8:11], s34 offen sc1
  v_mfma_f32_16x16x32_bf16 v[88:91], a[208:211], a[168:171], v[88:91]
  s_waitcnt lgkmcnt(5)
  ds_read_b64_tr_b16 a[226:227], v198 offset:15552
  v_mfma_f32_16x16x32_bf16 v[128:131], a[208:211], a[172:175], v[128:131]
  buffer_load_dwordx4 a[28:31], v207, s[8:11], s34 offen sc1
  v_mfma_f32_16x16x32_bf16 v[12:15], a[212:215], a[160:163], v[12:15]
  ds_read_b64_tr_b16 a[228:229], v199 offset:10432
  v_mfma_f32_16x16x32_bf16 v[52:55], a[212:215], a[164:167], v[52:55]
  buffer_load_dwordx4 a[48:51], v204, s[8:11], s34 offen offset:1024 sc1
  v_mfma_f32_16x16x32_bf16 v[92:95], a[212:215], a[168:171], v[92:95]
  s_waitcnt lgkmcnt(5)
  ds_read_b64_tr_b16 a[230:231], v199 offset:15552
  v_mfma_f32_16x16x32_bf16 v[132:135], a[212:215], a[172:175], v[132:135]
  buffer_load_dwordx4 a[52:55], v205, s[8:11], s34 offen offset:1024 sc1
  v_mfma_f32_16x16x32_bf16 v[16:19], a[216:219], a[160:163], v[16:19]
  ds_read_b64_tr_b16 a[232:233], v198 offset:10496
  v_mfma_f32_16x16x32_bf16 v[56:59], a[216:219], a[164:167], v[56:59]
  buffer_load_dwordx4 a[56:59], v206, s[8:11], s34 offen offset:1024 sc1
  v_mfma_f32_16x16x32_bf16 v[96:99], a[216:219], a[168:171], v[96:99]
  s_waitcnt lgkmcnt(5)
  ds_read_b64_tr_b16 a[234:235], v198 offset:15616
  v_add_u32 v198, s31, v198
  v_mfma_f32_16x16x32_bf16 v[136:139], a[216:219], a[172:175], v[136:139]
  buffer_load_dwordx4 a[60:63], v207, s[8:11], s34 offen offset:1024 sc1
  v_mfma_f32_16x16x32_bf16 v[20:23], a[220:223], a[160:163], v[20:23]
  s_barrier
  ds_read_b64_tr_b16 a[236:237], v199 offset:10496
  v_mfma_f32_16x16x32_bf16 v[60:63], a[220:223], a[164:167], v[60:63]
  buffer_load_dwordx4 a[80:83], v204, s[8:11], s34 offen offset:2048 sc1
  v_mfma_f32_16x16x32_bf16 v[100:103], a[220:223], a[168:171], v[100:103]
  s_waitcnt lgkmcnt(5)
  ds_read_b64_tr_b16 a[238:239], v199 offset:15616
  v_add_u32 v199, s31, v199
  v_mfma_f32_16x16x32_bf16 v[140:143], a[220:223], a[172:175], v[140:143]
  buffer_load_dwordx4 a[84:87], v205, s[8:11], s34 offen offset:2048 sc1
  v_mfma_f32_16x16x32_bf16 v[24:27], a[224:227], a[160:163], v[24:27]
  s_add_u32 s30, s30, 1
  ds_read_b64_tr_b16 a[192:193], v198 offset:0
  v_mfma_f32_16x16x32_bf16 v[64:67], a[224:227], a[164:167], v[64:67]
  buffer_load_dwordx4 a[88:91], v206, s[8:11], s34 offen offset:2048 sc1
  v_mfma_f32_16x16x32_bf16 v[104:107], a[224:227], a[168:171], v[104:107]
  s_waitcnt lgkmcnt(5)
  ds_read_b64_tr_b16 a[194:195], v198 offset:5120
  v_mfma_f32_16x16x32_bf16 v[144:147], a[224:227], a[172:175], v[144:147]
  buffer_load_dwordx4 a[92:95], v207, s[8:11], s34 offen offset:2048 sc1
  v_mfma_f32_16x16x32_bf16 v[28:31], a[228:231], a[160:163], v[28:31]
  s_cmp_eq_u32 s30, 6
  ds_read_b64_tr_b16 a[196:197], v199 offset:0
  v_mfma_f32_16x16x32_bf16 v[68:71], a[228:231], a[164:167], v[68:71]
  s_cselect_b32 s39, s41, s42
  s_cselect_b32 s30, 0, s30
  v_mfma_f32_16x16x32_bf16 v[108:111], a[228:231], a[168:171], v[108:111]
  s_waitcnt lgkmcnt(5)
  ds_read_b64_tr_b16 a[198:199], v199 offset:5120
  v_mfma_f32_16x16x32_bf16 v[148:151], a[228:231], a[172:175], v[148:151]
  s_add_u32 s29, s29, s39
  s_add_u32 s34, s34, 3072
  v_mfma_f32_16x16x32_bf16 v[32:35], a[232:235], a[160:163], v[32:35]
  ds_read_b64_tr_b16 a[200:201], v198 offset:64
  v_mfma_f32_16x16x32_bf16 v[72:75], a[232:235], a[164:167], v[72:75]
  v_mfma_f32_16x16x32_bf16 v[112:115], a[232:235], a[168:171], v[112:115]
  s_waitcnt lgkmcnt(5)
  ds_read_b64_tr_b16 a[202:203], v198 offset:5184
  v_mfma_f32_16x16x32_bf16 v[152:155], a[232:235], a[172:175], v[152:155]
  v_mfma_f32_16x16x32_bf16 v[36:39], a[236:239], a[160:163], v[36:39]
  ds_read_b64_tr_b16 a[204:205], v199 offset:64
  v_mfma_f32_16x16x32_bf16 v[76:79], a[236:239], a[164:167], v[76:79]
  v_mfma_f32_16x16x32_bf16 v[116:119], a[236:239], a[168:171], v[116:119]
  s_waitcnt vmcnt(8) lgkmcnt(5)
  ds_read_b64_tr_b16 a[206:207], v199 offset:5184
  v_mfma_f32_16x16x32_bf16 v[156:159], a[236:239], a[172:175], v[156:159]
  s_mov_b32 s33, 3
adaLN_cond__sliding_block_cached__glu_gated_swiglu__prompt_kernel_d_loop:
  v_mfma_f32_16x16x32_bf16 v[0:3], a[192:195], a[16:19], v[0:3]
  ds_read_b64_tr_b16 a[208:209], v198 offset:128
  v_mfma_f32_16x16x32_bf16 v[40:43], a[192:195], a[20:23], v[40:43]
  buffer_load_dwordx4 a[112:115], v204, s[8:11], s34 offen sc1
  v_mfma_f32_16x16x32_bf16 v[80:83], a[192:195], a[24:27], v[80:83]
  s_waitcnt lgkmcnt(5)
  ds_read_b64_tr_b16 a[210:211], v198 offset:5248
  v_mfma_f32_16x16x32_bf16 v[120:123], a[192:195], a[28:31], v[120:123]
  buffer_load_dwordx4 a[116:119], v205, s[8:11], s34 offen sc1
  v_mfma_f32_16x16x32_bf16 v[4:7], a[196:199], a[16:19], v[4:7]
  s_mov_b32 m0, s29
  ds_read_b64_tr_b16 a[212:213], v199 offset:128
  v_mfma_f32_16x16x32_bf16 v[44:47], a[196:199], a[20:23], v[44:47]
  buffer_load_dwordx4 a[120:123], v206, s[8:11], s34 offen sc1
  v_mfma_f32_16x16x32_bf16 v[84:87], a[196:199], a[24:27], v[84:87]
  s_waitcnt lgkmcnt(5)
  ds_read_b64_tr_b16 a[214:215], v199 offset:5248
  v_mfma_f32_16x16x32_bf16 v[124:127], a[196:199], a[28:31], v[124:127]
  buffer_load_dwordx4 a[124:127], v207, s[8:11], s34 offen sc1
  v_mfma_f32_16x16x32_bf16 v[8:11], a[200:203], a[16:19], v[8:11]
  s_add_u32 s34, s34, 1024
  ds_read_b64_tr_b16 a[216:217], v198 offset:192
  v_mfma_f32_16x16x32_bf16 v[48:51], a[200:203], a[20:23], v[48:51]
  buffer_load_dwordx4 v232, s[4:7], s28 offen lds
  v_mfma_f32_16x16x32_bf16 v[88:91], a[200:203], a[24:27], v[88:91]
  s_waitcnt lgkmcnt(5)
  ds_read_b64_tr_b16 a[218:219], v198 offset:5312
  v_mfma_f32_16x16x32_bf16 v[128:131], a[200:203], a[28:31], v[128:131]
  v_mfma_f32_16x16x32_bf16 v[12:15], a[204:207], a[16:19], v[12:15]
  s_add_u32 s32, s32, 1
  ds_read_b64_tr_b16 a[220:221], v199 offset:192
  v_mfma_f32_16x16x32_bf16 v[52:55], a[204:207], a[20:23], v[52:55]
  s_cmp_eq_u32 s32, 6
  s_cselect_b32 s31, s41, s42
  v_mfma_f32_16x16x32_bf16 v[92:95], a[204:207], a[24:27], v[92:95]
  s_waitcnt lgkmcnt(5)
  ds_read_b64_tr_b16 a[222:223], v199 offset:5312
  v_mfma_f32_16x16x32_bf16 v[132:135], a[204:207], a[28:31], v[132:135]
  s_cselect_b32 s32, 0, s32
  v_mfma_f32_16x16x32_bf16 v[16:19], a[208:211], a[16:19], v[16:19]
  ds_read_b64_tr_b16 a[224:225], v198 offset:256
  v_mfma_f32_16x16x32_bf16 v[56:59], a[208:211], a[20:23], v[56:59]
  buffer_load_dwordx4 v233, s[4:7], s28 offen offset:1024 lds
  v_mfma_f32_16x16x32_bf16 v[96:99], a[208:211], a[24:27], v[96:99]
  s_waitcnt lgkmcnt(5)
  ds_read_b64_tr_b16 a[226:227], v198 offset:5376
  v_mfma_f32_16x16x32_bf16 v[136:139], a[208:211], a[28:31], v[136:139]
  v_mfma_f32_16x16x32_bf16 v[20:23], a[212:215], a[16:19], v[20:23]
  ds_read_b64_tr_b16 a[228:229], v199 offset:256
  v_mfma_f32_16x16x32_bf16 v[60:63], a[212:215], a[20:23], v[60:63]
  v_mfma_f32_16x16x32_bf16 v[100:103], a[212:215], a[24:27], v[100:103]
  s_waitcnt lgkmcnt(5)
  ds_read_b64_tr_b16 a[230:231], v199 offset:5376
  v_mfma_f32_16x16x32_bf16 v[140:143], a[212:215], a[28:31], v[140:143]
  v_mfma_f32_16x16x32_bf16 v[24:27], a[216:219], a[16:19], v[24:27]
  ds_read_b64_tr_b16 a[232:233], v198 offset:10240
  v_mfma_f32_16x16x32_bf16 v[64:67], a[216:219], a[20:23], v[64:67]
  buffer_load_dwordx4 v234, s[4:7], s28 offen offset:2048 lds
  v_mfma_f32_16x16x32_bf16 v[104:107], a[216:219], a[24:27], v[104:107]
  s_waitcnt lgkmcnt(5)
  ds_read_b64_tr_b16 a[234:235], v198 offset:15360
  v_mfma_f32_16x16x32_bf16 v[144:147], a[216:219], a[28:31], v[144:147]
  v_mfma_f32_16x16x32_bf16 v[28:31], a[220:223], a[16:19], v[28:31]
  ds_read_b64_tr_b16 a[236:237], v199 offset:10240
  v_mfma_f32_16x16x32_bf16 v[68:71], a[220:223], a[20:23], v[68:71]
  v_mfma_f32_16x16x32_bf16 v[108:111], a[220:223], a[24:27], v[108:111]
  s_waitcnt lgkmcnt(5)
  ds_read_b64_tr_b16 a[238:239], v199 offset:15360
  v_mfma_f32_16x16x32_bf16 v[148:151], a[220:223], a[28:31], v[148:151]
  v_mfma_f32_16x16x32_bf16 v[32:35], a[224:227], a[16:19], v[32:35]
  ds_read_b64_tr_b16 a[192:193], v198 offset:10304
  v_mfma_f32_16x16x32_bf16 v[72:75], a[224:227], a[20:23], v[72:75]
  buffer_load_dwordx4 v235, s[4:7], s28 offen offset:3072 lds
  v_mfma_f32_16x16x32_bf16 v[112:115], a[224:227], a[24:27], v[112:115]
  s_waitcnt lgkmcnt(5)
  ds_read_b64_tr_b16 a[194:195], v198 offset:15424
  v_mfma_f32_16x16x32_bf16 v[152:155], a[224:227], a[28:31], v[152:155]
  s_add_u32 m0, s29, 4096
  v_mfma_f32_16x16x32_bf16 v[36:39], a[228:231], a[16:19], v[36:39]
  ds_read_b64_tr_b16 a[196:197], v199 offset:10304
  v_mfma_f32_16x16x32_bf16 v[76:79], a[228:231], a[20:23], v[76:79]
  v_mfma_f32_16x16x32_bf16 v[116:119], a[228:231], a[24:27], v[116:119]
  s_waitcnt vmcnt(12) lgkmcnt(5)
  ds_read_b64_tr_b16 a[198:199], v199 offset:15424
  v_mfma_f32_16x16x32_bf16 v[156:159], a[228:231], a[28:31], v[156:159]
  v_mfma_f32_16x16x32_bf16 v[0:3], a[232:235], a[48:51], v[0:3]
  ds_read_b64_tr_b16 a[200:201], v198 offset:10368
  v_mfma_f32_16x16x32_bf16 v[40:43], a[232:235], a[52:55], v[40:43]
  buffer_load_dwordx4 a[144:147], v204, s[8:11], s34 offen sc1
  v_mfma_f32_16x16x32_bf16 v[80:83], a[232:235], a[56:59], v[80:83]
  s_waitcnt lgkmcnt(5)
  ds_read_b64_tr_b16 a[202:203], v198 offset:15488
  v_mfma_f32_16x16x32_bf16 v[120:123], a[232:235], a[60:63], v[120:123]
  buffer_load_dwordx4 a[148:151], v205, s[8:11], s34 offen sc1
  v_mfma_f32_16x16x32_bf16 v[4:7], a[236:239], a[48:51], v[4:7]
  ds_read_b64_tr_b16 a[204:205], v199 offset:10368
  v_mfma_f32_16x16x32_bf16 v[44:47], a[236:239], a[52:55], v[44:47]
  buffer_load_dwordx4 a[152:155], v206, s[8:11], s34 offen sc1
  v_mfma_f32_16x16x32_bf16 v[84:87], a[236:239], a[56:59], v[84:87]
  s_waitcnt lgkmcnt(5)
  ds_read_b64_tr_b16 a[206:207], v199 offset:15488
  v_mfma_f32_16x16x32_bf16 v[124:127], a[236:239], a[60:63], v[124:127]
  buffer_load_dwordx4 a[156:159], v207, s[8:11], s34 offen sc1
  v_mfma_f32_16x16x32_bf16 v[8:11], a[192:195], a[48:51], v[8:11]
  s_add_u32 s34, s34, 1024
  ds_read_b64_tr_b16 a[208:209], v198 offset:10432
  v_mfma_f32_16x16x32_bf16 v[48:51], a[192:195], a[52:55], v[48:51]
  buffer_load_dwordx4 v236, s[4:7], s28 offen lds
  v_mfma_f32_16x16x32_bf16 v[88:91], a[192:195], a[56:59], v[88:91]
  s_waitcnt lgkmcnt(5)
  ds_read_b64_tr_b16 a[210:211], v198 offset:15552
  v_mfma_f32_16x16x32_bf16 v[128:131], a[192:195], a[60:63], v[128:131]
  s_add_u32 s28, s28, 81920
  s_cmp_ge_u32 s28, s38
  v_mfma_f32_16x16x32_bf16 v[12:15], a[196:199], a[48:51], v[12:15]
  s_cselect_b32 s40, s92, 0
  ds_read_b64_tr_b16 a[212:213], v199 offset:10432
  v_mfma_f32_16x16x32_bf16 v[52:55], a[196:199], a[52:55], v[52:55]
  s_sub_u32 s28, s28, s40
  s_add_u32 s90, s90, 1
  v_mfma_f32_16x16x32_bf16 v[92:95], a[196:199], a[56:59], v[92:95]
  s_waitcnt lgkmcnt(5)
  ds_read_b64_tr_b16 a[214:215], v199 offset:15552
  v_mfma_f32_16x16x32_bf16 v[132:135], a[196:199], a[60:63], v[132:135]
  s_cmp_lt_u32 s90, 12
  s_cselect_b32 s6, s91, 0
  v_mfma_f32_16x16x32_bf16 v[16:19], a[200:203], a[48:51], v[16:19]
  ds_read_b64_tr_b16 a[216:217], v198 offset:10496
  v_mfma_f32_16x16x32_bf16 v[56:59], a[200:203], a[52:55], v[56:59]
  s_add_u32 s30, s30, 1
  s_cmp_eq_u32 s30, 6
  v_mfma_f32_16x16x32_bf16 v[96:99], a[200:203], a[56:59], v[96:99]
  s_waitcnt lgkmcnt(5)
  ds_read_b64_tr_b16 a[218:219], v198 offset:15616
  v_add_u32 v198, s31, v198
  v_mfma_f32_16x16x32_bf16 v[136:139], a[200:203], a[60:63], v[136:139]
  s_cselect_b32 s39, s41, s42
  s_cselect_b32 s30, 0, s30
  v_mfma_f32_16x16x32_bf16 v[20:23], a[204:207], a[48:51], v[20:23]
  s_barrier
  ds_read_b64_tr_b16 a[220:221], v199 offset:10496
  v_mfma_f32_16x16x32_bf16 v[60:63], a[204:207], a[52:55], v[60:63]
  s_add_u32 s29, s29, s39
  v_mfma_f32_16x16x32_bf16 v[100:103], a[204:207], a[56:59], v[100:103]
  s_waitcnt lgkmcnt(5)
  ds_read_b64_tr_b16 a[222:223], v199 offset:15616
  v_add_u32 v199, s31, v199
  v_mfma_f32_16x16x32_bf16 v[140:143], a[204:207], a[60:63], v[140:143]
  v_mfma_f32_16x16x32_bf16 v[24:27], a[208:211], a[48:51], v[24:27]
  ds_read_b64_tr_b16 a[224:225], v198 offset:0
  v_mfma_f32_16x16x32_bf16 v[64:67], a[208:211], a[52:55], v[64:67]
  v_mfma_f32_16x16x32_bf16 v[104:107], a[208:211], a[56:59], v[104:107]
  s_waitcnt lgkmcnt(5)
  ds_read_b64_tr_b16 a[226:227], v198 offset:5120
  v_mfma_f32_16x16x32_bf16 v[144:147], a[208:211], a[60:63], v[144:147]
  v_mfma_f32_16x16x32_bf16 v[28:31], a[212:215], a[48:51], v[28:31]
  ds_read_b64_tr_b16 a[228:229], v199 offset:0
  v_mfma_f32_16x16x32_bf16 v[68:71], a[212:215], a[52:55], v[68:71]
  v_mfma_f32_16x16x32_bf16 v[108:111], a[212:215], a[56:59], v[108:111]
  s_waitcnt lgkmcnt(5)
  ds_read_b64_tr_b16 a[230:231], v199 offset:5120
  v_mfma_f32_16x16x32_bf16 v[148:151], a[212:215], a[60:63], v[148:151]
  v_mfma_f32_16x16x32_bf16 v[32:35], a[216:219], a[48:51], v[32:35]
  ds_read_b64_tr_b16 a[232:233], v198 offset:64
  v_mfma_f32_16x16x32_bf16 v[72:75], a[216:219], a[52:55], v[72:75]
  v_mfma_f32_16x16x32_bf16 v[112:115], a[216:219], a[56:59], v[112:115]
  s_waitcnt lgkmcnt(5)
  ds_read_b64_tr_b16 a[234:235], v198 offset:5184
  v_mfma_f32_16x16x32_bf16 v[152:155], a[216:219], a[60:63], v[152:155]
  v_mfma_f32_16x16x32_bf16 v[36:39], a[220:223], a[48:51], v[36:39]
  ds_read_b64_tr_b16 a[236:237], v199 offset:64
  v_mfma_f32_16x16x32_bf16 v[76:79], a[220:223], a[52:55], v[76:79]
  v_mfma_f32_16x16x32_bf16 v[116:119], a[220:223], a[56:59], v[116:119]
  s_waitcnt vmcnt(13) lgkmcnt(5)
  ds_read_b64_tr_b16 a[238:239], v199 offset:5184
  v_mfma_f32_16x16x32_bf16 v[156:159], a[220:223], a[60:63], v[156:159]
  v_mfma_f32_16x16x32_bf16 v[0:3], a[224:227], a[80:83], v[0:3]
  ds_read_b64_tr_b16 a[192:193], v198 offset:128
  v_mfma_f32_16x16x32_bf16 v[40:43], a[224:227], a[84:87], v[40:43]
  buffer_load_dwordx4 a[176:179], v204, s[8:11], s34 offen sc1
  v_mfma_f32_16x16x32_bf16 v[80:83], a[224:227], a[88:91], v[80:83]
  s_waitcnt lgkmcnt(5)
  ds_read_b64_tr_b16 a[194:195], v198 offset:5248
  v_mfma_f32_16x16x32_bf16 v[120:123], a[224:227], a[92:95], v[120:123]
  buffer_load_dwordx4 a[180:183], v205, s[8:11], s34 offen sc1
  v_mfma_f32_16x16x32_bf16 v[4:7], a[228:231], a[80:83], v[4:7]
  s_mov_b32 m0, s29
  ds_read_b64_tr_b16 a[196:197], v199 offset:128
  v_mfma_f32_16x16x32_bf16 v[44:47], a[228:231], a[84:87], v[44:47]
  buffer_load_dwordx4 a[184:187], v206, s[8:11], s34 offen sc1
  v_mfma_f32_16x16x32_bf16 v[84:87], a[228:231], a[88:91], v[84:87]
  s_waitcnt lgkmcnt(5)
  ds_read_b64_tr_b16 a[198:199], v199 offset:5248
  v_mfma_f32_16x16x32_bf16 v[124:127], a[228:231], a[92:95], v[124:127]
  buffer_load_dwordx4 a[188:191], v207, s[8:11], s34 offen sc1
  v_mfma_f32_16x16x32_bf16 v[8:11], a[232:235], a[80:83], v[8:11]
  s_add_u32 s89, s89, 1
  ds_read_b64_tr_b16 a[200:201], v198 offset:192
  v_mfma_f32_16x16x32_bf16 v[48:51], a[232:235], a[84:87], v[48:51]
  buffer_load_dwordx4 v232, s[4:7], s28 offen lds
  v_mfma_f32_16x16x32_bf16 v[88:91], a[232:235], a[88:91], v[88:91]
  s_waitcnt lgkmcnt(5)
  ds_read_b64_tr_b16 a[202:203], v198 offset:5312
  v_mfma_f32_16x16x32_bf16 v[128:131], a[232:235], a[92:95], v[128:131]
  s_and_b32 s89, s89, 3
  s_mul_i32 s34, s89, 6144
  v_mfma_f32_16x16x32_bf16 v[12:15], a[236:239], a[80:83], v[12:15]
  s_add_u32 s34, s34, s88
  ds_read_b64_tr_b16 a[204:205], v199 offset:192
  v_mfma_f32_16x16x32_bf16 v[52:55], a[236:239], a[84:87], v[52:55]
  s_cmp_gt_u32 s33, 1
  s_cselect_b32 s10, s43, 0
  v_mfma_f32_16x16x32_bf16 v[92:95], a[236:239], a[88:91], v[92:95]
  s_waitcnt lgkmcnt(5)
  ds_read_b64_tr_b16 a[206:207], v199 offset:5312
  v_mfma_f32_16x16x32_bf16 v[132:135], a[236:239], a[92:95], v[132:135]
  s_add_u32 s32, s32, 1
  s_cmp_eq_u32 s32, 6
  v_mfma_f32_16x16x32_bf16 v[16:19], a[192:195], a[80:83], v[16:19]
  s_cselect_b32 s31, s41, s42
  ds_read_b64_tr_b16 a[208:209], v198 offset:256
  v_mfma_f32_16x16x32_bf16 v[56:59], a[192:195], a[84:87], v[56:59]
  buffer_load_dwordx4 v233, s[4:7], s28 offen offset:1024 lds
  v_mfma_f32_16x16x32_bf16 v[96:99], a[192:195], a[88:91], v[96:99]
  s_waitcnt lgkmcnt(5)
  ds_read_b64_tr_b16 a[210:211], v198 offset:5376
  v_mfma_f32_16x16x32_bf16 v[136:139], a[192:195], a[92:95], v[136:139]
  s_cselect_b32 s32, 0, s32
  v_mfma_f32_16x16x32_bf16 v[20:23], a[196:199], a[80:83], v[20:23]
  ds_read_b64_tr_b16 a[212:213], v199 offset:256
  v_mfma_f32_16x16x32_bf16 v[60:63], a[196:199], a[84:87], v[60:63]
  v_mfma_f32_16x16x32_bf16 v[100:103], a[196:199], a[88:91], v[100:103]
  s_waitcnt lgkmcnt(5)
  ds_read_b64_tr_b16 a[214:215], v199 offset:5376
  v_mfma_f32_16x16x32_bf16 v[140:143], a[196:199], a[92:95], v[140:143]
  v_mfma_f32_16x16x32_bf16 v[24:27], a[200:203], a[80:83], v[24:27]
  ds_read_b64_tr_b16 a[216:217], v198 offset:10240
  v_mfma_f32_16x16x32_bf16 v[64:67], a[200:203], a[84:87], v[64:67]
  buffer_load_dwordx4 v234, s[4:7], s28 offen offset:2048 lds
  v_mfma_f32_16x16x32_bf16 v[104:107], a[200:203], a[88:91], v[104:107]
  s_waitcnt lgkmcnt(5)
  ds_read_b64_tr_b16 a[218:219], v198 offset:15360
  v_mfma_f32_16x16x32_bf16 v[144:147], a[200:203], a[92:95], v[144:147]
  v_mfma_f32_16x16x32_bf16 v[28:31], a[204:207], a[80:83], v[28:31]
  ds_read_b64_tr_b16 a[220:221], v199 offset:10240
  v_mfma_f32_16x16x32_bf16 v[68:71], a[204:207], a[84:87], v[68:71]
  v_mfma_f32_16x16x32_bf16 v[108:111], a[204:207], a[88:91], v[108:111]
  s_waitcnt lgkmcnt(5)
  ds_read_b64_tr_b16 a[222:223], v199 offset:15360
  v_mfma_f32_16x16x32_bf16 v[148:151], a[204:207], a[92:95], v[148:151]
  v_mfma_f32_16x16x32_bf16 v[32:35], a[208:211], a[80:83], v[32:35]
  ds_read_b64_tr_b16 a[224:225], v198 offset:10304
  v_mfma_f32_16x16x32_bf16 v[72:75], a[208:211], a[84:87], v[72:75]
  buffer_load_dwordx4 v235, s[4:7], s28 offen offset:3072 lds
  v_mfma_f32_16x16x32_bf16 v[112:115], a[208:211], a[88:91], v[112:115]
  s_waitcnt lgkmcnt(5)
  ds_read_b64_tr_b16 a[226:227], v198 offset:15424
  v_mfma_f32_16x16x32_bf16 v[152:155], a[208:211], a[92:95], v[152:155]
  s_add_u32 m0, s29, 4096
  v_mfma_f32_16x16x32_bf16 v[36:39], a[212:215], a[80:83], v[36:39]
  ds_read_b64_tr_b16 a[228:229], v199 offset:10304
  v_mfma_f32_16x16x32_bf16 v[76:79], a[212:215], a[84:87], v[76:79]
  v_mfma_f32_16x16x32_bf16 v[116:119], a[212:215], a[88:91], v[116:119]
  s_waitcnt vmcnt(17) lgkmcnt(5)
  ds_read_b64_tr_b16 a[230:231], v199 offset:15424
  v_mfma_f32_16x16x32_bf16 v[156:159], a[212:215], a[92:95], v[156:159]
  v_mfma_f32_16x16x32_bf16 v[0:3], a[216:219], a[112:115], v[0:3]
  ds_read_b64_tr_b16 a[232:233], v198 offset:10368
  v_mfma_f32_16x16x32_bf16 v[40:43], a[216:219], a[116:119], v[40:43]
  buffer_load_dwordx4 a[16:19], v204, s[8:11], s34 offen sc1
  v_mfma_f32_16x16x32_bf16 v[80:83], a[216:219], a[120:123], v[80:83]
  s_waitcnt lgkmcnt(5)
  ds_read_b64_tr_b16 a[234:235], v198 offset:15488
  v_mfma_f32_16x16x32_bf16 v[120:123], a[216:219], a[124:127], v[120:123]
  buffer_load_dwordx4 a[20:23], v205, s[8:11], s34 offen sc1
  v_mfma_f32_16x16x32_bf16 v[4:7], a[220:223], a[112:115], v[4:7]
  ds_read_b64_tr_b16 a[236:237], v199 offset:10368
  v_mfma_f32_16x16x32_bf16 v[44:47], a[220:223], a[116:119], v[44:47]
  buffer_load_dwordx4 a[24:27], v206, s[8:11], s34 offen sc1
  v_mfma_f32_16x16x32_bf16 v[84:87], a[220:223], a[120:123], v[84:87]
  s_waitcnt lgkmcnt(5)
  ds_read_b64_tr_b16 a[238:239], v199 offset:15488
  v_mfma_f32_16x16x32_bf16 v[124:127], a[220:223], a[124:127], v[124:127]
  buffer_load_dwordx4 a[28:31], v207, s[8:11], s34 offen sc1
  v_mfma_f32_16x16x32_bf16 v[8:11], a[224:227], a[112:115], v[8:11]
  s_add_u32 s34, s34, 1024
  ds_read_b64_tr_b16 a[192:193], v198 offset:10432
  v_mfma_f32_16x16x32_bf16 v[48:51], a[224:227], a[116:119], v[48:51]
  buffer_load_dwordx4 v236, s[4:7], s28 offen lds
  v_mfma_f32_16x16x32_bf16 v[88:91], a[224:227], a[120:123], v[88:91]
  s_waitcnt lgkmcnt(5)
  ds_read_b64_tr_b16 a[194:195], v198 offset:15552
  v_mfma_f32_16x16x32_bf16 v[128:131], a[224:227], a[124:127], v[128:131]
  s_add_u32 s28, s28, 81920
  s_cmp_ge_u32 s28, s38
  v_mfma_f32_16x16x32_bf16 v[12:15], a[228:231], a[112:115], v[12:15]
  s_cselect_b32 s40, s92, 0
  ds_read_b64_tr_b16 a[196:197], v199 offset:10432
  v_mfma_f32_16x16x32_bf16 v[52:55], a[228:231], a[116:119], v[52:55]
  s_sub_u32 s28, s28, s40
  s_add_u32 s90, s90, 1
  v_mfma_f32_16x16x32_bf16 v[92:95], a[228:231], a[120:123], v[92:95]
  s_waitcnt lgkmcnt(5)
  ds_read_b64_tr_b16 a[198:199], v199 offset:15552
  v_mfma_f32_16x16x32_bf16 v[132:135], a[228:231], a[124:127], v[132:135]
  s_cmp_lt_u32 s90, 12
  s_cselect_b32 s6, s91, 0
  v_mfma_f32_16x16x32_bf16 v[16:19], a[232:235], a[112:115], v[16:19]
  ds_read_b64_tr_b16 a[200:201], v198 offset:10496
  v_mfma_f32_16x16x32_bf16 v[56:59], a[232:235], a[116:119], v[56:59]
  s_add_u32 s30, s30, 1
  s_cmp_eq_u32 s30, 6
  v_mfma_f32_16x16x32_bf16 v[96:99], a[232:235], a[120:123], v[96:99]
  s_waitcnt lgkmcnt(5)
  ds_read_b64_tr_b16 a[202:203], v198 offset:15616
  v_add_u32 v198, s31, v198
  v_mfma_f32_16x16x32_bf16 v[136:139], a[232:235], a[124:127], v[136:139]
  s_cselect_b32 s39, s41, s42
  s_cselect_b32 s30, 0, s30
  v_mfma_f32_16x16x32_bf16 v[20:23], a[236:239], a[112:115], v[20:23]
  s_barrier
  ds_read_b64_tr_b16 a[204:205], v199 offset:10496
  v_mfma_f32_16x16x32_bf16 v[60:63], a[236:239], a[116:119], v[60:63]
  s_add_u32 s29, s29, s39
  v_mfma_f32_16x16x32_bf16 v[100:103], a[236:239], a[120:123], v[100:103]
  s_waitcnt lgkmcnt(5)
  ds_read_b64_tr_b16 a[206:207], v199 offset:15616
  v_add_u32 v199, s31, v199
  v_mfma_f32_16x16x32_bf16 v[140:143], a[236:239], a[124:127], v[140:143]
  v_mfma_f32_16x16x32_bf16 v[24:27], a[192:195], a[112:115], v[24:27]
  ds_read_b64_tr_b16 a[208:209], v198 offset:0
  v_mfma_f32_16x16x32_bf16 v[64:67], a[192:195], a[116:119], v[64:67]
  v_mfma_f32_16x16x32_bf16 v[104:107], a[192:195], a[120:123], v[104:107]
  s_waitcnt lgkmcnt(5)
  ds_read_b64_tr_b16 a[210:211], v198 offset:5120
  v_mfma_f32_16x16x32_bf16 v[144:147], a[192:195], a[124:127], v[144:147]
  v_mfma_f32_16x16x32_bf16 v[28:31], a[196:199], a[112:115], v[28:31]
  ds_read_b64_tr_b16 a[212:213], v199 offset:0
  v_mfma_f32_16x16x32_bf16 v[68:71], a[196:199], a[116:119], v[68:71]
  v_mfma_f32_16x16x32_bf16 v[108:111], a[196:199], a[120:123], v[108:111]
  s_waitcnt lgkmcnt(5)
  ds_read_b64_tr_b16 a[214:215], v199 offset:5120
  v_mfma_f32_16x16x32_bf16 v[148:151], a[196:199], a[124:127], v[148:151]
  v_mfma_f32_16x16x32_bf16 v[32:35], a[200:203], a[112:115], v[32:35]
  ds_read_b64_tr_b16 a[216:217], v198 offset:64
  v_mfma_f32_16x16x32_bf16 v[72:75], a[200:203], a[116:119], v[72:75]
  v_mfma_f32_16x16x32_bf16 v[112:115], a[200:203], a[120:123], v[112:115]
  s_waitcnt lgkmcnt(5)
  ds_read_b64_tr_b16 a[218:219], v198 offset:5184
  v_mfma_f32_16x16x32_bf16 v[152:155], a[200:203], a[124:127], v[152:155]
  v_mfma_f32_16x16x32_bf16 v[36:39], a[204:207], a[112:115], v[36:39]
  ds_read_b64_tr_b16 a[220:221], v199 offset:64
  v_mfma_f32_16x16x32_bf16 v[76:79], a[204:207], a[116:119], v[76:79]
  v_mfma_f32_16x16x32_bf16 v[116:119], a[204:207], a[120:123], v[116:119]
  s_waitcnt vmcnt(14) lgkmcnt(5)
  ds_read_b64_tr_b16 a[222:223], v199 offset:5184
  v_mfma_f32_16x16x32_bf16 v[156:159], a[204:207], a[124:127], v[156:159]
  v_mfma_f32_16x16x32_bf16 v[0:3], a[208:211], a[144:147], v[0:3]
  ds_read_b64_tr_b16 a[224:225], v198 offset:128
  v_mfma_f32_16x16x32_bf16 v[40:43], a[208:211], a[148:151], v[40:43]
  buffer_load_dwordx4 a[48:51], v204, s[8:11], s34 offen sc1
  v_mfma_f32_16x16x32_bf16 v[80:83], a[208:211], a[152:155], v[80:83]
  s_waitcnt lgkmcnt(5)
  ds_read_b64_tr_b16 a[226:227], v198 offset:5248
  v_mfma_f32_16x16x32_bf16 v[120:123], a[208:211], a[156:159], v[120:123]
  buffer_load_dwordx4 a[52:55], v205, s[8:11], s34 offen sc1
  v_mfma_f32_16x16x32_bf16 v[4:7], a[212:215], a[144:147], v[4:7]
  s_mov_b32 m0, s29
  ds_read_b64_tr_b16 a[228:229], v199 offset:128
  v_mfma_f32_16x16x32_bf16 v[44:47], a[212:215], a[148:151], v[44:47]
  buffer_load_dwordx4 a[56:59], v206, s[8:11], s34 offen sc1
  v_mfma_f32_16x16x32_bf16 v[84:87], a[212:215], a[152:155], v[84:87]
  s_waitcnt lgkmcnt(5)
  ds_read_b64_tr_b16 a[230:231], v199 offset:5248
  v_mfma_f32_16x16x32_bf16 v[124:127], a[212:215], a[156:159], v[124:127]
  buffer_load_dwordx4 a[60:63], v207, s[8:11], s34 offen sc1
  v_mfma_f32_16x16x32_bf16 v[8:11], a[216:219], a[144:147], v[8:11]
  s_add_u32 s34, s34, 1024
  ds_read_b64_tr_b16 a[232:233], v198 offset:192
  v_mfma_f32_16x16x32_bf16 v[48:51], a[216:219], a[148:151], v[48:51]
  buffer_load_dwordx4 v232, s[4:7], s28 offen lds
  v_mfma_f32_16x16x32_bf16 v[88:91], a[216:219], a[152:155], v[88:91]
  s_waitcnt lgkmcnt(5)
  ds_read_b64_tr_b16 a[234:235], v198 offset:5312
  v_mfma_f32_16x16x32_bf16 v[128:131], a[216:219], a[156:159], v[128:131]
  v_mfma_f32_16x16x32_bf16 v[12:15], a[220:223], a[144:147], v[12:15]
  s_add_u32 s32, s32, 1
  ds_read_b64_tr_b16 a[236:237], v199 offset:192
  v_mfma_f32_16x16x32_bf16 v[52:55], a[220:223], a[148:151], v[52:55]
  s_cmp_eq_u32 s32, 6
  s_cselect_b32 s31, s41, s42
  v_mfma_f32_16x16x32_bf16 v[92:95], a[220:223], a[152:155], v[92:95]
  s_waitcnt lgkmcnt(5)
  ds_read_b64_tr_b16 a[238:239], v199 offset:5312
  v_mfma_f32_16x16x32_bf16 v[132:135], a[220:223], a[156:159], v[132:135]
  s_cselect_b32 s32, 0, s32
  v_mfma_f32_16x16x32_bf16 v[16:19], a[224:227], a[144:147], v[16:19]
  ds_read_b64_tr_b16 a[192:193], v198 offset:256
  v_mfma_f32_16x16x32_bf16 v[56:59], a[224:227], a[148:151], v[56:59]
  buffer_load_dwordx4 v233, s[4:7], s28 offen offset:1024 lds
  v_mfma_f32_16x16x32_bf16 v[96:99], a[224:227], a[152:155], v[96:99]
  s_waitcnt lgkmcnt(5)
  ds_read_b64_tr_b16 a[194:195], v198 offset:5376
  v_mfma_f32_16x16x32_bf16 v[136:139], a[224:227], a[156:159], v[136:139]
  v_mfma_f32_16x16x32_bf16 v[20:23], a[228:231], a[144:147], v[20:23]
  ds_read_b64_tr_b16 a[196:197], v199 offset:256
  v_mfma_f32_16x16x32_bf16 v[60:63], a[228:231], a[148:151], v[60:63]
  v_mfma_f32_16x16x32_bf16 v[100:103], a[228:231], a[152:155], v[100:103]
  s_waitcnt lgkmcnt(5)
  ds_read_b64_tr_b16 a[198:199], v199 offset:5376
  v_mfma_f32_16x16x32_bf16 v[140:143], a[228:231], a[156:159], v[140:143]
  v_mfma_f32_16x16x32_bf16 v[24:27], a[232:235], a[144:147], v[24:27]
  ds_read_b64_tr_b16 a[200:201], v198 offset:10240
  v_mfma_f32_16x16x32_bf16 v[64:67], a[232:235], a[148:151], v[64:67]
  buffer_load_dwordx4 v234, s[4:7], s28 offen offset:2048 lds
  v_mfma_f32_16x16x32_bf16 v[104:107], a[232:235], a[152:155], v[104:107]
  s_waitcnt lgkmcnt(5)
  ds_read_b64_tr_b16 a[202:203], v198 offset:15360
  v_mfma_f32_16x16x32_bf16 v[144:147], a[232:235], a[156:159], v[144:147]
  v_mfma_f32_16x16x32_bf16 v[28:31], a[236:239], a[144:147], v[28:31]
  ds_read_b64_tr_b16 a[204:205], v199 offset:10240
  v_mfma_f32_16x16x32_bf16 v[68:71], a[236:239], a[148:151], v[68:71]
  v_mfma_f32_16x16x32_bf16 v[108:111], a[236:239], a[152:155], v[108:111]
  s_waitcnt lgkmcnt(5)
  ds_read_b64_tr_b16 a[206:207], v199 offset:15360
  v_mfma_f32_16x16x32_bf16 v[148:151], a[236:239], a[156:159], v[148:151]
  v_mfma_f32_16x16x32_bf16 v[32:35], a[192:195], a[144:147], v[32:35]
  ds_read_b64_tr_b16 a[208:209], v198 offset:10304
  v_mfma_f32_16x16x32_bf16 v[72:75], a[192:195], a[148:151], v[72:75]
  buffer_load_dwordx4 v235, s[4:7], s28 offen offset:3072 lds
  v_mfma_f32_16x16x32_bf16 v[112:115], a[192:195], a[152:155], v[112:115]
  s_waitcnt lgkmcnt(5)
  ds_read_b64_tr_b16 a[210:211], v198 offset:15424
  v_mfma_f32_16x16x32_bf16 v[152:155], a[192:195], a[156:159], v[152:155]
  s_add_u32 m0, s29, 4096
  v_mfma_f32_16x16x32_bf16 v[36:39], a[196:199], a[144:147], v[36:39]
  ds_read_b64_tr_b16 a[212:213], v199 offset:10304
  v_mfma_f32_16x16x32_bf16 v[76:79], a[196:199], a[148:151], v[76:79]
  v_mfma_f32_16x16x32_bf16 v[116:119], a[196:199], a[152:155], v[116:119]
  s_waitcnt vmcnt(17) lgkmcnt(5)
  ds_read_b64_tr_b16 a[214:215], v199 offset:15424
  v_mfma_f32_16x16x32_bf16 v[156:159], a[196:199], a[156:159], v[156:159]
  v_mfma_f32_16x16x32_bf16 v[0:3], a[200:203], a[176:179], v[0:3]
  ds_read_b64_tr_b16 a[216:217], v198 offset:10368
  v_mfma_f32_16x16x32_bf16 v[40:43], a[200:203], a[180:183], v[40:43]
  buffer_load_dwordx4 a[80:83], v204, s[8:11], s34 offen sc1
  v_mfma_f32_16x16x32_bf16 v[80:83], a[200:203], a[184:187], v[80:83]
  s_waitcnt lgkmcnt(5)
  ds_read_b64_tr_b16 a[218:219], v198 offset:15488
  v_mfma_f32_16x16x32_bf16 v[120:123], a[200:203], a[188:191], v[120:123]
  buffer_load_dwordx4 a[84:87], v205, s[8:11], s34 offen sc1
  v_mfma_f32_16x16x32_bf16 v[4:7], a[204:207], a[176:179], v[4:7]
  ds_read_b64_tr_b16 a[220:221], v199 offset:10368
  v_mfma_f32_16x16x32_bf16 v[44:47], a[204:207], a[180:183], v[44:47]
  buffer_load_dwordx4 a[88:91], v206, s[8:11], s34 offen sc1
  v_mfma_f32_16x16x32_bf16 v[84:87], a[204:207], a[184:187], v[84:87]
  s_waitcnt lgkmcnt(5)
  ds_read_b64_tr_b16 a[222:223], v199 offset:15488
  v_mfma_f32_16x16x32_bf16 v[124:127], a[204:207], a[188:191], v[124:127]
  buffer_load_dwordx4 a[92:95], v207, s[8:11], s34 offen sc1
  v_mfma_f32_16x16x32_bf16 v[8:11], a[208:211], a[176:179], v[8:11]
  s_add_u32 s34, s34, 1024
  ds_read_b64_tr_b16 a[224:225], v198 offset:10432
  v_mfma_f32_16x16x32_bf16 v[48:51], a[208:211], a[180:183], v[48:51]
  buffer_load_dwordx4 v236, s[4:7], s28 offen lds
  v_mfma_f32_16x16x32_bf16 v[88:91], a[208:211], a[184:187], v[88:91]
  s_waitcnt lgkmcnt(5)
  ds_read_b64_tr_b16 a[226:227], v198 offset:15552
  v_mfma_f32_16x16x32_bf16 v[128:131], a[208:211], a[188:191], v[128:131]
  s_add_u32 s28, s28, 81920
  s_cmp_ge_u32 s28, s38
  v_mfma_f32_16x16x32_bf16 v[12:15], a[212:215], a[176:179], v[12:15]
  s_cselect_b32 s40, s92, 0
  ds_read_b64_tr_b16 a[228:229], v199 offset:10432
  v_mfma_f32_16x16x32_bf16 v[52:55], a[212:215], a[180:183], v[52:55]
  s_sub_u32 s28, s28, s40
  s_add_u32 s90, s90, 1
  v_mfma_f32_16x16x32_bf16 v[92:95], a[212:215], a[184:187], v[92:95]
  s_waitcnt lgkmcnt(5)
  ds_read_b64_tr_b16 a[230:231], v199 offset:15552
  v_mfma_f32_16x16x32_bf16 v[132:135], a[212:215], a[188:191], v[132:135]
  s_cmp_lt_u32 s90, 12
  s_cselect_b32 s6, s91, 0
  v_mfma_f32_16x16x32_bf16 v[16:19], a[216:219], a[176:179], v[16:19]
  ds_read_b64_tr_b16 a[232:233], v198 offset:10496
  v_mfma_f32_16x16x32_bf16 v[56:59], a[216:219], a[180:183], v[56:59]
  v_mfma_f32_16x16x32_bf16 v[96:99], a[216:219], a[184:187], v[96:99]
  s_waitcnt lgkmcnt(5)
  ds_read_b64_tr_b16 a[234:235], v198 offset:15616
  v_add_u32 v198, s31, v198
  v_mfma_f32_16x16x32_bf16 v[136:139], a[216:219], a[188:191], v[136:139]
  v_mfma_f32_16x16x32_bf16 v[20:23], a[220:223], a[176:179], v[20:23]
  s_barrier
  ds_read_b64_tr_b16 a[236:237], v199 offset:10496
  v_mfma_f32_16x16x32_bf16 v[60:63], a[220:223], a[180:183], v[60:63]
  s_add_u32 s30, s30, 1
  s_cmp_eq_u32 s30, 6
  v_mfma_f32_16x16x32_bf16 v[100:103], a[220:223], a[184:187], v[100:103]
  s_waitcnt lgkmcnt(5)
  ds_read_b64_tr_b16 a[238:239], v199 offset:15616
  v_add_u32 v199, s31, v199
  v_mfma_f32_16x16x32_bf16 v[140:143], a[220:223], a[188:191], v[140:143]
  s_cselect_b32 s39, s41, s42
  s_cselect_b32 s30, 0, s30
  v_mfma_f32_16x16x32_bf16 v[24:27], a[224:227], a[176:179], v[24:27]
  s_add_u32 s29, s29, s39
  ds_read_b64_tr_b16 a[192:193], v198 offset:0
  v_mfma_f32_16x16x32_bf16 v[64:67], a[224:227], a[180:183], v[64:67]
  s_sub_u32 s33, s33, 1
  s_cmp_lg_u32 s33, 0
  v_mfma_f32_16x16x32_bf16 v[104:107], a[224:227], a[184:187], v[104:107]
  s_waitcnt lgkmcnt(5)
  ds_read_b64_tr_b16 a[194:195], v198 offset:5120
  v_mfma_f32_16x16x32_bf16 v[144:147], a[224:227], a[188:191], v[144:147]
  v_mfma_f32_16x16x32_bf16 v[28:31], a[228:231], a[176:179], v[28:31]
  ds_read_b64_tr_b16 a[196:197], v199 offset:0
  v_mfma_f32_16x16x32_bf16 v[68:71], a[228:231], a[180:183], v[68:71]
  v_mfma_f32_16x16x32_bf16 v[108:111], a[228:231], a[184:187], v[108:111]
  s_waitcnt lgkmcnt(5)
  ds_read_b64_tr_b16 a[198:199], v199 offset:5120
  v_mfma_f32_16x16x32_bf16 v[148:151], a[228:231], a[188:191], v[148:151]
  v_mfma_f32_16x16x32_bf16 v[32:35], a[232:235], a[176:179], v[32:35]
  ds_read_b64_tr_b16 a[200:201], v198 offset:64
  v_mfma_f32_16x16x32_bf16 v[72:75], a[232:235], a[180:183], v[72:75]
  v_mfma_f32_16x16x32_bf16 v[112:115], a[232:235], a[184:187], v[112:115]
  s_waitcnt lgkmcnt(5)
  ds_read_b64_tr_b16 a[202:203], v198 offset:5184
  v_mfma_f32_16x16x32_bf16 v[152:155], a[232:235], a[188:191], v[152:155]
  v_mfma_f32_16x16x32_bf16 v[36:39], a[236:239], a[176:179], v[36:39]
  ds_read_b64_tr_b16 a[204:205], v199 offset:64
  v_mfma_f32_16x16x32_bf16 v[76:79], a[236:239], a[180:183], v[76:79]
  v_mfma_f32_16x16x32_bf16 v[116:119], a[236:239], a[184:187], v[116:119]
  s_waitcnt vmcnt(14) lgkmcnt(5)
  ds_read_b64_tr_b16 a[206:207], v199 offset:5184
  v_mfma_f32_16x16x32_bf16 v[156:159], a[236:239], a[188:191], v[156:159]
  s_cbranch_scc1 adaLN_cond__sliding_block_cached__glu_gated_swiglu__prompt_kernel_d_loop
  s_waitcnt lgkmcnt(0)
  s_barrier
  s_nop 7
  v_lshlrev_b32 v218, 4, v255
  s_lshl_b32 s39, s35, 7
  s_lshl_b32 s40, s37, 4
  s_add_u32 s39, s39, s40
  s_lshl_b32 s40, s82, 2
  s_add_u32 s39, s39, s40
  s_mul_i32 s39, s39, 20
  s_mul_i32 s40, s36, 5
  s_add_u32 s39, s39, s40
  s_lshl_b32 s39, s39, 10
  v_cvt_pk_bf16_f32 v160, v0, v1
  v_cvt_pk_bf16_f32 v161, v2, v3
  v_cvt_pk_bf16_f32 v162, v4, v5
  v_cvt_pk_bf16_f32 v163, v6, v7
  buffer_store_dwordx4 v[160:163], v218, s[12:15], s39 offen sc1
  v_cvt_pk_bf16_f32 v164, v8, v9
  v_cvt_pk_bf16_f32 v165, v10, v11
  v_cvt_pk_bf16_f32 v166, v12, v13
  v_cvt_pk_bf16_f32 v167, v14, v15
  buffer_store_dwordx4 v[164:167], v218, s[12:15], s39 offen offset:1024 sc1
  v_cvt_pk_bf16_f32 v168, v16, v17
  v_cvt_pk_bf16_f32 v169, v18, v19
  v_cvt_pk_bf16_f32 v170, v20, v21
  v_cvt_pk_bf16_f32 v171, v22, v23
  buffer_store_dwordx4 v[168:171], v218, s[12:15], s39 offen offset:2048 sc1
  v_cvt_pk_bf16_f32 v172, v24, v25
  v_cvt_pk_bf16_f32 v173, v26, v27
  v_cvt_pk_bf16_f32 v174, v28, v29
  v_cvt_pk_bf16_f32 v175, v30, v31
  buffer_store_dwordx4 v[172:175], v218, s[12:15], s39 offen offset:3072 sc1
  v_cvt_pk_bf16_f32 v160, v32, v33
  v_cvt_pk_bf16_f32 v161, v34, v35
  v_cvt_pk_bf16_f32 v162, v36, v37
  v_cvt_pk_bf16_f32 v163, v38, v39
  s_add_u32 s39, s39, 4096
  buffer_store_dwordx4 v[160:163], v218, s[12:15], s39 offen sc1
  s_add_u32 s39, s39, 16384
  v_cvt_pk_bf16_f32 v164, v40, v41
  v_cvt_pk_bf16_f32 v165, v42, v43
  v_cvt_pk_bf16_f32 v166, v44, v45
  v_cvt_pk_bf16_f32 v167, v46, v47
  buffer_store_dwordx4 v[164:167], v218, s[12:15], s39 offen sc1
  v_cvt_pk_bf16_f32 v168, v48, v49
  v_cvt_pk_bf16_f32 v169, v50, v51
  v_cvt_pk_bf16_f32 v170, v52, v53
  v_cvt_pk_bf16_f32 v171, v54, v55
  buffer_store_dwordx4 v[168:171], v218, s[12:15], s39 offen offset:1024 sc1
  v_cvt_pk_bf16_f32 v172, v56, v57
  v_cvt_pk_bf16_f32 v173, v58, v59
  v_cvt_pk_bf16_f32 v174, v60, v61
  v_cvt_pk_bf16_f32 v175, v62, v63
  buffer_store_dwordx4 v[172:175], v218, s[12:15], s39 offen offset:2048 sc1
  v_cvt_pk_bf16_f32 v160, v64, v65
  v_cvt_pk_bf16_f32 v161, v66, v67
  v_cvt_pk_bf16_f32 v162, v68, v69
  v_cvt_pk_bf16_f32 v163, v70, v71
  buffer_store_dwordx4 v[160:163], v218, s[12:15], s39 offen offset:3072 sc1
  v_cvt_pk_bf16_f32 v164, v72, v73
  v_cvt_pk_bf16_f32 v165, v74, v75
  v_cvt_pk_bf16_f32 v166, v76, v77
  v_cvt_pk_bf16_f32 v167, v78, v79
  s_add_u32 s39, s39, 4096
  buffer_store_dwordx4 v[164:167], v218, s[12:15], s39 offen sc1
  s_add_u32 s39, s39, 16384
  v_cvt_pk_bf16_f32 v168, v80, v81
  v_cvt_pk_bf16_f32 v169, v82, v83
  v_cvt_pk_bf16_f32 v170, v84, v85
  v_cvt_pk_bf16_f32 v171, v86, v87
  buffer_store_dwordx4 v[168:171], v218, s[12:15], s39 offen sc1
  v_cvt_pk_bf16_f32 v172, v88, v89
  v_cvt_pk_bf16_f32 v173, v90, v91
  v_cvt_pk_bf16_f32 v174, v92, v93
  v_cvt_pk_bf16_f32 v175, v94, v95
  buffer_store_dwordx4 v[172:175], v218, s[12:15], s39 offen offset:1024 sc1
  v_cvt_pk_bf16_f32 v160, v96, v97
  v_cvt_pk_bf16_f32 v161, v98, v99
  v_cvt_pk_bf16_f32 v162, v100, v101
  v_cvt_pk_bf16_f32 v163, v102, v103
  buffer_store_dwordx4 v[160:163], v218, s[12:15], s39 offen offset:2048 sc1
  v_cvt_pk_bf16_f32 v164, v104, v105
  v_cvt_pk_bf16_f32 v165, v106, v107
  v_cvt_pk_bf16_f32 v166, v108, v109
  v_cvt_pk_bf16_f32 v167, v110, v111
  buffer_store_dwordx4 v[164:167], v218, s[12:15], s39 offen offset:3072 sc1
  v_cvt_pk_bf16_f32 v168, v112, v113
  v_cvt_pk_bf16_f32 v169, v114, v115
  v_cvt_pk_bf16_f32 v170, v116, v117
  v_cvt_pk_bf16_f32 v171, v118, v119
  s_add_u32 s39, s39, 4096
  buffer_store_dwordx4 v[168:171], v218, s[12:15], s39 offen sc1
  s_add_u32 s39, s39, 16384
  v_cvt_pk_bf16_f32 v172, v120, v121
  v_cvt_pk_bf16_f32 v173, v122, v123
  v_cvt_pk_bf16_f32 v174, v124, v125
  v_cvt_pk_bf16_f32 v175, v126, v127
  buffer_store_dwordx4 v[172:175], v218, s[12:15], s39 offen sc1
  v_cvt_pk_bf16_f32 v160, v128, v129
  v_cvt_pk_bf16_f32 v161, v130, v131
  v_cvt_pk_bf16_f32 v162, v132, v133
  v_cvt_pk_bf16_f32 v163, v134, v135
  buffer_store_dwordx4 v[160:163], v218, s[12:15], s39 offen offset:1024 sc1
  v_cvt_pk_bf16_f32 v164, v136, v137
  v_cvt_pk_bf16_f32 v165, v138, v139
  v_cvt_pk_bf16_f32 v166, v140, v141
  v_cvt_pk_bf16_f32 v167, v142, v143
  buffer_store_dwordx4 v[164:167], v218, s[12:15], s39 offen offset:2048 sc1
  v_cvt_pk_bf16_f32 v168, v144, v145
  v_cvt_pk_bf16_f32 v169, v146, v147
  v_cvt_pk_bf16_f32 v170, v148, v149
  v_cvt_pk_bf16_f32 v171, v150, v151
  buffer_store_dwordx4 v[168:171], v218, s[12:15], s39 offen offset:3072 sc1
  v_cvt_pk_bf16_f32 v172, v152, v153
  v_cvt_pk_bf16_f32 v173, v154, v155
  v_cvt_pk_bf16_f32 v174, v156, v157
  v_cvt_pk_bf16_f32 v175, v158, v159
  s_add_u32 s39, s39, 4096
  buffer_store_dwordx4 v[172:175], v218, s[12:15], s39 offen sc1
  s_add_u32 s39, s39, 16384
  s_waitcnt vmcnt(0)
  s_barrier
s_cmp_eq_u32 s82, 0
s_cbranch_scc0 adaLN_cond__sliding_block_cached__glu_gated_swiglu__prompt_kernel_sd_nosig
s_add_u32 s83, s37, 24
s_lshl_b32 s83, s83, 7
s_lshl_b32 s3, s35, 2
s_add_u32 s3, s3, s36
s_lshl_b32 s3, s3, 2
s_add_u32 s83, s83, s3
s_add_u32 s83, s83, 62914560
v_mov_b32 v253, s83
v_mov_b32 v254, 1
s_mov_b64 exec, 1
global_store_dword v253, v254, s[50:51] sc1
s_mov_b64 exec, -1
adaLN_cond__sliding_block_cached__glu_gated_swiglu__prompt_kernel_sd_nosig:
  s_add_u32 s16, s50, 16384
  s_addc_u32 s17, s51, 0
  s_mov_b32 s18, 46080
  s_mov_b32 s19, 0x20000
  s_lshl_b32 s93, s82, 6
  v_add_u32 v160, s93, v255
  v_cmp_gt_u32 vcc, 256, v160
  s_and_saveexec_b64 s[100:101], vcc
  s_cbranch_execz stg_e_st0
  v_lshlrev_b32 v161, 5, v160
  s_mov_b32 s93, 5120
  buffer_load_dwordx4 v[164:167], v161, s[16:19], s93 offen offset:0 sc1
  buffer_load_dwordx4 v[168:171], v161, s[16:19], s93 offen offset:16 sc1
  s_mov_b32 s93, 20480
  buffer_load_dwordx4 v[172:175], v161, s[16:19], s93 offen offset:0 sc1
  buffer_load_dwordx4 v[176:179], v161, s[16:19], s93 offen offset:16 sc1
  s_mov_b32 s93, 35840
  buffer_load_dwordx4 v[180:183], v161, s[16:19], s93 offen offset:0 sc1
  buffer_load_dwordx4 v[184:187], v161, s[16:19], s93 offen offset:16 sc1
  s_waitcnt vmcnt(0)
  v_pk_add_f32 v[164:165], v[164:165], v[172:173]
  v_pk_add_f32 v[166:167], v[166:167], v[174:175]
  v_pk_add_f32 v[168:169], v[168:169], v[176:177]
  v_pk_add_f32 v[170:171], v[170:171], v[178:179]
  v_pk_add_f32 v[164:165], v[164:165], v[180:181]
  v_pk_add_f32 v[166:167], v[166:167], v[182:183]
  v_pk_add_f32 v[168:169], v[168:169], v[184:185]
  v_pk_add_f32 v[170:171], v[170:171], v[186:187]
  v_cvt_pk_bf16_f32 v164, v164, v164
  v_and_b32 v164, 0xffff0000, v164
  v_cvt_pk_bf16_f32 v165, v165, v165
  v_and_b32 v165, 0xffff0000, v165
  v_cvt_pk_bf16_f32 v166, v166, v166
  v_and_b32 v166, 0xffff0000, v166
  v_cvt_pk_bf16_f32 v167, v167, v167
  v_and_b32 v167, 0xffff0000, v167
  v_cvt_pk_bf16_f32 v168, v168, v168
  v_and_b32 v168, 0xffff0000, v168
  v_cvt_pk_bf16_f32 v169, v169, v169
  v_and_b32 v169, 0xffff0000, v169
  v_cvt_pk_bf16_f32 v170, v170, v170
  v_and_b32 v170, 0xffff0000, v170
  v_cvt_pk_bf16_f32 v171, v171, v171
  v_and_b32 v171, 0xffff0000, v171
  v_subrev_u32 v162, 160, v160
  v_cmp_gt_u32 vcc, 80, v162
  v_add_f32 v172, 1.0, v164
  v_add_f32 v173, 1.0, v165
  v_add_f32 v174, 1.0, v166
  v_add_f32 v175, 1.0, v167
  v_add_f32 v176, 1.0, v168
  v_add_f32 v177, 1.0, v169
  v_add_f32 v178, 1.0, v170
  v_add_f32 v179, 1.0, v171
  v_cvt_pk_bf16_f32 v172, v172, v172
  v_and_b32 v172, 0xffff0000, v172
  v_cvt_pk_bf16_f32 v173, v173, v173
  v_and_b32 v173, 0xffff0000, v173
  v_cvt_pk_bf16_f32 v174, v174, v174
  v_and_b32 v174, 0xffff0000, v174
  v_cvt_pk_bf16_f32 v175, v175, v175
  v_and_b32 v175, 0xffff0000, v175
  v_cvt_pk_bf16_f32 v176, v176, v176
  v_and_b32 v176, 0xffff0000, v176
  v_cvt_pk_bf16_f32 v177, v177, v177
  v_and_b32 v177, 0xffff0000, v177
  v_cvt_pk_bf16_f32 v178, v178, v178
  v_and_b32 v178, 0xffff0000, v178
  v_cvt_pk_bf16_f32 v179, v179, v179
  v_and_b32 v179, 0xffff0000, v179
  v_cndmask_b32 v164, v164, v172, vcc
  v_cndmask_b32 v165, v165, v173, vcc
  v_cndmask_b32 v166, v166, v174, vcc
  v_cndmask_b32 v167, v167, v175, vcc
  v_cndmask_b32 v168, v168, v176, vcc
  v_cndmask_b32 v169, v169, v177, vcc
  v_cndmask_b32 v170, v170, v178, vcc
  v_cndmask_b32 v171, v171, v179, vcc
  v_add_u32 v161, 152832, v161
  ds_write_b128 v161, v[164:167]
  ds_write_b128 v161, v[168:171] offset:16
stg_e_st0:
  s_mov_b64 exec, s[100:101]
  s_lshl_b32 s93, s82, 6
  v_add_u32 v160, s93, v255
  v_cmp_gt_u32 vcc, 64, v160
  s_and_saveexec_b64 s[100:101], vcc
  s_cbranch_execz stg_e_st1
  v_lshlrev_b32 v161, 5, v160
  s_mov_b32 s93, 13312
  buffer_load_dwordx4 v[164:167], v161, s[16:19], s93 offen offset:0 sc1
  buffer_load_dwordx4 v[168:171], v161, s[16:19], s93 offen offset:16 sc1
  s_mov_b32 s93, 28672
  buffer_load_dwordx4 v[172:175], v161, s[16:19], s93 offen offset:0 sc1
  buffer_load_dwordx4 v[176:179], v161, s[16:19], s93 offen offset:16 sc1
  s_mov_b32 s93, 44032
  buffer_load_dwordx4 v[180:183], v161, s[16:19], s93 offen offset:0 sc1
  buffer_load_dwordx4 v[184:187], v161, s[16:19], s93 offen offset:16 sc1
  s_waitcnt vmcnt(0)
  v_pk_add_f32 v[164:165], v[164:165], v[172:173]
  v_pk_add_f32 v[166:167], v[166:167], v[174:175]
  v_pk_add_f32 v[168:169], v[168:169], v[176:177]
  v_pk_add_f32 v[170:171], v[170:171], v[178:179]
  v_pk_add_f32 v[164:165], v[164:165], v[180:181]
  v_pk_add_f32 v[166:167], v[166:167], v[182:183]
  v_pk_add_f32 v[168:169], v[168:169], v[184:185]
  v_pk_add_f32 v[170:171], v[170:171], v[186:187]
  v_cvt_pk_bf16_f32 v164, v164, v164
  v_and_b32 v164, 0xffff0000, v164
  v_cvt_pk_bf16_f32 v165, v165, v165
  v_and_b32 v165, 0xffff0000, v165
  v_cvt_pk_bf16_f32 v166, v166, v166
  v_and_b32 v166, 0xffff0000, v166
  v_cvt_pk_bf16_f32 v167, v167, v167
  v_and_b32 v167, 0xffff0000, v167
  v_cvt_pk_bf16_f32 v168, v168, v168
  v_and_b32 v168, 0xffff0000, v168
  v_cvt_pk_bf16_f32 v169, v169, v169
  v_and_b32 v169, 0xffff0000, v169
  v_cvt_pk_bf16_f32 v170, v170, v170
  v_and_b32 v170, 0xffff0000, v170
  v_cvt_pk_bf16_f32 v171, v171, v171
  v_and_b32 v171, 0xffff0000, v171
  v_add_u32 v161, 161024, v161
  ds_write_b128 v161, v[164:167]
  ds_write_b128 v161, v[168:171] offset:16
stg_e_st1:
  s_mov_b64 exec, s[100:101]
  s_waitcnt lgkmcnt(0)
  v_and_b32 v1, 7, v255
  v_bfe_u32 v2, v255, 3, 2
  v_bfe_u32 v3, v255, 5, 1
  s_and_b32 s93, s2, 1
  s_lshl_b32 s93, s93, 3
  v_add_u32 v8, s93, v1
  s_lshr_b32 s93, s2, 1
  s_mul_i32 s92, s93, 20480
  s_mul_i32 s93, s82, 5
  v_add_u32 v5, s93, v3
  v_lshl_add_u32 v4, v2, 4, v8
  v_lshlrev_b32 v4, 4, v4
  v_lshl_add_u32 v4, v5, 10, v4
  v_lshlrev_b32 v7, 4, v1
  v_add_u32 v7, 151552, v7
  s_lshl_b32 s93, s82, 2
  v_add_u32 v6, s93, v7
  v_lshlrev_b32 v9, 5, v5
  v_lshl_add_u32 v9, v2, 2, v9
  v_lshlrev_b32 v11, 2, v9
  s_movk_i32 s93, 1280
  v_mul_lo_u32 v10, v8, s93
  v_lshl_add_u32 v10, v9, 1, v10
  s_mov_b32 s20, s52
  s_mov_b32 s21, s53
  s_mov_b32 s22, 2621440
  s_mov_b32 s23, 0x20000
  buffer_load_dwordx2 v[112:113], v10, s[20:23], s92 offen offset:0
  buffer_load_dwordx2 v[114:115], v10, s[20:23], s92 offen offset:32
  buffer_load_dwordx2 v[116:117], v10, s[20:23], s92 offen offset:128
  buffer_load_dwordx2 v[118:119], v10, s[20:23], s92 offen offset:160
  s_mov_b32 exec_hi, 0
  buffer_load_dwordx2 v[120:121], v10, s[20:23], s92 offen offset:256
  buffer_load_dwordx2 v[122:123], v10, s[20:23], s92 offen offset:288
  s_mov_b32 exec_hi, -1
s_cmp_eq_u32 s82, 0
s_cbranch_scc0 adaLN_cond__sliding_block_cached__glu_gated_swiglu__prompt_kernel_wd_nopoll
s_lshr_b32 s83, s2, 5
s_add_u32 s83, s83, 24
s_lshl_b32 s83, s83, 7
s_add_u32 s83, s83, 62914560
v_lshlrev_b32 v253, 2, v255
v_add_u32 v253, s83, v253
s_mov_b32 exec_lo, 0xffffffff
s_mov_b32 exec_hi, 0x0
s_mov_b32 s3, 400000
global_load_dword v254, v253, s[50:51] sc1
s_sleep 10
adaLN_cond__sliding_block_cached__glu_gated_swiglu__prompt_kernel_wd_poll:
global_load_dword v252, v253, s[50:51] sc1
s_waitcnt vmcnt(1)
v_cmp_ne_u32 vcc, 1, v254
s_nop 1
s_cmp_eq_u64 vcc, 0
s_cbranch_scc1 adaLN_cond__sliding_block_cached__glu_gated_swiglu__prompt_kernel_wd_ready
global_load_dword v254, v253, s[50:51] sc1
s_waitcnt vmcnt(1)
v_cmp_ne_u32 vcc, 1, v252
s_nop 1
s_cmp_eq_u64 vcc, 0
s_cbranch_scc1 adaLN_cond__sliding_block_cached__glu_gated_swiglu__prompt_kernel_wd_ready
s_sub_u32 s3, s3, 1
s_cmp_lg_u32 s3, 0
s_cbranch_scc1 adaLN_cond__sliding_block_cached__glu_gated_swiglu__prompt_kernel_wd_poll
s_endpgm
adaLN_cond__sliding_block_cached__glu_gated_swiglu__prompt_kernel_wd_ready:
s_mov_b64 exec, -1
adaLN_cond__sliding_block_cached__glu_gated_swiglu__prompt_kernel_wd_nopoll:
  s_barrier
  s_add_u32 s84, s50, 28311552
  s_addc_u32 s85, s51, 0
  s_mov_b32 s86, 20971520
  s_mov_b32 s87, 0x20000
  s_mov_b32 s93, s92
  s_add_u32 s94, s92, 4096
  buffer_load_dwordx4 v[16:19], v4, s[84:87], s93 offen sc1
  buffer_load_dwordx4 v[20:23], v4, s[84:87], s93 offen offset:2048 sc1
  s_mov_b32 exec_hi, 0
  buffer_load_dwordx4 v[24:27], v4, s[84:87], s94 offen sc1
  s_mov_b32 exec_hi, -1
  s_add_u32 s93, s93, 2621440
  s_add_u32 s94, s94, 2621440
  buffer_load_dwordx4 v[28:31], v4, s[84:87], s93 offen sc1
  buffer_load_dwordx4 v[32:35], v4, s[84:87], s93 offen offset:2048 sc1
  s_mov_b32 exec_hi, 0
  buffer_load_dwordx4 v[36:39], v4, s[84:87], s94 offen sc1
  s_mov_b32 exec_hi, -1
  s_add_u32 s93, s93, 2621440
  s_add_u32 s94, s94, 2621440
  buffer_load_dwordx4 v[40:43], v4, s[84:87], s93 offen sc1
  buffer_load_dwordx4 v[44:47], v4, s[84:87], s93 offen offset:2048 sc1
  s_mov_b32 exec_hi, 0
  buffer_load_dwordx4 v[48:51], v4, s[84:87], s94 offen sc1
  s_mov_b32 exec_hi, -1
  s_add_u32 s93, s93, 2621440
  s_add_u32 s94, s94, 2621440
  buffer_load_dwordx4 v[52:55], v4, s[84:87], s93 offen sc1
  buffer_load_dwordx4 v[56:59], v4, s[84:87], s93 offen offset:2048 sc1
  s_mov_b32 exec_hi, 0
  buffer_load_dwordx4 v[60:63], v4, s[84:87], s94 offen sc1
  s_mov_b32 exec_hi, -1
  s_add_u32 s93, s93, 2621440
  s_add_u32 s94, s94, 2621440
  buffer_load_dwordx4 v[64:67], v4, s[84:87], s93 offen sc1
  buffer_load_dwordx4 v[68:71], v4, s[84:87], s93 offen offset:2048 sc1
  s_mov_b32 exec_hi, 0
  buffer_load_dwordx4 v[72:75], v4, s[84:87], s94 offen sc1
  s_mov_b32 exec_hi, -1
  s_add_u32 s93, s93, 2621440
  s_add_u32 s94, s94, 2621440
  buffer_load_dwordx4 v[76:79], v4, s[84:87], s93 offen sc1
  buffer_load_dwordx4 v[80:83], v4, s[84:87], s93 offen offset:2048 sc1
  s_mov_b32 exec_hi, 0
  buffer_load_dwordx4 v[84:87], v4, s[84:87], s94 offen sc1
  s_mov_b32 exec_hi, -1
  s_add_u32 s93, s93, 2621440
  s_add_u32 s94, s94, 2621440
  buffer_load_dwordx4 v[88:91], v4, s[84:87], s93 offen sc1
  buffer_load_dwordx4 v[92:95], v4, s[84:87], s93 offen offset:2048 sc1
  s_mov_b32 exec_hi, 0
  buffer_load_dwordx4 v[96:99], v4, s[84:87], s94 offen sc1
  s_mov_b32 exec_hi, -1
  s_add_u32 s93, s93, 2621440
  s_add_u32 s94, s94, 2621440
  buffer_load_dwordx4 v[100:103], v4, s[84:87], s93 offen sc1
  buffer_load_dwordx4 v[104:107], v4, s[84:87], s93 offen offset:2048 sc1
  s_mov_b32 exec_hi, 0
  buffer_load_dwordx4 v[108:111], v4, s[84:87], s94 offen sc1
  s_mov_b32 exec_hi, -1
  s_mov_b32 s4, s56
  s_mov_b32 s5, s57
  s_mov_b32 s6, 1966080
  s_mov_b32 s7, 0x20000
  s_mov_b32 s8, s58
  s_mov_b32 s9, s59
  s_mov_b32 s10, 1966080
  s_mov_b32 s11, 0x20000
  s_and_b32 s94, s2, 3
  s_lshl_b32 s94, s94, 2
  s_bfe_u32 s95, s2, 0x20003
  s_add_u32 s94, s94, s95
  s_mul_i32 s95, s94, 192
  s_mul_i32 s94, s82, 3072
  s_add_u32 m0, s94, 0
  s_nop 0
  buffer_load_dwordx4 v237, s[4:7], s95 offen lds
  buffer_load_dwordx4 v238, s[4:7], s95 offen offset:1024 lds
  buffer_load_dwordx4 v239, s[4:7], s95 offen offset:2048 lds
  s_add_u32 m0, s94, 12288
  s_nop 0
  buffer_load_dwordx4 v237, s[8:11], s95 offen lds
  buffer_load_dwordx4 v238, s[8:11], s95 offen offset:1024 lds
  buffer_load_dwordx4 v239, s[8:11], s95 offen offset:2048 lds
  s_add_u32 s95, s95, 196608
  s_add_u32 m0, s94, 24576
  s_nop 0
  buffer_load_dwordx4 v237, s[4:7], s95 offen lds
  buffer_load_dwordx4 v238, s[4:7], s95 offen offset:1024 lds
  buffer_load_dwordx4 v239, s[4:7], s95 offen offset:2048 lds
  s_add_u32 m0, s94, 36864
  s_nop 0
  buffer_load_dwordx4 v237, s[8:11], s95 offen lds
  buffer_load_dwordx4 v238, s[8:11], s95 offen offset:1024 lds
  buffer_load_dwordx4 v239, s[8:11], s95 offen offset:2048 lds
  s_add_u32 s95, s95, 196608
  s_add_u32 m0, s94, 49152
  s_nop 0
  buffer_load_dwordx4 v237, s[4:7], s95 offen lds
  buffer_load_dwordx4 v238, s[4:7], s95 offen offset:1024 lds
  buffer_load_dwordx4 v239, s[4:7], s95 offen offset:2048 lds
  s_add_u32 m0, s94, 61440
  s_nop 0
  buffer_load_dwordx4 v237, s[8:11], s95 offen lds
  buffer_load_dwordx4 v238, s[8:11], s95 offen offset:1024 lds
  buffer_load_dwordx4 v239, s[8:11], s95 offen offset:2048 lds
  s_add_u32 s95, s95, 196608
  s_add_u32 m0, s94, 73728
  s_nop 0
  buffer_load_dwordx4 v237, s[4:7], s95 offen lds
  buffer_load_dwordx4 v238, s[4:7], s95 offen offset:1024 lds
  buffer_load_dwordx4 v239, s[4:7], s95 offen offset:2048 lds
  s_add_u32 m0, s94, 86016
  s_nop 0
  buffer_load_dwordx4 v237, s[8:11], s95 offen lds
  buffer_load_dwordx4 v238, s[8:11], s95 offen offset:1024 lds
  buffer_load_dwordx4 v239, s[8:11], s95 offen offset:2048 lds
  v_add_u32 v11, 152832, v11
  ds_read_b128 v[124:127], v11 offset:0
  ds_read_b128 v[128:131], v11 offset:64
  ds_read_b128 v[132:135], v11 offset:256
  ds_read_b128 v[136:139], v11 offset:320
  ds_read_b128 v[140:143], v11 offset:512
  ds_read_b128 v[144:147], v11 offset:576
  ds_read_b128 v[148:151], v11 offset:5120
  ds_read_b128 v[152:155], v11 offset:5184
  ds_read_b128 v[156:159], v11 offset:5376
  ds_read_b128 v[160:163], v11 offset:5440
  ds_read_b128 v[164:167], v11 offset:5632
  ds_read_b128 v[168:171], v11 offset:5696
  ds_read_b128 v[172:175], v11 offset:2560
  ds_read_b128 v[176:179], v11 offset:2624
  ds_read_b128 v[180:183], v11 offset:2816
  ds_read_b128 v[184:187], v11 offset:2880
  ds_read_b128 v[188:191], v11 offset:3072
  ds_read_b128 v[192:195], v11 offset:3136
  s_mov_b32 s100, 0x3f80
  s_mov_b32 s101, 0x3f800000
  v_mov_b64 v[196:197], 0
  v_mov_b64 v[198:199], 0
  v_mov_b64 v[200:201], 0
  v_mov_b64 v[202:203], 0
  v_mov_b64 v[204:205], 0
  v_mov_b64 v[206:207], 0
  v_mov_b64 v[208:209], 0
  v_mov_b64 v[210:211], 0
  v_mov_b64 v[212:213], 0
  v_mov_b64 v[214:215], 0
  v_mov_b64 v[216:217], 0
  v_mov_b64 v[218:219], 0
  s_waitcnt vmcnt(45)
  v_dot2c_f32_bf16 v196, s100, v16
  v_dot2c_f32_bf16 v197, s101, v16
  v_dot2c_f32_bf16 v198, s100, v17
  v_dot2c_f32_bf16 v199, s101, v17
  v_dot2c_f32_bf16 v200, s100, v18
  v_dot2c_f32_bf16 v201, s101, v18
  v_dot2c_f32_bf16 v202, s100, v19
  v_dot2c_f32_bf16 v203, s101, v19
  v_dot2c_f32_bf16 v204, s100, v20
  v_dot2c_f32_bf16 v205, s101, v20
  v_dot2c_f32_bf16 v206, s100, v21
  v_dot2c_f32_bf16 v207, s101, v21
  v_dot2c_f32_bf16 v208, s100, v22
  v_dot2c_f32_bf16 v209, s101, v22
  v_dot2c_f32_bf16 v210, s100, v23
  v_dot2c_f32_bf16 v211, s101, v23
  v_dot2c_f32_bf16 v212, s100, v24
  v_dot2c_f32_bf16 v213, s101, v24
  v_dot2c_f32_bf16 v214, s100, v25
  v_dot2c_f32_bf16 v215, s101, v25
  v_dot2c_f32_bf16 v216, s100, v26
  v_dot2c_f32_bf16 v217, s101, v26
  v_dot2c_f32_bf16 v218, s100, v27
  v_dot2c_f32_bf16 v219, s101, v27
  s_waitcnt vmcnt(42)
  v_dot2c_f32_bf16 v196, s100, v28
  v_dot2c_f32_bf16 v197, s101, v28
  v_dot2c_f32_bf16 v198, s100, v29
  v_dot2c_f32_bf16 v199, s101, v29
  v_dot2c_f32_bf16 v200, s100, v30
  v_dot2c_f32_bf16 v201, s101, v30
  v_dot2c_f32_bf16 v202, s100, v31
  v_dot2c_f32_bf16 v203, s101, v31
  v_dot2c_f32_bf16 v204, s100, v32
  v_dot2c_f32_bf16 v205, s101, v32
  v_dot2c_f32_bf16 v206, s100, v33
  v_dot2c_f32_bf16 v207, s101, v33
  v_dot2c_f32_bf16 v208, s100, v34
  v_dot2c_f32_bf16 v209, s101, v34
  v_dot2c_f32_bf16 v210, s100, v35
  v_dot2c_f32_bf16 v211, s101, v35
  v_dot2c_f32_bf16 v212, s100, v36
  v_dot2c_f32_bf16 v213, s101, v36
  v_dot2c_f32_bf16 v214, s100, v37
  v_dot2c_f32_bf16 v215, s101, v37
  v_dot2c_f32_bf16 v216, s100, v38
  v_dot2c_f32_bf16 v217, s101, v38
  v_dot2c_f32_bf16 v218, s100, v39
  v_dot2c_f32_bf16 v219, s101, v39
  s_waitcnt vmcnt(39)
  v_dot2c_f32_bf16 v196, s100, v40
  v_dot2c_f32_bf16 v197, s101, v40
  v_dot2c_f32_bf16 v198, s100, v41
  v_dot2c_f32_bf16 v199, s101, v41
  v_dot2c_f32_bf16 v200, s100, v42
  v_dot2c_f32_bf16 v201, s101, v42
  v_dot2c_f32_bf16 v202, s100, v43
  v_dot2c_f32_bf16 v203, s101, v43
  v_dot2c_f32_bf16 v204, s100, v44
  v_dot2c_f32_bf16 v205, s101, v44
  v_dot2c_f32_bf16 v206, s100, v45
  v_dot2c_f32_bf16 v207, s101, v45
  v_dot2c_f32_bf16 v208, s100, v46
  v_dot2c_f32_bf16 v209, s101, v46
  v_dot2c_f32_bf16 v210, s100, v47
  v_dot2c_f32_bf16 v211, s101, v47
  v_dot2c_f32_bf16 v212, s100, v48
  v_dot2c_f32_bf16 v213, s101, v48
  v_dot2c_f32_bf16 v214, s100, v49
  v_dot2c_f32_bf16 v215, s101, v49
  v_dot2c_f32_bf16 v216, s100, v50
  v_dot2c_f32_bf16 v217, s101, v50
  v_dot2c_f32_bf16 v218, s100, v51
  v_dot2c_f32_bf16 v219, s101, v51
  s_waitcnt vmcnt(36)
  v_dot2c_f32_bf16 v196, s100, v52
  v_dot2c_f32_bf16 v197, s101, v52
  v_dot2c_f32_bf16 v198, s100, v53
  v_dot2c_f32_bf16 v199, s101, v53
  v_dot2c_f32_bf16 v200, s100, v54
  v_dot2c_f32_bf16 v201, s101, v54
  v_dot2c_f32_bf16 v202, s100, v55
  v_dot2c_f32_bf16 v203, s101, v55
  v_dot2c_f32_bf16 v204, s100, v56
  v_dot2c_f32_bf16 v205, s101, v56
  v_dot2c_f32_bf16 v206, s100, v57
  v_dot2c_f32_bf16 v207, s101, v57
  v_dot2c_f32_bf16 v208, s100, v58
  v_dot2c_f32_bf16 v209, s101, v58
  v_dot2c_f32_bf16 v210, s100, v59
  v_dot2c_f32_bf16 v211, s101, v59
  v_dot2c_f32_bf16 v212, s100, v60
  v_dot2c_f32_bf16 v213, s101, v60
  v_dot2c_f32_bf16 v214, s100, v61
  v_dot2c_f32_bf16 v215, s101, v61
  v_dot2c_f32_bf16 v216, s100, v62
  v_dot2c_f32_bf16 v217, s101, v62
  v_dot2c_f32_bf16 v218, s100, v63
  v_dot2c_f32_bf16 v219, s101, v63
  s_waitcnt vmcnt(33)
  v_dot2c_f32_bf16 v196, s100, v64
  v_dot2c_f32_bf16 v197, s101, v64
  v_dot2c_f32_bf16 v198, s100, v65
  v_dot2c_f32_bf16 v199, s101, v65
  v_dot2c_f32_bf16 v200, s100, v66
  v_dot2c_f32_bf16 v201, s101, v66
  v_dot2c_f32_bf16 v202, s100, v67
  v_dot2c_f32_bf16 v203, s101, v67
  v_dot2c_f32_bf16 v204, s100, v68
  v_dot2c_f32_bf16 v205, s101, v68
  v_dot2c_f32_bf16 v206, s100, v69
  v_dot2c_f32_bf16 v207, s101, v69
  v_dot2c_f32_bf16 v208, s100, v70
  v_dot2c_f32_bf16 v209, s101, v70
  v_dot2c_f32_bf16 v210, s100, v71
  v_dot2c_f32_bf16 v211, s101, v71
  v_dot2c_f32_bf16 v212, s100, v72
  v_dot2c_f32_bf16 v213, s101, v72
  v_dot2c_f32_bf16 v214, s100, v73
  v_dot2c_f32_bf16 v215, s101, v73
  v_dot2c_f32_bf16 v216, s100, v74
  v_dot2c_f32_bf16 v217, s101, v74
  v_dot2c_f32_bf16 v218, s100, v75
  v_dot2c_f32_bf16 v219, s101, v75
  s_waitcnt vmcnt(30)
  v_dot2c_f32_bf16 v196, s100, v76
  v_dot2c_f32_bf16 v197, s101, v76
  v_dot2c_f32_bf16 v198, s100, v77
  v_dot2c_f32_bf16 v199, s101, v77
  v_dot2c_f32_bf16 v200, s100, v78
  v_dot2c_f32_bf16 v201, s101, v78
  v_dot2c_f32_bf16 v202, s100, v79
  v_dot2c_f32_bf16 v203, s101, v79
  v_dot2c_f32_bf16 v204, s100, v80
  v_dot2c_f32_bf16 v205, s101, v80
  v_dot2c_f32_bf16 v206, s100, v81
  v_dot2c_f32_bf16 v207, s101, v81
  v_dot2c_f32_bf16 v208, s100, v82
  v_dot2c_f32_bf16 v209, s101, v82
  v_dot2c_f32_bf16 v210, s100, v83
  v_dot2c_f32_bf16 v211, s101, v83
  v_dot2c_f32_bf16 v212, s100, v84
  v_dot2c_f32_bf16 v213, s101, v84
  v_dot2c_f32_bf16 v214, s100, v85
  v_dot2c_f32_bf16 v215, s101, v85
  v_dot2c_f32_bf16 v216, s100, v86
  v_dot2c_f32_bf16 v217, s101, v86
  v_dot2c_f32_bf16 v218, s100, v87
  v_dot2c_f32_bf16 v219, s101, v87
  s_waitcnt vmcnt(27)
  v_dot2c_f32_bf16 v196, s100, v88
  v_dot2c_f32_bf16 v197, s101, v88
  v_dot2c_f32_bf16 v198, s100, v89
  v_dot2c_f32_bf16 v199, s101, v89
  v_dot2c_f32_bf16 v200, s100, v90
  v_dot2c_f32_bf16 v201, s101, v90
  v_dot2c_f32_bf16 v202, s100, v91
  v_dot2c_f32_bf16 v203, s101, v91
  v_dot2c_f32_bf16 v204, s100, v92
  v_dot2c_f32_bf16 v205, s101, v92
  v_dot2c_f32_bf16 v206, s100, v93
  v_dot2c_f32_bf16 v207, s101, v93
  v_dot2c_f32_bf16 v208, s100, v94
  v_dot2c_f32_bf16 v209, s101, v94
  v_dot2c_f32_bf16 v210, s100, v95
  v_dot2c_f32_bf16 v211, s101, v95
  v_dot2c_f32_bf16 v212, s100, v96
  v_dot2c_f32_bf16 v213, s101, v96
  v_dot2c_f32_bf16 v214, s100, v97
  v_dot2c_f32_bf16 v215, s101, v97
  v_dot2c_f32_bf16 v216, s100, v98
  v_dot2c_f32_bf16 v217, s101, v98
  v_dot2c_f32_bf16 v218, s100, v99
  v_dot2c_f32_bf16 v219, s101, v99
  s_waitcnt vmcnt(24)
  v_dot2c_f32_bf16 v196, s100, v100
  v_dot2c_f32_bf16 v197, s101, v100
  v_dot2c_f32_bf16 v198, s100, v101
  v_dot2c_f32_bf16 v199, s101, v101
  v_dot2c_f32_bf16 v200, s100, v102
  v_dot2c_f32_bf16 v201, s101, v102
  v_dot2c_f32_bf16 v202, s100, v103
  v_dot2c_f32_bf16 v203, s101, v103
  v_dot2c_f32_bf16 v204, s100, v104
  v_dot2c_f32_bf16 v205, s101, v104
  v_dot2c_f32_bf16 v206, s100, v105
  v_dot2c_f32_bf16 v207, s101, v105
  v_dot2c_f32_bf16 v208, s100, v106
  v_dot2c_f32_bf16 v209, s101, v106
  v_dot2c_f32_bf16 v210, s100, v107
  v_dot2c_f32_bf16 v211, s101, v107
  v_dot2c_f32_bf16 v212, s100, v108
  v_dot2c_f32_bf16 v213, s101, v108
  v_dot2c_f32_bf16 v214, s100, v109
  v_dot2c_f32_bf16 v215, s101, v109
  v_dot2c_f32_bf16 v216, s100, v110
  v_dot2c_f32_bf16 v217, s101, v110
  v_dot2c_f32_bf16 v218, s100, v111
  v_dot2c_f32_bf16 v219, s101, v111
  s_waitcnt lgkmcnt(0)
  v_lshlrev_b32 v220, 16, v112
  v_and_b32 v221, 0xffff0000, v112
  v_pk_fma_f32 v[196:197], v[196:197], v[124:125], v[220:221]
  v_cvt_pk_bf16_f32 v112, v196, v197
  v_lshlrev_b32 v196, 16, v112
  v_and_b32 v197, 0xffff0000, v112
  v_lshlrev_b32 v220, 16, v113
  v_and_b32 v221, 0xffff0000, v113
  v_pk_fma_f32 v[198:199], v[198:199], v[126:127], v[220:221]
  v_cvt_pk_bf16_f32 v113, v198, v199
  v_lshlrev_b32 v198, 16, v113
  v_and_b32 v199, 0xffff0000, v113
  v_lshlrev_b32 v220, 16, v114
  v_and_b32 v221, 0xffff0000, v114
  v_pk_fma_f32 v[200:201], v[200:201], v[128:129], v[220:221]
  v_cvt_pk_bf16_f32 v114, v200, v201
  v_lshlrev_b32 v200, 16, v114
  v_and_b32 v201, 0xffff0000, v114
  v_lshlrev_b32 v220, 16, v115
  v_and_b32 v221, 0xffff0000, v115
  v_pk_fma_f32 v[202:203], v[202:203], v[130:131], v[220:221]
  v_cvt_pk_bf16_f32 v115, v202, v203
  v_lshlrev_b32 v202, 16, v115
  v_and_b32 v203, 0xffff0000, v115
  v_lshlrev_b32 v220, 16, v116
  v_and_b32 v221, 0xffff0000, v116
  v_pk_fma_f32 v[204:205], v[204:205], v[132:133], v[220:221]
  v_cvt_pk_bf16_f32 v116, v204, v205
  v_lshlrev_b32 v204, 16, v116
  v_and_b32 v205, 0xffff0000, v116
  v_lshlrev_b32 v220, 16, v117
  v_and_b32 v221, 0xffff0000, v117
  v_pk_fma_f32 v[206:207], v[206:207], v[134:135], v[220:221]
  v_cvt_pk_bf16_f32 v117, v206, v207
  v_lshlrev_b32 v206, 16, v117
  v_and_b32 v207, 0xffff0000, v117
  v_lshlrev_b32 v220, 16, v118
  v_and_b32 v221, 0xffff0000, v118
  v_pk_fma_f32 v[208:209], v[208:209], v[136:137], v[220:221]
  v_cvt_pk_bf16_f32 v118, v208, v209
  v_lshlrev_b32 v208, 16, v118
  v_and_b32 v209, 0xffff0000, v118
  v_lshlrev_b32 v220, 16, v119
  v_and_b32 v221, 0xffff0000, v119
  v_pk_fma_f32 v[210:211], v[210:211], v[138:139], v[220:221]
  v_cvt_pk_bf16_f32 v119, v210, v211
  v_lshlrev_b32 v210, 16, v119
  v_and_b32 v211, 0xffff0000, v119
  v_lshlrev_b32 v220, 16, v120
  v_and_b32 v221, 0xffff0000, v120
  v_pk_fma_f32 v[212:213], v[212:213], v[140:141], v[220:221]
  v_cvt_pk_bf16_f32 v120, v212, v213
  v_lshlrev_b32 v212, 16, v120
  v_and_b32 v213, 0xffff0000, v120
  v_lshlrev_b32 v220, 16, v121
  v_and_b32 v221, 0xffff0000, v121
  v_pk_fma_f32 v[214:215], v[214:215], v[142:143], v[220:221]
  v_cvt_pk_bf16_f32 v121, v214, v215
  v_lshlrev_b32 v214, 16, v121
  v_and_b32 v215, 0xffff0000, v121
  v_lshlrev_b32 v220, 16, v122
  v_and_b32 v221, 0xffff0000, v122
  v_pk_fma_f32 v[216:217], v[216:217], v[144:145], v[220:221]
  v_cvt_pk_bf16_f32 v122, v216, v217
  v_lshlrev_b32 v216, 16, v122
  v_and_b32 v217, 0xffff0000, v122
  v_lshlrev_b32 v220, 16, v123
  v_and_b32 v221, 0xffff0000, v123
  v_pk_fma_f32 v[218:219], v[218:219], v[146:147], v[220:221]
  v_cvt_pk_bf16_f32 v123, v218, v219
  v_lshlrev_b32 v218, 16, v123
  v_and_b32 v219, 0xffff0000, v123
  s_add_u32 s20, s50, 49283072
  s_addc_u32 s21, s51, 0
  s_mov_b32 s22, 2621440
  s_mov_b32 s23, 0x20000
  s_add_u32 s94, s92, 4096
  buffer_store_dwordx4 v[112:115], v4, s[20:23], s92 offen sc1
  buffer_store_dwordx4 v[116:119], v4, s[20:23], s92 offen offset:2048 sc1
  s_mov_b32 exec_hi, 0
  buffer_store_dwordx4 v[120:123], v4, s[20:23], s94 offen sc1
  s_mov_b32 exec_hi, -1
  v_pk_add_f32 v[220:221], v[196:197], v[200:201]
  v_pk_add_f32 v[222:223], v[198:199], v[202:203]
  v_pk_add_f32 v[220:221], v[204:205], v[220:221]
  v_pk_add_f32 v[222:223], v[206:207], v[222:223]
  v_pk_add_f32 v[220:221], v[208:209], v[220:221]
  v_pk_add_f32 v[222:223], v[210:211], v[222:223]
  s_mov_b32 exec_hi, 0
  v_pk_add_f32 v[220:221], v[212:213], v[220:221]
  v_pk_add_f32 v[222:223], v[214:215], v[222:223]
  v_pk_add_f32 v[220:221], v[216:217], v[220:221]
  v_pk_add_f32 v[222:223], v[218:219], v[222:223]
  s_mov_b32 exec_hi, -1
  v_pk_add_f32 v[220:221], v[220:221], v[222:223]
  v_add_f32 v220, v220, v221
  v_mov_b32 v221, v220
  s_nop 1
  v_add_f32_dpp v220, v221, v220 row_ror:8 row_mask:0xf bank_mask:0xf
  v_mov_b32 v221, v220
  s_nop 1
  v_permlane16_swap_b32 v221, v220
  v_add_f32 v220, v221, v220
  v_mov_b32 v221, v220
  s_nop 1
  v_permlane32_swap_b32 v221, v220
  v_add_f32 v220, v221, v220
  ds_write_b32 v6, v220 offset:0
  s_waitcnt lgkmcnt(0)
  s_barrier
  ds_read_b128 v[224:227], v7 offset:0
  s_waitcnt lgkmcnt(0)
  v_add_f32 v224, v224, v225
  v_add_f32 v226, v226, v227
  v_add_f32 v220, v224, v226
  v_mul_f32 v220, 0xbacccccd, v220
  v_pk_add_f32 v[196:197], v[196:197], v[220:221] op_sel_hi:[1,0]
  v_pk_add_f32 v[198:199], v[198:199], v[220:221] op_sel_hi:[1,0]
  v_pk_add_f32 v[200:201], v[200:201], v[220:221] op_sel_hi:[1,0]
  v_pk_add_f32 v[202:203], v[202:203], v[220:221] op_sel_hi:[1,0]
  v_pk_add_f32 v[204:205], v[204:205], v[220:221] op_sel_hi:[1,0]
  v_pk_add_f32 v[206:207], v[206:207], v[220:221] op_sel_hi:[1,0]
  v_pk_add_f32 v[208:209], v[208:209], v[220:221] op_sel_hi:[1,0]
  v_pk_add_f32 v[210:211], v[210:211], v[220:221] op_sel_hi:[1,0]
  v_pk_add_f32 v[212:213], v[212:213], v[220:221] op_sel_hi:[1,0]
  v_pk_add_f32 v[214:215], v[214:215], v[220:221] op_sel_hi:[1,0]
  v_pk_add_f32 v[216:217], v[216:217], v[220:221] op_sel_hi:[1,0]
  v_pk_add_f32 v[218:219], v[218:219], v[220:221] op_sel_hi:[1,0]
  v_pk_mul_f32 v[220:221], v[196:197], v[196:197]
  v_pk_mul_f32 v[222:223], v[198:199], v[198:199]
  v_pk_fma_f32 v[220:221], v[200:201], v[200:201], v[220:221]
  v_pk_fma_f32 v[222:223], v[202:203], v[202:203], v[222:223]
  v_pk_fma_f32 v[220:221], v[204:205], v[204:205], v[220:221]
  v_pk_fma_f32 v[222:223], v[206:207], v[206:207], v[222:223]
  v_pk_fma_f32 v[220:221], v[208:209], v[208:209], v[220:221]
  v_pk_fma_f32 v[222:223], v[210:211], v[210:211], v[222:223]
  s_mov_b32 exec_hi, 0
  v_pk_fma_f32 v[220:221], v[212:213], v[212:213], v[220:221]
  v_pk_fma_f32 v[222:223], v[214:215], v[214:215], v[222:223]
  v_pk_fma_f32 v[220:221], v[216:217], v[216:217], v[220:221]
  v_pk_fma_f32 v[222:223], v[218:219], v[218:219], v[222:223]
  s_mov_b32 exec_hi, -1
  v_pk_add_f32 v[220:221], v[220:221], v[222:223]
  v_add_f32 v220, v220, v221
  v_mov_b32 v221, v220
  s_nop 1
  v_add_f32_dpp v220, v221, v220 row_ror:8 row_mask:0xf bank_mask:0xf
  v_mov_b32 v221, v220
  s_nop 1
  v_permlane16_swap_b32 v221, v220
  v_add_f32 v220, v221, v220
  v_mov_b32 v221, v220
  s_nop 1
  v_permlane32_swap_b32 v221, v220
  v_add_f32 v220, v221, v220
  ds_write_b32 v6, v220 offset:128
  s_waitcnt lgkmcnt(0)
  s_barrier
  ds_read_b128 v[224:227], v7 offset:128
  s_waitcnt lgkmcnt(0)
  v_add_f32 v224, v224, v225
  v_add_f32 v226, v226, v227
  v_add_f32 v220, v224, v226
  v_mov_b32 v221, 0x3727c5ac
  v_fmac_f32 v221, 0x3acccccd, v220
  v_rsq_f32 v220, v221
  s_nop 0
  v_pk_mul_f32 v[196:197], v[196:197], v[220:221] op_sel_hi:[1,0]
  v_pk_mul_f32 v[198:199], v[198:199], v[220:221] op_sel_hi:[1,0]
  v_pk_mul_f32 v[200:201], v[200:201], v[220:221] op_sel_hi:[1,0]
  v_pk_mul_f32 v[202:203], v[202:203], v[220:221] op_sel_hi:[1,0]
  v_pk_mul_f32 v[204:205], v[204:205], v[220:221] op_sel_hi:[1,0]
  v_pk_mul_f32 v[206:207], v[206:207], v[220:221] op_sel_hi:[1,0]
  v_pk_mul_f32 v[208:209], v[208:209], v[220:221] op_sel_hi:[1,0]
  v_pk_mul_f32 v[210:211], v[210:211], v[220:221] op_sel_hi:[1,0]
  v_pk_mul_f32 v[212:213], v[212:213], v[220:221] op_sel_hi:[1,0]
  v_pk_mul_f32 v[214:215], v[214:215], v[220:221] op_sel_hi:[1,0]
  v_pk_mul_f32 v[216:217], v[216:217], v[220:221] op_sel_hi:[1,0]
  v_pk_mul_f32 v[218:219], v[218:219], v[220:221] op_sel_hi:[1,0]
  v_pk_fma_f32 v[196:197], v[196:197], v[148:149], v[172:173]
  v_pk_fma_f32 v[198:199], v[198:199], v[150:151], v[174:175]
  v_pk_fma_f32 v[200:201], v[200:201], v[152:153], v[176:177]
  v_pk_fma_f32 v[202:203], v[202:203], v[154:155], v[178:179]
  v_pk_fma_f32 v[204:205], v[204:205], v[156:157], v[180:181]
  v_pk_fma_f32 v[206:207], v[206:207], v[158:159], v[182:183]
  v_pk_fma_f32 v[208:209], v[208:209], v[160:161], v[184:185]
  v_pk_fma_f32 v[210:211], v[210:211], v[162:163], v[186:187]
  v_pk_fma_f32 v[212:213], v[212:213], v[164:165], v[188:189]
  v_pk_fma_f32 v[214:215], v[214:215], v[166:167], v[190:191]
  v_pk_fma_f32 v[216:217], v[216:217], v[168:169], v[192:193]
  v_pk_fma_f32 v[218:219], v[218:219], v[170:171], v[194:195]
  v_cvt_pk_bf16_f32 v16, v196, v197
  v_cvt_pk_bf16_f32 v17, v198, v199
  v_cvt_pk_bf16_f32 v18, v200, v201
  v_cvt_pk_bf16_f32 v19, v202, v203
  v_cvt_pk_bf16_f32 v20, v204, v205
  v_cvt_pk_bf16_f32 v21, v206, v207
  v_cvt_pk_bf16_f32 v22, v208, v209
  v_cvt_pk_bf16_f32 v23, v210, v211
  v_cvt_pk_bf16_f32 v24, v212, v213
  v_cvt_pk_bf16_f32 v25, v214, v215
  v_cvt_pk_bf16_f32 v26, v216, v217
  v_cvt_pk_bf16_f32 v27, v218, v219
  s_add_u32 s84, s50, 52428800
  s_addc_u32 s85, s51, 0
  s_mov_b32 s86, 2621440
  s_mov_b32 s87, 0x20000
  buffer_store_dwordx4 v[16:19], v4, s[84:87], s92 offen sc1
  buffer_store_dwordx4 v[20:23], v4, s[84:87], s92 offen offset:2048 sc1
  s_mov_b32 exec_hi, 0
  buffer_store_dwordx4 v[24:27], v4, s[84:87], s94 offen sc1
  s_mov_b32 exec_hi, -1
  s_waitcnt vmcnt(0)
  s_barrier
s_cmp_eq_u32 s82, 0
s_cbranch_scc0 adaLN_cond__sliding_block_cached__glu_gated_swiglu__prompt_kernel_se_nosig
s_lshr_b32 s83, s2, 4
s_add_u32 s83, s83, 40
s_lshl_b32 s83, s83, 7
s_and_b32 s3, s2, 15
s_lshl_b32 s3, s3, 2
s_add_u32 s83, s83, s3
s_add_u32 s83, s83, 62914560
v_mov_b32 v253, s83
v_mov_b32 v254, 1
s_mov_b64 exec, 1
global_store_dword v253, v254, s[50:51] sc1
s_mov_b64 exec, -1
adaLN_cond__sliding_block_cached__glu_gated_swiglu__prompt_kernel_se_nosig:
  s_and_b32 s38, s2, 3
  s_lshl_b32 s38, s38, 2
  s_bfe_u32 s39, s2, 0x20003
  s_add_u32 s35, s38, s39
  s_bfe_u32 s38, s2, 0x10002
  s_lshl_b32 s38, s38, 3
  s_lshr_b32 s39, s2, 5
  s_add_u32 s36, s38, s39
  v_lshlrev_b32 v204, 4, v255
  v_lshlrev_b32 v205, 4, v255
  v_add_u32 v205, 20480, v205
  v_and_b32 v218, 15, v255
  v_lshrrev_b32 v219, 4, v255
  v_lshrrev_b32 v221, 2, v218
  v_lshl_add_u32 v221, v219, 2, v221
  v_mul_u32_u24 v220, 192, v221
  v_bfe_u32 v221, v218, 1, 1
  v_lshl_add_u32 v220, v221, 4, v220
  v_and_b32 v221, 1, v218
  v_lshl_add_u32 v220, v221, 3, v220
  v_and_b32 v221, 1, v219
  v_xor_b32 v222, 0, v221
  v_lshl_add_u32 v198, v222, 5, v220
  v_xor_b32 v222, 1, v221
  v_lshl_add_u32 v199, v222, 5, v220
  s_mov_b32 s4, s56
  s_mov_b32 s5, s57
  s_mov_b32 s6, 1966080
  s_mov_b32 s7, 0x20000
  s_mov_b32 s8, s58
  s_mov_b32 s9, s59
  s_mov_b32 s10, 1966080
  s_mov_b32 s11, 0x20000
  s_add_u32 s12, s50, 52428800
  s_addc_u32 s13, s51, 0
  s_mov_b32 s14, 2621440
  s_mov_b32 s15, 0x20000
  s_add_u32 s16, s50, 55574528
  s_addc_u32 s17, s51, 0
  s_mov_b32 s18, 6291456
  s_mov_b32 s19, 0x20000
  s_mov_b32 s40, -122880
  s_mov_b32 s41, 24576
  s_mov_b32 s30, 0
  s_mov_b32 s32, 0
  s_mov_b32 s30, 4
  s_mul_i32 s29, s82, 3072
  s_add_u32 s29, s29, 98304
  s_mul_i32 s28, s35, 192
  s_add_u32 s28, s28, 786432
  s_lshl_b32 s38, s36, 3
  s_lshl_b32 s39, s82, 1
  s_add_u32 s38, s38, s39
  s_mul_i32 s34, s38, 20480
  s_add_u32 s37, s34, 20480
  s_mov_b32 s88, 2621440
  s_add_u32 s84, s50, 71303168
  s_addc_u32 s85, s51, 0
  s_mov_b32 s86, 1966080
  s_mov_b32 s87, 0x20000
  s_and_b32 s94, s2, 1
  s_mul_i32 s89, s94, 983040
  s_add_u32 s86, s89, 983040
  s_lshr_b32 s94, s2, 3
  s_lshl_b32 s94, s94, 2
  s_add_u32 s94, s94, s82
  s_mul_i32 s94, s94, 10240
  s_add_u32 s89, s89, s94
  s_lshl_b32 s91, s82, 10
  s_add_u32 s91, s91, 147456
  v_mov_b64 v[0:1], 0
  v_mov_b64 v[2:3], 0
  v_mov_b64 v[4:5], 0
  v_mov_b64 v[6:7], 0
  v_mov_b64 v[8:9], 0
  v_mov_b64 v[10:11], 0
  v_mov_b64 v[12:13], 0
  v_mov_b64 v[14:15], 0
  v_mov_b64 v[16:17], 0
  v_mov_b64 v[18:19], 0
  v_mov_b64 v[20:21], 0
  v_mov_b64 v[22:23], 0
  v_mov_b64 v[24:25], 0
  v_mov_b64 v[26:27], 0
  v_mov_b64 v[28:29], 0
  v_mov_b64 v[30:31], 0
  v_mov_b64 v[32:33], 0
  v_mov_b64 v[34:35], 0
  v_mov_b64 v[36:37], 0
  v_mov_b64 v[38:39], 0
  v_mov_b64 v[40:41], 0
  v_mov_b64 v[42:43], 0
  v_mov_b64 v[44:45], 0
  v_mov_b64 v[46:47], 0
  v_mov_b64 v[48:49], 0
  v_mov_b64 v[50:51], 0
  v_mov_b64 v[52:53], 0
  v_mov_b64 v[54:55], 0
  v_mov_b64 v[56:57], 0
  v_mov_b64 v[58:59], 0
  v_mov_b64 v[60:61], 0
  v_mov_b64 v[62:63], 0
  v_mov_b64 v[64:65], 0
  v_mov_b64 v[66:67], 0
  v_mov_b64 v[68:69], 0
  v_mov_b64 v[70:71], 0
  v_mov_b64 v[72:73], 0
  v_mov_b64 v[74:75], 0
  v_mov_b64 v[76:77], 0
  v_mov_b64 v[78:79], 0
  v_mov_b64 v[80:81], 0
  v_mov_b64 v[82:83], 0
  v_mov_b64 v[84:85], 0
  v_mov_b64 v[86:87], 0
  v_mov_b64 v[88:89], 0
  v_mov_b64 v[90:91], 0
  v_mov_b64 v[92:93], 0
  v_mov_b64 v[94:95], 0
s_cmp_eq_u32 s82, 0
s_cbranch_scc0 adaLN_cond__sliding_block_cached__glu_gated_swiglu__prompt_kernel_we_nopoll
s_add_u32 s83, s36, 40
s_lshl_b32 s83, s83, 7
s_add_u32 s83, s83, 62914560
v_lshlrev_b32 v253, 2, v255
v_add_u32 v253, s83, v253
s_mov_b32 exec_lo, 0xffff
s_mov_b32 exec_hi, 0x0
s_mov_b32 s3, 400000
global_load_dword v254, v253, s[50:51] sc1
s_sleep 10
adaLN_cond__sliding_block_cached__glu_gated_swiglu__prompt_kernel_we_poll:
global_load_dword v252, v253, s[50:51] sc1
s_waitcnt vmcnt(1)
v_cmp_ne_u32 vcc, 1, v254
s_nop 1
s_cmp_eq_u64 vcc, 0
s_cbranch_scc1 adaLN_cond__sliding_block_cached__glu_gated_swiglu__prompt_kernel_we_ready
global_load_dword v254, v253, s[50:51] sc1
s_waitcnt vmcnt(1)
v_cmp_ne_u32 vcc, 1, v252
s_nop 1
s_cmp_eq_u64 vcc, 0
s_cbranch_scc1 adaLN_cond__sliding_block_cached__glu_gated_swiglu__prompt_kernel_we_ready
s_sub_u32 s3, s3, 1
s_cmp_lg_u32 s3, 0
s_cbranch_scc1 adaLN_cond__sliding_block_cached__glu_gated_swiglu__prompt_kernel_we_poll
s_endpgm
adaLN_cond__sliding_block_cached__glu_gated_swiglu__prompt_kernel_we_ready:
s_mov_b64 exec, -1
adaLN_cond__sliding_block_cached__glu_gated_swiglu__prompt_kernel_we_nopoll:
  s_barrier
  buffer_load_dwordx4 a[0:3], v204, s[12:15], s34 offen sc1
  buffer_load_dwordx4 a[4:7], v205, s[12:15], s34 offen sc1
  s_add_u32 s34, s34, 1024
  buffer_load_dwordx4 a[8:11], v204, s[12:15], s34 offen sc1
  buffer_load_dwordx4 a[12:15], v205, s[12:15], s34 offen sc1
  s_add_u32 s34, s34, 1024
  buffer_load_dwordx4 a[16:19], v204, s[12:15], s34 offen sc1
  buffer_load_dwordx4 a[20:23], v205, s[12:15], s34 offen sc1
  s_add_u32 s34, s34, 1024
  s_waitcnt vmcnt(4)
  s_barrier
  ds_read_b64_tr_b16 a[192:193], v198 offset:0
  ds_read_b64_tr_b16 a[194:195], v198 offset:3072
  ds_read_b64_tr_b16 a[196:197], v198 offset:12288
  ds_read_b64_tr_b16 a[198:199], v198 offset:15360
  ds_read_b64_tr_b16 a[200:201], v199 offset:0
  ds_read_b64_tr_b16 a[202:203], v199 offset:3072
  ds_read_b64_tr_b16 a[204:205], v199 offset:12288
  ds_read_b64_tr_b16 a[206:207], v199 offset:15360
  ds_read_b64_tr_b16 a[208:209], v198 offset:64
  ds_read_b64_tr_b16 a[210:211], v198 offset:3136
  ds_read_b64_tr_b16 a[212:213], v198 offset:12352
  ds_read_b64_tr_b16 a[214:215], v198 offset:15424
  ds_read_b64_tr_b16 a[216:217], v199 offset:64
  ds_read_b64_tr_b16 a[218:219], v199 offset:3136
  ds_read_b64_tr_b16 a[220:221], v199 offset:12352
  ds_read_b64_tr_b16 a[222:223], v199 offset:15424
  s_waitcnt lgkmcnt(12)
  s_mov_b32 s33, 5
adaLN_cond__sliding_block_cached__glu_gated_swiglu__prompt_kernel_f_loop:
  v_mfma_f32_16x16x32_bf16 v[0:3], a[192:195], a[0:3], v[0:3]
  ds_read_b64_tr_b16 a[224:225], v198 offset:128
  v_mfma_f32_16x16x32_bf16 v[4:7], a[192:195], a[4:7], v[4:7]
  ds_read_b64_tr_b16 a[226:227], v198 offset:3200
  buffer_load_dwordx4 a[24:27], v204, s[12:15], s34 offen sc1
  v_mfma_f32_16x16x32_bf16 v[8:11], a[196:199], a[0:3], v[8:11]
  s_waitcnt lgkmcnt(10)
  ds_read_b64_tr_b16 a[228:229], v198 offset:12416
  v_mfma_f32_16x16x32_bf16 v[12:15], a[196:199], a[4:7], v[12:15]
  ds_read_b64_tr_b16 a[230:231], v198 offset:15488
  v_mfma_f32_16x16x32_bf16 v[16:19], a[200:203], a[0:3], v[16:19]
  ds_read_b64_tr_b16 a[232:233], v199 offset:128
  v_mfma_f32_16x16x32_bf16 v[20:23], a[200:203], a[4:7], v[20:23]
  s_mov_b32 m0, s29
  ds_read_b64_tr_b16 a[234:235], v199 offset:3200
  buffer_load_dwordx4 a[28:31], v205, s[12:15], s34 offen sc1
  v_mfma_f32_16x16x32_bf16 v[24:27], a[204:207], a[0:3], v[24:27]
  s_waitcnt lgkmcnt(10)
  ds_read_b64_tr_b16 a[236:237], v199 offset:12416
  v_mfma_f32_16x16x32_bf16 v[28:31], a[204:207], a[4:7], v[28:31]
  s_add_u32 s34, s34, 1024
  ds_read_b64_tr_b16 a[238:239], v199 offset:15488
  v_mfma_f32_16x16x32_bf16 v[32:35], a[208:211], a[0:3], v[32:35]
  s_cmp_lt_u32 s34, s37
  ds_read_b64_tr_b16 a[192:193], v198 offset:6144
  v_mfma_f32_16x16x32_bf16 v[36:39], a[208:211], a[4:7], v[36:39]
  s_cselect_b32 s14, s88, 0
  ds_read_b64_tr_b16 a[194:195], v198 offset:9216
  buffer_load_dwordx4 v237, s[4:7], s28 offen lds
  v_mfma_f32_16x16x32_bf16 v[40:43], a[212:215], a[0:3], v[40:43]
  s_waitcnt lgkmcnt(10)
  ds_read_b64_tr_b16 a[196:197], v198 offset:18432
  v_mfma_f32_16x16x32_bf16 v[44:47], a[212:215], a[4:7], v[44:47]
  s_add_u32 s32, s32, 1
  ds_read_b64_tr_b16 a[198:199], v198 offset:21504
  v_mfma_f32_16x16x32_bf16 v[48:51], a[216:219], a[0:3], v[48:51]
  s_cmp_eq_u32 s32, 6
  ds_read_b64_tr_b16 a[200:201], v199 offset:6144
  v_mfma_f32_16x16x32_bf16 v[52:55], a[216:219], a[4:7], v[52:55]
  s_cselect_b32 s31, s40, s41
  ds_read_b64_tr_b16 a[202:203], v199 offset:9216
  buffer_load_dwordx4 v238, s[4:7], s28 offen offset:1024 lds
  v_mfma_f32_16x16x32_bf16 v[56:59], a[220:223], a[0:3], v[56:59]
  s_waitcnt lgkmcnt(10)
  ds_read_b64_tr_b16 a[204:205], v199 offset:18432
  v_mfma_f32_16x16x32_bf16 v[60:63], a[220:223], a[4:7], v[60:63]
  s_cselect_b32 s32, 0, s32
  ds_read_b64_tr_b16 a[206:207], v199 offset:21504
  v_mfma_f32_16x16x32_bf16 v[64:67], a[224:227], a[0:3], v[64:67]
  ds_read_b64_tr_b16 a[208:209], v198 offset:6208
  v_mfma_f32_16x16x32_bf16 v[68:71], a[224:227], a[4:7], v[68:71]
  ds_read_b64_tr_b16 a[210:211], v198 offset:9280
  buffer_load_dwordx4 v239, s[4:7], s28 offen offset:2048 lds
  v_mfma_f32_16x16x32_bf16 v[72:75], a[228:231], a[0:3], v[72:75]
  s_waitcnt lgkmcnt(10)
  ds_read_b64_tr_b16 a[212:213], v198 offset:18496
  v_mfma_f32_16x16x32_bf16 v[76:79], a[228:231], a[4:7], v[76:79]
  s_add_u32 m0, s29, 12288
  ds_read_b64_tr_b16 a[214:215], v198 offset:21568
  v_mfma_f32_16x16x32_bf16 v[80:83], a[232:235], a[0:3], v[80:83]
  ds_read_b64_tr_b16 a[216:217], v199 offset:6208
  v_mfma_f32_16x16x32_bf16 v[84:87], a[232:235], a[4:7], v[84:87]
  ds_read_b64_tr_b16 a[218:219], v199 offset:9280
  buffer_load_dwordx4 v237, s[8:11], s28 offen lds
  v_mfma_f32_16x16x32_bf16 v[88:91], a[236:239], a[0:3], v[88:91]
  s_waitcnt vmcnt(9) lgkmcnt(10)
  ds_read_b64_tr_b16 a[220:221], v199 offset:18496
  v_mfma_f32_16x16x32_bf16 v[92:95], a[236:239], a[4:7], v[92:95]
  ds_read_b64_tr_b16 a[222:223], v199 offset:21568
  v_mfma_f32_16x16x32_bf16 v[0:3], a[192:195], a[8:11], v[0:3]
  s_waitcnt vmcnt(8)
  ds_read_b64_tr_b16 a[224:225], v198 offset:6272
  v_mfma_f32_16x16x32_bf16 v[4:7], a[192:195], a[12:15], v[4:7]
  ds_read_b64_tr_b16 a[226:227], v198 offset:9344
  buffer_load_dwordx4 a[0:3], v204, s[12:15], s34 offen sc1
  v_mfma_f32_16x16x32_bf16 v[8:11], a[196:199], a[8:11], v[8:11]
  s_waitcnt lgkmcnt(10)
  ds_read_b64_tr_b16 a[228:229], v198 offset:18560
  v_mfma_f32_16x16x32_bf16 v[12:15], a[196:199], a[12:15], v[12:15]
  ds_read_b64_tr_b16 a[230:231], v198 offset:21632
  v_mfma_f32_16x16x32_bf16 v[16:19], a[200:203], a[8:11], v[16:19]
  s_barrier
  ds_read_b64_tr_b16 a[232:233], v199 offset:6272
  v_add_u32 v198, s31, v198
  v_mfma_f32_16x16x32_bf16 v[20:23], a[200:203], a[12:15], v[20:23]
  ds_read_b64_tr_b16 a[234:235], v199 offset:9344
  buffer_load_dwordx4 a[4:7], v205, s[12:15], s34 offen sc1
  v_mfma_f32_16x16x32_bf16 v[24:27], a[204:207], a[8:11], v[24:27]
  s_waitcnt lgkmcnt(10)
  ds_read_b64_tr_b16 a[236:237], v199 offset:18560
  v_mfma_f32_16x16x32_bf16 v[28:31], a[204:207], a[12:15], v[28:31]
  s_add_u32 s34, s34, 1024
  ds_read_b64_tr_b16 a[238:239], v199 offset:21632
  v_mfma_f32_16x16x32_bf16 v[32:35], a[208:211], a[8:11], v[32:35]
  s_cmp_lt_u32 s34, s37
  ds_read_b64_tr_b16 a[192:193], v198 offset:0
  v_mfma_f32_16x16x32_bf16 v[36:39], a[208:211], a[12:15], v[36:39]
  s_cselect_b32 s14, s88, 0
  ds_read_b64_tr_b16 a[194:195], v198 offset:3072
  buffer_load_dwordx4 v238, s[8:11], s28 offen offset:1024 lds
  v_mfma_f32_16x16x32_bf16 v[40:43], a[212:215], a[8:11], v[40:43]
  s_waitcnt lgkmcnt(10)
  ds_read_b64_tr_b16 a[196:197], v198 offset:12288
  v_add_u32 v199, s31, v199
  v_mfma_f32_16x16x32_bf16 v[44:47], a[212:215], a[12:15], v[44:47]
  ds_read_b64_tr_b16 a[198:199], v198 offset:15360
  v_mfma_f32_16x16x32_bf16 v[48:51], a[216:219], a[8:11], v[48:51]
  ds_read_b64_tr_b16 a[200:201], v199 offset:0
  v_mfma_f32_16x16x32_bf16 v[52:55], a[216:219], a[12:15], v[52:55]
  ds_read_b64_tr_b16 a[202:203], v199 offset:3072
  buffer_load_dwordx4 v239, s[8:11], s28 offen offset:2048 lds
  v_mfma_f32_16x16x32_bf16 v[56:59], a[220:223], a[8:11], v[56:59]
  s_waitcnt lgkmcnt(10)
  ds_read_b64_tr_b16 a[204:205], v199 offset:12288
  v_mfma_f32_16x16x32_bf16 v[60:63], a[220:223], a[12:15], v[60:63]
  s_add_u32 s28, s28, 196608
  ds_read_b64_tr_b16 a[206:207], v199 offset:15360
  v_mfma_f32_16x16x32_bf16 v[64:67], a[224:227], a[8:11], v[64:67]
  ds_read_b64_tr_b16 a[208:209], v198 offset:64
  v_mfma_f32_16x16x32_bf16 v[68:71], a[224:227], a[12:15], v[68:71]
  ds_read_b64_tr_b16 a[210:211], v198 offset:3136
  v_mfma_f32_16x16x32_bf16 v[72:75], a[228:231], a[8:11], v[72:75]
  s_waitcnt lgkmcnt(10)
  ds_read_b64_tr_b16 a[212:213], v198 offset:12352
  v_mfma_f32_16x16x32_bf16 v[76:79], a[228:231], a[12:15], v[76:79]
  s_add_u32 s30, s30, 1
  ds_read_b64_tr_b16 a[214:215], v198 offset:15424
  v_mfma_f32_16x16x32_bf16 v[80:83], a[232:235], a[8:11], v[80:83]
  s_cmp_eq_u32 s30, 6
  ds_read_b64_tr_b16 a[216:217], v199 offset:64
  v_mfma_f32_16x16x32_bf16 v[84:87], a[232:235], a[12:15], v[84:87]
  s_cselect_b32 s38, s40, s41
  ds_read_b64_tr_b16 a[218:219], v199 offset:3136
  v_mfma_f32_16x16x32_bf16 v[88:91], a[236:239], a[8:11], v[88:91]
  s_waitcnt vmcnt(10) lgkmcnt(10)
  ds_read_b64_tr_b16 a[220:221], v199 offset:12352
  v_mfma_f32_16x16x32_bf16 v[92:95], a[236:239], a[12:15], v[92:95]
  s_cselect_b32 s30, 0, s30
  ds_read_b64_tr_b16 a[222:223], v199 offset:15424
  v_mfma_f32_16x16x32_bf16 v[0:3], a[192:195], a[16:19], v[0:3]
  s_add_u32 s29, s29, s38
  ds_read_b64_tr_b16 a[224:225], v198 offset:128
  v_mfma_f32_16x16x32_bf16 v[4:7], a[192:195], a[20:23], v[4:7]
  ds_read_b64_tr_b16 a[226:227], v198 offset:3200
  buffer_load_dwordx4 a[8:11], v204, s[12:15], s34 offen sc1
  v_mfma_f32_16x16x32_bf16 v[8:11], a[196:199], a[16:19], v[8:11]
  s_waitcnt lgkmcnt(10)
  ds_read_b64_tr_b16 a[228:229], v198 offset:12416
  v_mfma_f32_16x16x32_bf16 v[12:15], a[196:199], a[20:23], v[12:15]
  ds_read_b64_tr_b16 a[230:231], v198 offset:15488
  v_mfma_f32_16x16x32_bf16 v[16:19], a[200:203], a[16:19], v[16:19]
  ds_read_b64_tr_b16 a[232:233], v199 offset:128
  v_mfma_f32_16x16x32_bf16 v[20:23], a[200:203], a[20:23], v[20:23]
  s_mov_b32 m0, s29
  ds_read_b64_tr_b16 a[234:235], v199 offset:3200
  buffer_load_dwordx4 a[12:15], v205, s[12:15], s34 offen sc1
  v_mfma_f32_16x16x32_bf16 v[24:27], a[204:207], a[16:19], v[24:27]
  s_waitcnt lgkmcnt(10)
  ds_read_b64_tr_b16 a[236:237], v199 offset:12416
  v_mfma_f32_16x16x32_bf16 v[28:31], a[204:207], a[20:23], v[28:31]
  s_add_u32 s34, s34, 1024
  ds_read_b64_tr_b16 a[238:239], v199 offset:15488
  v_mfma_f32_16x16x32_bf16 v[32:35], a[208:211], a[16:19], v[32:35]
  s_cmp_lt_u32 s34, s37
  ds_read_b64_tr_b16 a[192:193], v198 offset:6144
  v_mfma_f32_16x16x32_bf16 v[36:39], a[208:211], a[20:23], v[36:39]
  s_cselect_b32 s14, s88, 0
  ds_read_b64_tr_b16 a[194:195], v198 offset:9216
  buffer_load_dwordx4 v237, s[4:7], s28 offen lds
  v_mfma_f32_16x16x32_bf16 v[40:43], a[212:215], a[16:19], v[40:43]
  s_waitcnt lgkmcnt(10)
  ds_read_b64_tr_b16 a[196:197], v198 offset:18432
  v_mfma_f32_16x16x32_bf16 v[44:47], a[212:215], a[20:23], v[44:47]
  s_add_u32 s32, s32, 1
  ds_read_b64_tr_b16 a[198:199], v198 offset:21504
  v_mfma_f32_16x16x32_bf16 v[48:51], a[216:219], a[16:19], v[48:51]
  s_cmp_eq_u32 s32, 6
  ds_read_b64_tr_b16 a[200:201], v199 offset:6144
  v_mfma_f32_16x16x32_bf16 v[52:55], a[216:219], a[20:23], v[52:55]
  s_cselect_b32 s31, s40, s41
  ds_read_b64_tr_b16 a[202:203], v199 offset:9216
  buffer_load_dwordx4 v238, s[4:7], s28 offen offset:1024 lds
  v_mfma_f32_16x16x32_bf16 v[56:59], a[220:223], a[16:19], v[56:59]
  s_waitcnt lgkmcnt(10)
  ds_read_b64_tr_b16 a[204:205], v199 offset:18432
  v_mfma_f32_16x16x32_bf16 v[60:63], a[220:223], a[20:23], v[60:63]
  s_cselect_b32 s32, 0, s32
  ds_read_b64_tr_b16 a[206:207], v199 offset:21504
  v_mfma_f32_16x16x32_bf16 v[64:67], a[224:227], a[16:19], v[64:67]
  ds_read_b64_tr_b16 a[208:209], v198 offset:6208
  v_mfma_f32_16x16x32_bf16 v[68:71], a[224:227], a[20:23], v[68:71]
  ds_read_b64_tr_b16 a[210:211], v198 offset:9280
  buffer_load_dwordx4 v239, s[4:7], s28 offen offset:2048 lds
  v_mfma_f32_16x16x32_bf16 v[72:75], a[228:231], a[16:19], v[72:75]
  s_waitcnt lgkmcnt(10)
  ds_read_b64_tr_b16 a[212:213], v198 offset:18496
  v_mfma_f32_16x16x32_bf16 v[76:79], a[228:231], a[20:23], v[76:79]
  s_add_u32 m0, s29, 12288
  ds_read_b64_tr_b16 a[214:215], v198 offset:21568
  v_mfma_f32_16x16x32_bf16 v[80:83], a[232:235], a[16:19], v[80:83]
  ds_read_b64_tr_b16 a[216:217], v199 offset:6208
  v_mfma_f32_16x16x32_bf16 v[84:87], a[232:235], a[20:23], v[84:87]
  ds_read_b64_tr_b16 a[218:219], v199 offset:9280
  buffer_load_dwordx4 v237, s[8:11], s28 offen lds
  v_mfma_f32_16x16x32_bf16 v[88:91], a[236:239], a[16:19], v[88:91]
  s_waitcnt vmcnt(15) lgkmcnt(10)
  ds_read_b64_tr_b16 a[220:221], v199 offset:18496
  v_mfma_f32_16x16x32_bf16 v[92:95], a[236:239], a[20:23], v[92:95]
  ds_read_b64_tr_b16 a[222:223], v199 offset:21568
  v_mfma_f32_16x16x32_bf16 v[0:3], a[192:195], a[24:27], v[0:3]
  s_waitcnt vmcnt(14)
  ds_read_b64_tr_b16 a[224:225], v198 offset:6272
  v_mfma_f32_16x16x32_bf16 v[4:7], a[192:195], a[28:31], v[4:7]
  ds_read_b64_tr_b16 a[226:227], v198 offset:9344
  buffer_load_dwordx4 a[16:19], v204, s[12:15], s34 offen sc1
  v_mfma_f32_16x16x32_bf16 v[8:11], a[196:199], a[24:27], v[8:11]
  s_waitcnt lgkmcnt(10)
  ds_read_b64_tr_b16 a[228:229], v198 offset:18560
  v_mfma_f32_16x16x32_bf16 v[12:15], a[196:199], a[28:31], v[12:15]
  ds_read_b64_tr_b16 a[230:231], v198 offset:21632
  v_mfma_f32_16x16x32_bf16 v[16:19], a[200:203], a[24:27], v[16:19]
  s_barrier
  ds_read_b64_tr_b16 a[232:233], v199 offset:6272
  v_add_u32 v198, s31, v198
  v_mfma_f32_16x16x32_bf16 v[20:23], a[200:203], a[28:31], v[20:23]
  ds_read_b64_tr_b16 a[234:235], v199 offset:9344
  buffer_load_dwordx4 a[20:23], v205, s[12:15], s34 offen sc1
  v_mfma_f32_16x16x32_bf16 v[24:27], a[204:207], a[24:27], v[24:27]
  s_waitcnt lgkmcnt(10)
  ds_read_b64_tr_b16 a[236:237], v199 offset:18560
  v_mfma_f32_16x16x32_bf16 v[28:31], a[204:207], a[28:31], v[28:31]
  s_add_u32 s34, s34, 1024
  ds_read_b64_tr_b16 a[238:239], v199 offset:21632
  v_mfma_f32_16x16x32_bf16 v[32:35], a[208:211], a[24:27], v[32:35]
  s_cmp_lt_u32 s34, s37
  ds_read_b64_tr_b16 a[192:193], v198 offset:0
  v_mfma_f32_16x16x32_bf16 v[36:39], a[208:211], a[28:31], v[36:39]
  s_cselect_b32 s14, s88, 0
  ds_read_b64_tr_b16 a[194:195], v198 offset:3072
  buffer_load_dwordx4 v238, s[8:11], s28 offen offset:1024 lds
  v_mfma_f32_16x16x32_bf16 v[40:43], a[212:215], a[24:27], v[40:43]
  s_waitcnt lgkmcnt(10)
  ds_read_b64_tr_b16 a[196:197], v198 offset:12288
  v_add_u32 v199, s31, v199
  v_mfma_f32_16x16x32_bf16 v[44:47], a[212:215], a[28:31], v[44:47]
  ds_read_b64_tr_b16 a[198:199], v198 offset:15360
  v_mfma_f32_16x16x32_bf16 v[48:51], a[216:219], a[24:27], v[48:51]
  ds_read_b64_tr_b16 a[200:201], v199 offset:0
  v_mfma_f32_16x16x32_bf16 v[52:55], a[216:219], a[28:31], v[52:55]
  ds_read_b64_tr_b16 a[202:203], v199 offset:3072
  buffer_load_dwordx4 v239, s[8:11], s28 offen offset:2048 lds
  v_mfma_f32_16x16x32_bf16 v[56:59], a[220:223], a[24:27], v[56:59]
  s_waitcnt lgkmcnt(10)
  ds_read_b64_tr_b16 a[204:205], v199 offset:12288
  v_mfma_f32_16x16x32_bf16 v[60:63], a[220:223], a[28:31], v[60:63]
  s_add_u32 s28, s28, 196608
  ds_read_b64_tr_b16 a[206:207], v199 offset:15360
  v_mfma_f32_16x16x32_bf16 v[64:67], a[224:227], a[24:27], v[64:67]
  ds_read_b64_tr_b16 a[208:209], v198 offset:64
  v_mfma_f32_16x16x32_bf16 v[68:71], a[224:227], a[28:31], v[68:71]
  ds_read_b64_tr_b16 a[210:211], v198 offset:3136
  v_mfma_f32_16x16x32_bf16 v[72:75], a[228:231], a[24:27], v[72:75]
  s_waitcnt lgkmcnt(10)
  ds_read_b64_tr_b16 a[212:213], v198 offset:12352
  v_mfma_f32_16x16x32_bf16 v[76:79], a[228:231], a[28:31], v[76:79]
  ds_read_b64_tr_b16 a[214:215], v198 offset:15424
  v_mfma_f32_16x16x32_bf16 v[80:83], a[232:235], a[24:27], v[80:83]
  ds_read_b64_tr_b16 a[216:217], v199 offset:64
  v_mfma_f32_16x16x32_bf16 v[84:87], a[232:235], a[28:31], v[84:87]
  ds_read_b64_tr_b16 a[218:219], v199 offset:3136
  v_mfma_f32_16x16x32_bf16 v[88:91], a[236:239], a[24:27], v[88:91]
  s_waitcnt vmcnt(2) lgkmcnt(10)
  ds_read_b64_tr_b16 a[220:221], v199 offset:12352
  v_mfma_f32_16x16x32_bf16 v[92:95], a[236:239], a[28:31], v[92:95]
  ds_read_b64_tr_b16 a[222:223], v199 offset:15424
  s_add_u32 s30, s30, 1
  s_cmp_eq_u32 s30, 6
  s_cselect_b32 s38, s40, s41
  s_cselect_b32 s30, 0, s30
  s_add_u32 s29, s29, s38
  s_sub_u32 s33, s33, 1
  s_cmp_lg_u32 s33, 0
  s_cbranch_scc1 adaLN_cond__sliding_block_cached__glu_gated_swiglu__prompt_kernel_f_loop
  s_waitcnt lgkmcnt(0)
  s_barrier
  s_add_u32 s4, s50, 71303168
  s_addc_u32 s5, s51, 0
  s_mov_b32 s6, 1966080
  s_mov_b32 s7, 0x20000
  s_and_b32 s95, s2, 1
  s_lshl_b32 s95, s95, 2
  s_bfe_u32 s94, s2, 0x20003
  s_add_u32 s95, s95, s94
  s_mul_i32 s95, s95, 48
  s_mul_i32 s94, s82, 12
  s_add_u32 s95, s95, s94
  s_mul_i32 s95, s95, 5120
  s_nop 7
  v_lshlrev_b32 v218, 4, v255
  v_add_u32 v219, 49152, v218
  s_lshl_b32 s38, s36, 3
  s_lshl_b32 s39, s82, 1
  s_add_u32 s38, s38, s39
  s_mul_i32 s28, s38, 48
  s_mul_i32 s39, s35, 3
  s_add_u32 s28, s28, s39
  s_lshl_b32 s28, s28, 10
  v_mov_b32 v220, 0xbfb8aa3b
  v_mov_b32 v221, 0xbfb8aa3b
  v_mov_b32 v222, 1.0
  v_mov_b32 v223, 1.0
  v_pk_mul_f32 v[100:101], v[0:1], v[220:221]
  v_pk_mul_f32 v[102:103], v[2:3], v[220:221]
  v_exp_f32 v100, v100
  v_exp_f32 v101, v101
  v_exp_f32 v102, v102
  v_exp_f32 v103, v103
  v_pk_mul_f32 v[8:9], v[0:1], v[8:9]
  v_pk_mul_f32 v[10:11], v[2:3], v[10:11]
  v_pk_add_f32 v[100:101], v[100:101], v[222:223]
  v_pk_add_f32 v[102:103], v[102:103], v[222:223]
  v_rcp_f32 v100, v100
  v_rcp_f32 v101, v101
  v_rcp_f32 v102, v102
  v_rcp_f32 v103, v103
  s_nop 0
  v_pk_mul_f32 v[100:101], v[100:101], v[8:9]
  v_pk_mul_f32 v[102:103], v[102:103], v[10:11]
  v_pk_mul_f32 v[104:105], v[16:17], v[220:221]
  v_pk_mul_f32 v[106:107], v[18:19], v[220:221]
  v_exp_f32 v104, v104
  v_exp_f32 v105, v105
  v_exp_f32 v106, v106
  v_exp_f32 v107, v107
  v_pk_mul_f32 v[24:25], v[16:17], v[24:25]
  v_pk_mul_f32 v[26:27], v[18:19], v[26:27]
  v_pk_add_f32 v[104:105], v[104:105], v[222:223]
  v_pk_add_f32 v[106:107], v[106:107], v[222:223]
  v_rcp_f32 v104, v104
  v_rcp_f32 v105, v105
  v_rcp_f32 v106, v106
  v_rcp_f32 v107, v107
  s_nop 0
  v_pk_mul_f32 v[104:105], v[104:105], v[24:25]
  v_pk_mul_f32 v[106:107], v[106:107], v[26:27]
  v_cvt_pk_bf16_f32 v108, v100, v101
  v_cvt_pk_bf16_f32 v109, v102, v103
  v_cvt_pk_bf16_f32 v110, v104, v105
  v_cvt_pk_bf16_f32 v111, v106, v107
  buffer_store_dwordx4 v[108:111], v218, s[16:19], s28 offen sc1
  buffer_load_dwordx4 a[0:3], v240, s[4:7], s95 offen sc1
  buffer_load_dwordx4 a[4:7], v240, s[4:7], s95 offen offset:1024 sc1
  v_pk_mul_f32 v[112:113], v[32:33], v[220:221]
  v_pk_mul_f32 v[114:115], v[34:35], v[220:221]
  v_exp_f32 v112, v112
  v_exp_f32 v113, v113
  v_exp_f32 v114, v114
  v_exp_f32 v115, v115
  v_pk_mul_f32 v[40:41], v[32:33], v[40:41]
  v_pk_mul_f32 v[42:43], v[34:35], v[42:43]
  v_pk_add_f32 v[112:113], v[112:113], v[222:223]
  v_pk_add_f32 v[114:115], v[114:115], v[222:223]
  v_rcp_f32 v112, v112
  v_rcp_f32 v113, v113
  v_rcp_f32 v114, v114
  v_rcp_f32 v115, v115
  s_nop 0
  v_pk_mul_f32 v[112:113], v[112:113], v[40:41]
  v_pk_mul_f32 v[114:115], v[114:115], v[42:43]
  v_pk_mul_f32 v[116:117], v[48:49], v[220:221]
  v_pk_mul_f32 v[118:119], v[50:51], v[220:221]
  v_exp_f32 v116, v116
  v_exp_f32 v117, v117
  v_exp_f32 v118, v118
  v_exp_f32 v119, v119
  v_pk_mul_f32 v[56:57], v[48:49], v[56:57]
  v_pk_mul_f32 v[58:59], v[50:51], v[58:59]
  v_pk_add_f32 v[116:117], v[116:117], v[222:223]
  v_pk_add_f32 v[118:119], v[118:119], v[222:223]
  v_rcp_f32 v116, v116
  v_rcp_f32 v117, v117
  v_rcp_f32 v118, v118
  v_rcp_f32 v119, v119
  s_nop 0
  v_pk_mul_f32 v[116:117], v[116:117], v[56:57]
  v_pk_mul_f32 v[118:119], v[118:119], v[58:59]
  v_cvt_pk_bf16_f32 v120, v112, v113
  v_cvt_pk_bf16_f32 v121, v114, v115
  v_cvt_pk_bf16_f32 v122, v116, v117
  v_cvt_pk_bf16_f32 v123, v118, v119
  buffer_store_dwordx4 v[120:123], v218, s[16:19], s28 offen offset:1024 sc1
  buffer_load_dwordx4 a[8:11], v240, s[4:7], s95 offen offset:2048 sc1
  buffer_load_dwordx4 a[12:15], v240, s[4:7], s95 offen offset:3072 sc1
  v_pk_mul_f32 v[100:101], v[64:65], v[220:221]
  v_pk_mul_f32 v[102:103], v[66:67], v[220:221]
  v_exp_f32 v100, v100
  v_exp_f32 v101, v101
  v_exp_f32 v102, v102
  v_exp_f32 v103, v103
  v_pk_mul_f32 v[72:73], v[64:65], v[72:73]
  v_pk_mul_f32 v[74:75], v[66:67], v[74:75]
  v_pk_add_f32 v[100:101], v[100:101], v[222:223]
  v_pk_add_f32 v[102:103], v[102:103], v[222:223]
  v_rcp_f32 v100, v100
  v_rcp_f32 v101, v101
  v_rcp_f32 v102, v102
  v_rcp_f32 v103, v103
  s_nop 0
  v_pk_mul_f32 v[100:101], v[100:101], v[72:73]
  v_pk_mul_f32 v[102:103], v[102:103], v[74:75]
  v_pk_mul_f32 v[104:105], v[80:81], v[220:221]
  v_pk_mul_f32 v[106:107], v[82:83], v[220:221]
  v_exp_f32 v104, v104
  v_exp_f32 v105, v105
  v_exp_f32 v106, v106
  v_exp_f32 v107, v107
  v_pk_mul_f32 v[88:89], v[80:81], v[88:89]
  v_pk_mul_f32 v[90:91], v[82:83], v[90:91]
  v_pk_add_f32 v[104:105], v[104:105], v[222:223]
  v_pk_add_f32 v[106:107], v[106:107], v[222:223]
  v_rcp_f32 v104, v104
  v_rcp_f32 v105, v105
  v_rcp_f32 v106, v106
  v_rcp_f32 v107, v107
  s_nop 0
  v_pk_mul_f32 v[104:105], v[104:105], v[88:89]
  v_pk_mul_f32 v[106:107], v[106:107], v[90:91]
  v_cvt_pk_bf16_f32 v108, v100, v101
  v_cvt_pk_bf16_f32 v109, v102, v103
  v_cvt_pk_bf16_f32 v110, v104, v105
  v_cvt_pk_bf16_f32 v111, v106, v107
  buffer_store_dwordx4 v[108:111], v218, s[16:19], s28 offen offset:2048 sc1
  buffer_load_dwordx4 a[16:19], v241, s[4:7], s95 offen sc1
  s_add_u32 s95, s95, 5120
  buffer_load_dwordx4 a[20:23], v240, s[4:7], s95 offen sc1
  v_pk_mul_f32 v[112:113], v[4:5], v[220:221]
  v_pk_mul_f32 v[114:115], v[6:7], v[220:221]
  v_exp_f32 v112, v112
  v_exp_f32 v113, v113
  v_exp_f32 v114, v114
  v_exp_f32 v115, v115
  v_pk_mul_f32 v[12:13], v[4:5], v[12:13]
  v_pk_mul_f32 v[14:15], v[6:7], v[14:15]
  v_pk_add_f32 v[112:113], v[112:113], v[222:223]
  v_pk_add_f32 v[114:115], v[114:115], v[222:223]
  v_rcp_f32 v112, v112
  v_rcp_f32 v113, v113
  v_rcp_f32 v114, v114
  v_rcp_f32 v115, v115
  s_nop 0
  v_pk_mul_f32 v[112:113], v[112:113], v[12:13]
  v_pk_mul_f32 v[114:115], v[114:115], v[14:15]
  v_pk_mul_f32 v[116:117], v[20:21], v[220:221]
  v_pk_mul_f32 v[118:119], v[22:23], v[220:221]
  v_exp_f32 v116, v116
  v_exp_f32 v117, v117
  v_exp_f32 v118, v118
  v_exp_f32 v119, v119
  v_pk_mul_f32 v[28:29], v[20:21], v[28:29]
  v_pk_mul_f32 v[30:31], v[22:23], v[30:31]
  v_pk_add_f32 v[116:117], v[116:117], v[222:223]
  v_pk_add_f32 v[118:119], v[118:119], v[222:223]
  v_rcp_f32 v116, v116
  v_rcp_f32 v117, v117
  v_rcp_f32 v118, v118
  v_rcp_f32 v119, v119
  s_nop 0
  v_pk_mul_f32 v[116:117], v[116:117], v[28:29]
  v_pk_mul_f32 v[118:119], v[118:119], v[30:31]
  v_cvt_pk_bf16_f32 v120, v112, v113
  v_cvt_pk_bf16_f32 v121, v114, v115
  v_cvt_pk_bf16_f32 v122, v116, v117
  v_cvt_pk_bf16_f32 v123, v118, v119
  buffer_store_dwordx4 v[120:123], v219, s[16:19], s28 offen sc1
  buffer_load_dwordx4 a[24:27], v240, s[4:7], s95 offen offset:1024 sc1
  buffer_load_dwordx4 a[28:31], v240, s[4:7], s95 offen offset:2048 sc1
  v_pk_mul_f32 v[100:101], v[36:37], v[220:221]
  v_pk_mul_f32 v[102:103], v[38:39], v[220:221]
  v_exp_f32 v100, v100
  v_exp_f32 v101, v101
  v_exp_f32 v102, v102
  v_exp_f32 v103, v103
  v_pk_mul_f32 v[44:45], v[36:37], v[44:45]
  v_pk_mul_f32 v[46:47], v[38:39], v[46:47]
  v_pk_add_f32 v[100:101], v[100:101], v[222:223]
  v_pk_add_f32 v[102:103], v[102:103], v[222:223]
  v_rcp_f32 v100, v100
  v_rcp_f32 v101, v101
  v_rcp_f32 v102, v102
  v_rcp_f32 v103, v103
  s_nop 0
  v_pk_mul_f32 v[100:101], v[100:101], v[44:45]
  v_pk_mul_f32 v[102:103], v[102:103], v[46:47]
  v_pk_mul_f32 v[104:105], v[52:53], v[220:221]
  v_pk_mul_f32 v[106:107], v[54:55], v[220:221]
  v_exp_f32 v104, v104
  v_exp_f32 v105, v105
  v_exp_f32 v106, v106
  v_exp_f32 v107, v107
  v_pk_mul_f32 v[60:61], v[52:53], v[60:61]
  v_pk_mul_f32 v[62:63], v[54:55], v[62:63]
  v_pk_add_f32 v[104:105], v[104:105], v[222:223]
  v_pk_add_f32 v[106:107], v[106:107], v[222:223]
  v_rcp_f32 v104, v104
  v_rcp_f32 v105, v105
  v_rcp_f32 v106, v106
  v_rcp_f32 v107, v107
  s_nop 0
  v_pk_mul_f32 v[104:105], v[104:105], v[60:61]
  v_pk_mul_f32 v[106:107], v[106:107], v[62:63]
  v_cvt_pk_bf16_f32 v108, v100, v101
  v_cvt_pk_bf16_f32 v109, v102, v103
  v_cvt_pk_bf16_f32 v110, v104, v105
  v_cvt_pk_bf16_f32 v111, v106, v107
  buffer_store_dwordx4 v[108:111], v219, s[16:19], s28 offen offset:1024 sc1
  buffer_load_dwordx4 a[32:35], v240, s[4:7], s95 offen offset:3072 sc1
  buffer_load_dwordx4 a[36:39], v241, s[4:7], s95 offen sc1
  v_pk_mul_f32 v[112:113], v[68:69], v[220:221]
  v_pk_mul_f32 v[114:115], v[70:71], v[220:221]
  v_exp_f32 v112, v112
  v_exp_f32 v113, v113
  v_exp_f32 v114, v114
  v_exp_f32 v115, v115
  v_pk_mul_f32 v[76:77], v[68:69], v[76:77]
  v_pk_mul_f32 v[78:79], v[70:71], v[78:79]
  v_pk_add_f32 v[112:113], v[112:113], v[222:223]
  v_pk_add_f32 v[114:115], v[114:115], v[222:223]
  v_rcp_f32 v112, v112
  v_rcp_f32 v113, v113
  v_rcp_f32 v114, v114
  v_rcp_f32 v115, v115
  s_nop 0
  v_pk_mul_f32 v[112:113], v[112:113], v[76:77]
  v_pk_mul_f32 v[114:115], v[114:115], v[78:79]
  v_pk_mul_f32 v[116:117], v[84:85], v[220:221]
  v_pk_mul_f32 v[118:119], v[86:87], v[220:221]
  v_exp_f32 v116, v116
  v_exp_f32 v117, v117
  v_exp_f32 v118, v118
  v_exp_f32 v119, v119
  v_pk_mul_f32 v[92:93], v[84:85], v[92:93]
  v_pk_mul_f32 v[94:95], v[86:87], v[94:95]
  v_pk_add_f32 v[116:117], v[116:117], v[222:223]
  v_pk_add_f32 v[118:119], v[118:119], v[222:223]
  v_rcp_f32 v116, v116
  v_rcp_f32 v117, v117
  v_rcp_f32 v118, v118
  v_rcp_f32 v119, v119
  s_nop 0
  v_pk_mul_f32 v[116:117], v[116:117], v[92:93]
  v_pk_mul_f32 v[118:119], v[118:119], v[94:95]
  v_cvt_pk_bf16_f32 v120, v112, v113
  v_cvt_pk_bf16_f32 v121, v114, v115
  v_cvt_pk_bf16_f32 v122, v116, v117
  v_cvt_pk_bf16_f32 v123, v118, v119
  buffer_store_dwordx4 v[120:123], v219, s[16:19], s28 offen offset:2048 sc1
  s_waitcnt vmcnt(0)
  s_barrier
s_cmp_eq_u32 s82, 0
s_cbranch_scc0 adaLN_cond__sliding_block_cached__glu_gated_swiglu__prompt_kernel_sf_nosig
s_add_u32 s83, s36, 56
s_lshl_b32 s83, s83, 7
s_lshl_b32 s3, s35, 2
s_add_u32 s83, s83, s3
s_add_u32 s83, s83, 62914560
v_mov_b32 v253, s83
v_mov_b32 v254, 1
s_mov_b64 exec, 1
global_store_dword v253, v254, s[50:51] sc1
s_mov_b64 exec, -1
adaLN_cond__sliding_block_cached__glu_gated_swiglu__prompt_kernel_sf_nosig:
  s_and_b32 s33, s2, 1
  s_lshl_b32 s33, s33, 2
  s_bfe_u32 s34, s2, 0x20003
  s_add_u32 s31, s33, s34
  s_bfe_u32 s33, s2, 0x20001
  s_lshl_b32 s33, s33, 3
  s_lshr_b32 s34, s2, 5
  s_add_u32 s32, s33, s34
  v_lshlrev_b32 v204, 4, v255
  v_lshlrev_b32 v205, 4, v255
  v_add_u32 v205, 49152, v205
  v_lshlrev_b32 v206, 4, v255
  v_add_u32 v206, 98304, v206
  v_lshlrev_b32 v207, 4, v255
  v_add_u32 v207, 147456, v207
  s_add_u32 s4, s50, 71303168
  s_addc_u32 s5, s51, 0
  s_mov_b32 s6, 1966080
  s_mov_b32 s7, 0x20000
  s_add_u32 s8, s50, 55574528
  s_addc_u32 s9, s51, 0
  s_mov_b32 s10, 6291456
  s_mov_b32 s11, 0x20000
  s_add_u32 s12, s50, 49283072
  s_addc_u32 s13, s51, 0
  s_mov_b32 s14, 2621440
  s_mov_b32 s15, 0x20000
  s_mov_b32 s20, s62
  s_mov_b32 s21, s63
  s_mov_b32 s22, 2621440
  s_mov_b32 s23, 0x20000
  s_and_b32 s28, s2, 1
  s_lshl_b32 s28, s28, 2
  s_bfe_u32 s34, s2, 0x20003
  s_add_u32 s28, s28, s34
  s_mul_i32 s28, s28, 48
  s_mul_i32 s34, s82, 12
  s_add_u32 s28, s28, s34
  s_mul_i32 s28, s28, 5120
  s_add_u32 s28, s28, 10240
  s_mul_i32 s30, s32, 192
  s_mul_i32 s34, s82, 12
  s_add_u32 s30, s30, s34
  s_lshl_b32 s30, s30, 10
  v_lshlrev_b32 v218, 4, v255
  s_lshl_b32 s33, s32, 2
  s_add_u32 s33, s33, s82
  s_mul_i32 s29, s33, 20480
  s_mul_i32 s34, s31, 5
  s_add_u32 s34, s34, 0
  s_and_b32 s35, s34, 1
  s_lshl_b32 s35, s35, 3
  s_lshr_b32 s34, s34, 1
  s_lshl_b32 s34, s34, 10
  s_add_u32 s35, s35, s34
  s_add_u32 s35, s35, s29
  s_mul_i32 s34, s31, 5
  s_add_u32 s34, s34, 1
  s_and_b32 s36, s34, 1
  s_lshl_b32 s36, s36, 3
  s_lshr_b32 s34, s34, 1
  s_lshl_b32 s34, s34, 10
  s_add_u32 s36, s36, s34
  s_add_u32 s36, s36, s29
  s_mul_i32 s34, s31, 5
  s_add_u32 s34, s34, 2
  s_and_b32 s37, s34, 1
  s_lshl_b32 s37, s37, 3
  s_lshr_b32 s34, s34, 1
  s_lshl_b32 s34, s34, 10
  s_add_u32 s37, s37, s34
  s_add_u32 s37, s37, s29
  s_mul_i32 s34, s31, 5
  s_add_u32 s34, s34, 3
  s_and_b32 s38, s34, 1
  s_lshl_b32 s38, s38, 3
  s_lshr_b32 s34, s34, 1
  s_lshl_b32 s34, s34, 10
  s_add_u32 s38, s38, s34
  s_add_u32 s38, s38, s29
  s_mul_i32 s34, s31, 5
  s_add_u32 s34, s34, 4
  s_and_b32 s39, s34, 1
  s_lshl_b32 s39, s39, 3
  s_lshr_b32 s34, s34, 1
  s_lshl_b32 s34, s34, 10
  s_add_u32 s39, s39, s34
  s_add_u32 s39, s39, s29
  v_lshrrev_b32 v219, 4, v255
  v_lshlrev_b32 v220, 4, v219
  s_mul_i32 s34, s31, 320
  s_add_u32 s34, s34, 160512
  v_add_u32 v220, s34, v220
  ds_read_b128 v[112:115], v220 offset:0
  ds_read_b128 v[116:119], v220 offset:64
  ds_read_b128 v[120:123], v220 offset:128
  ds_read_b128 v[124:127], v220 offset:192
  ds_read_b128 v[128:131], v220 offset:256
  s_mul_i32 s33, s82, 5120
  v_add_u32 v221, s33, v218
  v_add_u32 v223, 40960, v221
  s_mul_i32 s33, s82, 20480
  v_add_u32 v224, s33, v218
  v_and_b32 v222, 15, v255
  s_movk_i32 s33, 1280
  v_mul_lo_u32 v222, v222, s33
  v_lshl_add_u32 v222, v219, 3, v222
  s_mul_i32 s34, s31, 160
  s_add_u32 s40, s29, s34
  s_waitcnt lgkmcnt(0)
  v_mov_b64 v[0:1], 0
  v_mov_b64 v[2:3], 0
  v_mov_b64 v[4:5], 0
  v_mov_b64 v[6:7], 0
  v_mov_b64 v[8:9], 0
  v_mov_b64 v[10:11], 0
  v_mov_b64 v[12:13], 0
  v_mov_b64 v[14:15], 0
  v_mov_b64 v[16:17], 0
  v_mov_b64 v[18:19], 0
  v_mov_b64 v[20:21], 0
  v_mov_b64 v[22:23], 0
  v_mov_b64 v[24:25], 0
  v_mov_b64 v[26:27], 0
  v_mov_b64 v[28:29], 0
  v_mov_b64 v[30:31], 0
  v_mov_b64 v[32:33], 0
  v_mov_b64 v[34:35], 0
  v_mov_b64 v[36:37], 0
  v_mov_b64 v[38:39], 0
  v_mov_b64 v[40:41], 0
  v_mov_b64 v[42:43], 0
  v_mov_b64 v[44:45], 0
  v_mov_b64 v[46:47], 0
  v_mov_b64 v[48:49], 0
  v_mov_b64 v[50:51], 0
  v_mov_b64 v[52:53], 0
  v_mov_b64 v[54:55], 0
  v_mov_b64 v[56:57], 0
  v_mov_b64 v[58:59], 0
  v_mov_b64 v[60:61], 0
  v_mov_b64 v[62:63], 0
  v_mov_b64 v[64:65], 0
  v_mov_b64 v[66:67], 0
  v_mov_b64 v[68:69], 0
  v_mov_b64 v[70:71], 0
  v_mov_b64 v[72:73], 0
  v_mov_b64 v[74:75], 0
  v_mov_b64 v[76:77], 0
  v_mov_b64 v[78:79], 0
s_cmp_eq_u32 s82, 0
s_cbranch_scc0 adaLN_cond__sliding_block_cached__glu_gated_swiglu__prompt_kernel_wf_nopoll
s_lshr_b32 s83, s32, 1
s_add_u32 s83, s83, 56
s_lshl_b32 s83, s83, 7
s_add_u32 s83, s83, 62914560
v_lshlrev_b32 v253, 2, v255
v_add_u32 v253, s83, v253
s_mov_b32 exec_lo, 0xffff
s_mov_b32 exec_hi, 0x0
s_mov_b32 s3, 400000
global_load_dword v254, v253, s[50:51] sc1
s_sleep 10
adaLN_cond__sliding_block_cached__glu_gated_swiglu__prompt_kernel_wf_poll:
global_load_dword v252, v253, s[50:51] sc1
s_waitcnt vmcnt(1)
v_cmp_ne_u32 vcc, 1, v254
s_nop 1
s_cmp_eq_u64 vcc, 0
s_cbranch_scc1 adaLN_cond__sliding_block_cached__glu_gated_swiglu__prompt_kernel_wf_ready
global_load_dword v254, v253, s[50:51] sc1
s_waitcnt vmcnt(1)
v_cmp_ne_u32 vcc, 1, v252
s_nop 1
s_cmp_eq_u64 vcc, 0
s_cbranch_scc1 adaLN_cond__sliding_block_cached__glu_gated_swiglu__prompt_kernel_wf_ready
s_sub_u32 s3, s3, 1
s_cmp_lg_u32 s3, 0
s_cbranch_scc1 adaLN_cond__sliding_block_cached__glu_gated_swiglu__prompt_kernel_wf_poll
s_endpgm
adaLN_cond__sliding_block_cached__glu_gated_swiglu__prompt_kernel_wf_ready:
s_mov_b64 exec, -1
adaLN_cond__sliding_block_cached__glu_gated_swiglu__prompt_kernel_wf_nopoll:
  s_barrier
  buffer_load_dwordx4 a[128:131], v204, s[8:11], s30 offen sc1
  buffer_load_dwordx4 a[132:135], v205, s[8:11], s30 offen sc1
  buffer_load_dwordx4 a[136:139], v206, s[8:11], s30 offen sc1
  buffer_load_dwordx4 a[140:143], v207, s[8:11], s30 offen sc1
  s_add_u32 s30, s30, 1024
  buffer_load_dwordx4 a[144:147], v204, s[8:11], s30 offen sc1
  buffer_load_dwordx4 a[148:151], v205, s[8:11], s30 offen sc1
  buffer_load_dwordx4 a[152:155], v206, s[8:11], s30 offen sc1
  buffer_load_dwordx4 a[156:159], v207, s[8:11], s30 offen sc1
  s_add_u32 s30, s30, 1024
  buffer_load_dwordx4 a[160:163], v204, s[8:11], s30 offen sc1
  buffer_load_dwordx4 a[164:167], v205, s[8:11], s30 offen sc1
  buffer_load_dwordx4 a[168:171], v206, s[8:11], s30 offen sc1
  buffer_load_dwordx4 a[172:175], v207, s[8:11], s30 offen sc1
  s_add_u32 s30, s30, 1024
  buffer_load_dwordx4 a[40:43], v240, s[4:7], s28 offen sc1
  buffer_load_dwordx4 a[44:47], v240, s[4:7], s28 offen offset:1024 sc1
  buffer_load_dwordx4 a[48:51], v240, s[4:7], s28 offen offset:2048 sc1
  buffer_load_dwordx4 a[52:55], v240, s[4:7], s28 offen offset:3072 sc1
  buffer_load_dwordx4 a[56:59], v241, s[4:7], s28 offen sc1
  s_add_u32 s28, s28, 5120
  s_waitcnt vmcnt(13)
  v_mfma_f32_16x16x32_bf16 v[0:3], a[0:3], a[128:131], v[0:3]
  buffer_load_dwordx4 a[176:179], v204, s[8:11], s30 offen sc1
  v_mfma_f32_16x16x32_bf16 v[20:23], a[0:3], a[132:135], v[20:23]
  v_mfma_f32_16x16x32_bf16 v[40:43], a[0:3], a[136:139], v[40:43]
  buffer_load_dwordx4 a[180:183], v205, s[8:11], s30 offen sc1
  v_mfma_f32_16x16x32_bf16 v[60:63], a[0:3], a[140:143], v[60:63]
  v_mfma_f32_16x16x32_bf16 v[4:7], a[4:7], a[128:131], v[4:7]
  buffer_load_dwordx4 a[184:187], v206, s[8:11], s30 offen sc1
  v_mfma_f32_16x16x32_bf16 v[24:27], a[4:7], a[132:135], v[24:27]
  v_mfma_f32_16x16x32_bf16 v[44:47], a[4:7], a[136:139], v[44:47]
  buffer_load_dwordx4 a[188:191], v207, s[8:11], s30 offen sc1
  v_mfma_f32_16x16x32_bf16 v[64:67], a[4:7], a[140:143], v[64:67]
  s_add_u32 s30, s30, 1024
  v_mfma_f32_16x16x32_bf16 v[8:11], a[8:11], a[128:131], v[8:11]
  buffer_load_dwordx4 a[60:63], v240, s[4:7], s28 offen sc1
  v_mfma_f32_16x16x32_bf16 v[28:31], a[8:11], a[132:135], v[28:31]
  v_mfma_f32_16x16x32_bf16 v[48:51], a[8:11], a[136:139], v[48:51]
  buffer_load_dwordx4 a[64:67], v240, s[4:7], s28 offen offset:1024 sc1
  v_mfma_f32_16x16x32_bf16 v[68:71], a[8:11], a[140:143], v[68:71]
  v_mfma_f32_16x16x32_bf16 v[12:15], a[12:15], a[128:131], v[12:15]
  buffer_load_dwordx4 a[68:71], v240, s[4:7], s28 offen offset:2048 sc1
  v_mfma_f32_16x16x32_bf16 v[32:35], a[12:15], a[132:135], v[32:35]
  v_mfma_f32_16x16x32_bf16 v[52:55], a[12:15], a[136:139], v[52:55]
  buffer_load_dwordx4 a[72:75], v240, s[4:7], s28 offen offset:3072 sc1
  v_mfma_f32_16x16x32_bf16 v[72:75], a[12:15], a[140:143], v[72:75]
  v_mfma_f32_16x16x32_bf16 v[16:19], a[16:19], a[128:131], v[16:19]
  buffer_load_dwordx4 a[76:79], v241, s[4:7], s28 offen sc1
  v_mfma_f32_16x16x32_bf16 v[36:39], a[16:19], a[132:135], v[36:39]
  s_add_u32 s28, s28, 5120
  v_mfma_f32_16x16x32_bf16 v[56:59], a[16:19], a[136:139], v[56:59]
  v_mfma_f32_16x16x32_bf16 v[76:79], a[16:19], a[140:143], v[76:79]
  s_waitcnt vmcnt(18)
  v_mfma_f32_16x16x32_bf16 v[0:3], a[20:23], a[144:147], v[0:3]
  buffer_load_dwordx4 a[128:131], v204, s[8:11], s30 offen sc1
  v_mfma_f32_16x16x32_bf16 v[20:23], a[20:23], a[148:151], v[20:23]
  v_mfma_f32_16x16x32_bf16 v[40:43], a[20:23], a[152:155], v[40:43]
  buffer_load_dwordx4 a[132:135], v205, s[8:11], s30 offen sc1
  v_mfma_f32_16x16x32_bf16 v[60:63], a[20:23], a[156:159], v[60:63]
  v_mfma_f32_16x16x32_bf16 v[4:7], a[24:27], a[144:147], v[4:7]
  buffer_load_dwordx4 a[136:139], v206, s[8:11], s30 offen sc1
  v_mfma_f32_16x16x32_bf16 v[24:27], a[24:27], a[148:151], v[24:27]
  v_mfma_f32_16x16x32_bf16 v[44:47], a[24:27], a[152:155], v[44:47]
  buffer_load_dwordx4 a[140:143], v207, s[8:11], s30 offen sc1
  v_mfma_f32_16x16x32_bf16 v[64:67], a[24:27], a[156:159], v[64:67]
  s_add_u32 s30, s30, 1024
  v_mfma_f32_16x16x32_bf16 v[8:11], a[28:31], a[144:147], v[8:11]
  buffer_load_dwordx4 a[0:3], v240, s[4:7], s28 offen sc1
  v_mfma_f32_16x16x32_bf16 v[28:31], a[28:31], a[148:151], v[28:31]
  v_mfma_f32_16x16x32_bf16 v[48:51], a[28:31], a[152:155], v[48:51]
  buffer_load_dwordx4 a[4:7], v240, s[4:7], s28 offen offset:1024 sc1
  v_mfma_f32_16x16x32_bf16 v[68:71], a[28:31], a[156:159], v[68:71]
  v_mfma_f32_16x16x32_bf16 v[12:15], a[32:35], a[144:147], v[12:15]
  buffer_load_dwordx4 a[8:11], v240, s[4:7], s28 offen offset:2048 sc1
  v_mfma_f32_16x16x32_bf16 v[32:35], a[32:35], a[148:151], v[32:35]
  v_mfma_f32_16x16x32_bf16 v[52:55], a[32:35], a[152:155], v[52:55]
  buffer_load_dwordx4 a[12:15], v240, s[4:7], s28 offen offset:3072 sc1
  v_mfma_f32_16x16x32_bf16 v[72:75], a[32:35], a[156:159], v[72:75]
  v_mfma_f32_16x16x32_bf16 v[16:19], a[36:39], a[144:147], v[16:19]
  buffer_load_dwordx4 a[16:19], v241, s[4:7], s28 offen sc1
  v_mfma_f32_16x16x32_bf16 v[36:39], a[36:39], a[148:151], v[36:39]
  s_add_u32 s28, s28, 5120
  v_mfma_f32_16x16x32_bf16 v[56:59], a[36:39], a[152:155], v[56:59]
  v_mfma_f32_16x16x32_bf16 v[76:79], a[36:39], a[156:159], v[76:79]
  s_waitcnt vmcnt(18)
  v_mfma_f32_16x16x32_bf16 v[0:3], a[40:43], a[160:163], v[0:3]
  buffer_load_dwordx4 a[144:147], v204, s[8:11], s30 offen sc1
  v_mfma_f32_16x16x32_bf16 v[20:23], a[40:43], a[164:167], v[20:23]
  v_mfma_f32_16x16x32_bf16 v[40:43], a[40:43], a[168:171], v[40:43]
  buffer_load_dwordx4 a[148:151], v205, s[8:11], s30 offen sc1
  v_mfma_f32_16x16x32_bf16 v[60:63], a[40:43], a[172:175], v[60:63]
  v_mfma_f32_16x16x32_bf16 v[4:7], a[44:47], a[160:163], v[4:7]
  buffer_load_dwordx4 a[152:155], v206, s[8:11], s30 offen sc1
  v_mfma_f32_16x16x32_bf16 v[24:27], a[44:47], a[164:167], v[24:27]
  v_mfma_f32_16x16x32_bf16 v[44:47], a[44:47], a[168:171], v[44:47]
  buffer_load_dwordx4 a[156:159], v207, s[8:11], s30 offen sc1
  v_mfma_f32_16x16x32_bf16 v[64:67], a[44:47], a[172:175], v[64:67]
  s_add_u32 s30, s30, 1024
  v_mfma_f32_16x16x32_bf16 v[8:11], a[48:51], a[160:163], v[8:11]
  buffer_load_dwordx4 a[20:23], v240, s[4:7], s28 offen sc1
  v_mfma_f32_16x16x32_bf16 v[28:31], a[48:51], a[164:167], v[28:31]
  v_mfma_f32_16x16x32_bf16 v[48:51], a[48:51], a[168:171], v[48:51]
  buffer_load_dwordx4 a[24:27], v240, s[4:7], s28 offen offset:1024 sc1
  v_mfma_f32_16x16x32_bf16 v[68:71], a[48:51], a[172:175], v[68:71]
  v_mfma_f32_16x16x32_bf16 v[12:15], a[52:55], a[160:163], v[12:15]
  buffer_load_dwordx4 a[28:31], v240, s[4:7], s28 offen offset:2048 sc1
  v_mfma_f32_16x16x32_bf16 v[32:35], a[52:55], a[164:167], v[32:35]
  v_mfma_f32_16x16x32_bf16 v[52:55], a[52:55], a[168:171], v[52:55]
  buffer_load_dwordx4 a[32:35], v240, s[4:7], s28 offen offset:3072 sc1
  v_mfma_f32_16x16x32_bf16 v[72:75], a[52:55], a[172:175], v[72:75]
  v_mfma_f32_16x16x32_bf16 v[16:19], a[56:59], a[160:163], v[16:19]
  buffer_load_dwordx4 a[36:39], v241, s[4:7], s28 offen sc1
  v_mfma_f32_16x16x32_bf16 v[36:39], a[56:59], a[164:167], v[36:39]
  s_add_u32 s28, s28, 5120
  v_mfma_f32_16x16x32_bf16 v[56:59], a[56:59], a[168:171], v[56:59]
  v_mfma_f32_16x16x32_bf16 v[76:79], a[56:59], a[172:175], v[76:79]
  s_waitcnt vmcnt(18)
  v_mfma_f32_16x16x32_bf16 v[0:3], a[60:63], a[176:179], v[0:3]
  buffer_load_dwordx4 a[160:163], v204, s[8:11], s30 offen sc1
  v_mfma_f32_16x16x32_bf16 v[20:23], a[60:63], a[180:183], v[20:23]
  v_mfma_f32_16x16x32_bf16 v[40:43], a[60:63], a[184:187], v[40:43]
  buffer_load_dwordx4 a[164:167], v205, s[8:11], s30 offen sc1
  v_mfma_f32_16x16x32_bf16 v[60:63], a[60:63], a[188:191], v[60:63]
  v_mfma_f32_16x16x32_bf16 v[4:7], a[64:67], a[176:179], v[4:7]
  buffer_load_dwordx4 a[168:171], v206, s[8:11], s30 offen sc1
  v_mfma_f32_16x16x32_bf16 v[24:27], a[64:67], a[180:183], v[24:27]
  v_mfma_f32_16x16x32_bf16 v[44:47], a[64:67], a[184:187], v[44:47]
  buffer_load_dwordx4 a[172:175], v207, s[8:11], s30 offen sc1
  v_mfma_f32_16x16x32_bf16 v[64:67], a[64:67], a[188:191], v[64:67]
  s_add_u32 s30, s30, 1024
  v_mfma_f32_16x16x32_bf16 v[8:11], a[68:71], a[176:179], v[8:11]
  buffer_load_dwordx4 a[40:43], v240, s[4:7], s28 offen sc1
  v_mfma_f32_16x16x32_bf16 v[28:31], a[68:71], a[180:183], v[28:31]
  v_mfma_f32_16x16x32_bf16 v[48:51], a[68:71], a[184:187], v[48:51]
  buffer_load_dwordx4 a[44:47], v240, s[4:7], s28 offen offset:1024 sc1
  v_mfma_f32_16x16x32_bf16 v[68:71], a[68:71], a[188:191], v[68:71]
  v_mfma_f32_16x16x32_bf16 v[12:15], a[72:75], a[176:179], v[12:15]
  buffer_load_dwordx4 a[48:51], v240, s[4:7], s28 offen offset:2048 sc1
  v_mfma_f32_16x16x32_bf16 v[32:35], a[72:75], a[180:183], v[32:35]
  v_mfma_f32_16x16x32_bf16 v[52:55], a[72:75], a[184:187], v[52:55]
  buffer_load_dwordx4 a[52:55], v240, s[4:7], s28 offen offset:3072 sc1
  v_mfma_f32_16x16x32_bf16 v[72:75], a[72:75], a[188:191], v[72:75]
  v_mfma_f32_16x16x32_bf16 v[16:19], a[76:79], a[176:179], v[16:19]
  buffer_load_dwordx4 a[56:59], v241, s[4:7], s28 offen sc1
  v_mfma_f32_16x16x32_bf16 v[36:39], a[76:79], a[180:183], v[36:39]
  s_add_u32 s28, s28, 5120
  v_mfma_f32_16x16x32_bf16 v[56:59], a[76:79], a[184:187], v[56:59]
  v_mfma_f32_16x16x32_bf16 v[76:79], a[76:79], a[188:191], v[76:79]
  s_waitcnt vmcnt(18)
  v_mfma_f32_16x16x32_bf16 v[0:3], a[0:3], a[128:131], v[0:3]
  buffer_load_dwordx4 a[176:179], v204, s[8:11], s30 offen sc1
  v_mfma_f32_16x16x32_bf16 v[20:23], a[0:3], a[132:135], v[20:23]
  v_mfma_f32_16x16x32_bf16 v[40:43], a[0:3], a[136:139], v[40:43]
  buffer_load_dwordx4 a[180:183], v205, s[8:11], s30 offen sc1
  v_mfma_f32_16x16x32_bf16 v[60:63], a[0:3], a[140:143], v[60:63]
  v_mfma_f32_16x16x32_bf16 v[4:7], a[4:7], a[128:131], v[4:7]
  buffer_load_dwordx4 a[184:187], v206, s[8:11], s30 offen sc1
  v_mfma_f32_16x16x32_bf16 v[24:27], a[4:7], a[132:135], v[24:27]
  v_mfma_f32_16x16x32_bf16 v[44:47], a[4:7], a[136:139], v[44:47]
  buffer_load_dwordx4 a[188:191], v207, s[8:11], s30 offen sc1
  v_mfma_f32_16x16x32_bf16 v[64:67], a[4:7], a[140:143], v[64:67]
  s_add_u32 s30, s30, 1024
  v_mfma_f32_16x16x32_bf16 v[8:11], a[8:11], a[128:131], v[8:11]
  buffer_load_dwordx4 a[60:63], v240, s[4:7], s28 offen sc1
  v_mfma_f32_16x16x32_bf16 v[28:31], a[8:11], a[132:135], v[28:31]
  v_mfma_f32_16x16x32_bf16 v[48:51], a[8:11], a[136:139], v[48:51]
  buffer_load_dwordx4 a[64:67], v240, s[4:7], s28 offen offset:1024 sc1
  v_mfma_f32_16x16x32_bf16 v[68:71], a[8:11], a[140:143], v[68:71]
  v_mfma_f32_16x16x32_bf16 v[12:15], a[12:15], a[128:131], v[12:15]
  buffer_load_dwordx4 a[68:71], v240, s[4:7], s28 offen offset:2048 sc1
  v_mfma_f32_16x16x32_bf16 v[32:35], a[12:15], a[132:135], v[32:35]
  v_mfma_f32_16x16x32_bf16 v[52:55], a[12:15], a[136:139], v[52:55]
  buffer_load_dwordx4 a[72:75], v240, s[4:7], s28 offen offset:3072 sc1
  v_mfma_f32_16x16x32_bf16 v[72:75], a[12:15], a[140:143], v[72:75]
  v_mfma_f32_16x16x32_bf16 v[16:19], a[16:19], a[128:131], v[16:19]
  buffer_load_dwordx4 a[76:79], v241, s[4:7], s28 offen sc1
  v_mfma_f32_16x16x32_bf16 v[36:39], a[16:19], a[132:135], v[36:39]
  s_add_u32 s28, s28, 5120
  v_mfma_f32_16x16x32_bf16 v[56:59], a[16:19], a[136:139], v[56:59]
  v_mfma_f32_16x16x32_bf16 v[76:79], a[16:19], a[140:143], v[76:79]
  s_waitcnt vmcnt(18)
  v_mfma_f32_16x16x32_bf16 v[0:3], a[20:23], a[144:147], v[0:3]
  buffer_load_dwordx4 a[128:131], v204, s[8:11], s30 offen sc1
  v_mfma_f32_16x16x32_bf16 v[20:23], a[20:23], a[148:151], v[20:23]
  v_mfma_f32_16x16x32_bf16 v[40:43], a[20:23], a[152:155], v[40:43]
  buffer_load_dwordx4 a[132:135], v205, s[8:11], s30 offen sc1
  v_mfma_f32_16x16x32_bf16 v[60:63], a[20:23], a[156:159], v[60:63]
  v_mfma_f32_16x16x32_bf16 v[4:7], a[24:27], a[144:147], v[4:7]
  buffer_load_dwordx4 a[136:139], v206, s[8:11], s30 offen sc1
  v_mfma_f32_16x16x32_bf16 v[24:27], a[24:27], a[148:151], v[24:27]
  v_mfma_f32_16x16x32_bf16 v[44:47], a[24:27], a[152:155], v[44:47]
  buffer_load_dwordx4 a[140:143], v207, s[8:11], s30 offen sc1
  v_mfma_f32_16x16x32_bf16 v[64:67], a[24:27], a[156:159], v[64:67]
  s_add_u32 s30, s30, 1024
  v_mfma_f32_16x16x32_bf16 v[8:11], a[28:31], a[144:147], v[8:11]
  buffer_load_dwordx4 a[0:3], v240, s[4:7], s28 offen sc1
  v_mfma_f32_16x16x32_bf16 v[28:31], a[28:31], a[148:151], v[28:31]
  v_mfma_f32_16x16x32_bf16 v[48:51], a[28:31], a[152:155], v[48:51]
  buffer_load_dwordx4 a[4:7], v240, s[4:7], s28 offen offset:1024 sc1
  v_mfma_f32_16x16x32_bf16 v[68:71], a[28:31], a[156:159], v[68:71]
  v_mfma_f32_16x16x32_bf16 v[12:15], a[32:35], a[144:147], v[12:15]
  buffer_load_dwordx4 a[8:11], v240, s[4:7], s28 offen offset:2048 sc1
  v_mfma_f32_16x16x32_bf16 v[32:35], a[32:35], a[148:151], v[32:35]
  v_mfma_f32_16x16x32_bf16 v[52:55], a[32:35], a[152:155], v[52:55]
  buffer_load_dwordx4 a[12:15], v240, s[4:7], s28 offen offset:3072 sc1
  v_mfma_f32_16x16x32_bf16 v[72:75], a[32:35], a[156:159], v[72:75]
  v_mfma_f32_16x16x32_bf16 v[16:19], a[36:39], a[144:147], v[16:19]
  buffer_load_dwordx4 a[16:19], v241, s[4:7], s28 offen sc1
  v_mfma_f32_16x16x32_bf16 v[36:39], a[36:39], a[148:151], v[36:39]
  s_add_u32 s28, s28, 5120
  v_mfma_f32_16x16x32_bf16 v[56:59], a[36:39], a[152:155], v[56:59]
  v_mfma_f32_16x16x32_bf16 v[76:79], a[36:39], a[156:159], v[76:79]
  s_waitcnt vmcnt(18)
  v_mfma_f32_16x16x32_bf16 v[0:3], a[40:43], a[160:163], v[0:3]
  buffer_load_dwordx4 a[144:147], v204, s[8:11], s30 offen sc1
  v_mfma_f32_16x16x32_bf16 v[20:23], a[40:43], a[164:167], v[20:23]
  v_mfma_f32_16x16x32_bf16 v[40:43], a[40:43], a[168:171], v[40:43]
  buffer_load_dwordx4 a[148:151], v205, s[8:11], s30 offen sc1
  v_mfma_f32_16x16x32_bf16 v[60:63], a[40:43], a[172:175], v[60:63]
  v_mfma_f32_16x16x32_bf16 v[4:7], a[44:47], a[160:163], v[4:7]
  buffer_load_dwordx4 a[152:155], v206, s[8:11], s30 offen sc1
  v_mfma_f32_16x16x32_bf16 v[24:27], a[44:47], a[164:167], v[24:27]
  v_mfma_f32_16x16x32_bf16 v[44:47], a[44:47], a[168:171], v[44:47]
  buffer_load_dwordx4 a[156:159], v207, s[8:11], s30 offen sc1
  v_mfma_f32_16x16x32_bf16 v[64:67], a[44:47], a[172:175], v[64:67]
  s_add_u32 s30, s30, 1024
  v_mfma_f32_16x16x32_bf16 v[8:11], a[48:51], a[160:163], v[8:11]
  buffer_load_dwordx4 a[20:23], v240, s[4:7], s28 offen sc1
  v_mfma_f32_16x16x32_bf16 v[28:31], a[48:51], a[164:167], v[28:31]
  v_mfma_f32_16x16x32_bf16 v[48:51], a[48:51], a[168:171], v[48:51]
  buffer_load_dwordx4 a[24:27], v240, s[4:7], s28 offen offset:1024 sc1
  v_mfma_f32_16x16x32_bf16 v[68:71], a[48:51], a[172:175], v[68:71]
  v_mfma_f32_16x16x32_bf16 v[12:15], a[52:55], a[160:163], v[12:15]
  buffer_load_dwordx4 a[28:31], v240, s[4:7], s28 offen offset:2048 sc1
  v_mfma_f32_16x16x32_bf16 v[32:35], a[52:55], a[164:167], v[32:35]
  v_mfma_f32_16x16x32_bf16 v[52:55], a[52:55], a[168:171], v[52:55]
  buffer_load_dwordx4 a[32:35], v240, s[4:7], s28 offen offset:3072 sc1
  v_mfma_f32_16x16x32_bf16 v[72:75], a[52:55], a[172:175], v[72:75]
  v_mfma_f32_16x16x32_bf16 v[16:19], a[56:59], a[160:163], v[16:19]
  buffer_load_dwordx4 a[36:39], v241, s[4:7], s28 offen sc1
  v_mfma_f32_16x16x32_bf16 v[36:39], a[56:59], a[164:167], v[36:39]
  s_add_u32 s28, s28, 5120
  v_mfma_f32_16x16x32_bf16 v[56:59], a[56:59], a[168:171], v[56:59]
  v_mfma_f32_16x16x32_bf16 v[76:79], a[56:59], a[172:175], v[76:79]
  s_waitcnt vmcnt(18)
  v_mfma_f32_16x16x32_bf16 v[0:3], a[60:63], a[176:179], v[0:3]
  buffer_load_dwordx4 a[160:163], v204, s[8:11], s30 offen sc1
  v_mfma_f32_16x16x32_bf16 v[20:23], a[60:63], a[180:183], v[20:23]
  v_mfma_f32_16x16x32_bf16 v[40:43], a[60:63], a[184:187], v[40:43]
  buffer_load_dwordx4 a[164:167], v205, s[8:11], s30 offen sc1
  v_mfma_f32_16x16x32_bf16 v[60:63], a[60:63], a[188:191], v[60:63]
  v_mfma_f32_16x16x32_bf16 v[4:7], a[64:67], a[176:179], v[4:7]
  buffer_load_dwordx4 a[168:171], v206, s[8:11], s30 offen sc1
  v_mfma_f32_16x16x32_bf16 v[24:27], a[64:67], a[180:183], v[24:27]
  v_mfma_f32_16x16x32_bf16 v[44:47], a[64:67], a[184:187], v[44:47]
  buffer_load_dwordx4 a[172:175], v207, s[8:11], s30 offen sc1
  v_mfma_f32_16x16x32_bf16 v[64:67], a[64:67], a[188:191], v[64:67]
  s_add_u32 s30, s30, 1024
  v_mfma_f32_16x16x32_bf16 v[8:11], a[68:71], a[176:179], v[8:11]
  buffer_load_dwordx4 a[40:43], v240, s[4:7], s28 offen sc1
  v_mfma_f32_16x16x32_bf16 v[28:31], a[68:71], a[180:183], v[28:31]
  v_mfma_f32_16x16x32_bf16 v[48:51], a[68:71], a[184:187], v[48:51]
  buffer_load_dwordx4 a[44:47], v240, s[4:7], s28 offen offset:1024 sc1
  v_mfma_f32_16x16x32_bf16 v[68:71], a[68:71], a[188:191], v[68:71]
  v_mfma_f32_16x16x32_bf16 v[12:15], a[72:75], a[176:179], v[12:15]
  buffer_load_dwordx4 a[48:51], v240, s[4:7], s28 offen offset:2048 sc1
  v_mfma_f32_16x16x32_bf16 v[32:35], a[72:75], a[180:183], v[32:35]
  v_mfma_f32_16x16x32_bf16 v[52:55], a[72:75], a[184:187], v[52:55]
  buffer_load_dwordx4 a[52:55], v240, s[4:7], s28 offen offset:3072 sc1
  v_mfma_f32_16x16x32_bf16 v[72:75], a[72:75], a[188:191], v[72:75]
  v_mfma_f32_16x16x32_bf16 v[16:19], a[76:79], a[176:179], v[16:19]
  buffer_load_dwordx4 a[56:59], v241, s[4:7], s28 offen sc1
  v_mfma_f32_16x16x32_bf16 v[36:39], a[76:79], a[180:183], v[36:39]
  s_add_u32 s28, s28, 5120
  v_mfma_f32_16x16x32_bf16 v[56:59], a[76:79], a[184:187], v[56:59]
  v_mfma_f32_16x16x32_bf16 v[76:79], a[76:79], a[188:191], v[76:79]
  s_waitcnt vmcnt(18)
  v_mfma_f32_16x16x32_bf16 v[0:3], a[0:3], a[128:131], v[0:3]
  buffer_load_dwordx4 a[176:179], v204, s[8:11], s30 offen sc1
  v_mfma_f32_16x16x32_bf16 v[20:23], a[0:3], a[132:135], v[20:23]
  v_mfma_f32_16x16x32_bf16 v[40:43], a[0:3], a[136:139], v[40:43]
  buffer_load_dwordx4 a[180:183], v205, s[8:11], s30 offen sc1
  v_mfma_f32_16x16x32_bf16 v[60:63], a[0:3], a[140:143], v[60:63]
  v_mfma_f32_16x16x32_bf16 v[4:7], a[4:7], a[128:131], v[4:7]
  buffer_load_dwordx4 a[184:187], v206, s[8:11], s30 offen sc1
  v_mfma_f32_16x16x32_bf16 v[24:27], a[4:7], a[132:135], v[24:27]
  v_mfma_f32_16x16x32_bf16 v[44:47], a[4:7], a[136:139], v[44:47]
  buffer_load_dwordx4 a[188:191], v207, s[8:11], s30 offen sc1
  v_mfma_f32_16x16x32_bf16 v[64:67], a[4:7], a[140:143], v[64:67]
  s_add_u32 s30, s30, 1024
  v_mfma_f32_16x16x32_bf16 v[8:11], a[8:11], a[128:131], v[8:11]
  buffer_load_dwordx4 a[60:63], v240, s[4:7], s28 offen sc1
  v_mfma_f32_16x16x32_bf16 v[28:31], a[8:11], a[132:135], v[28:31]
  v_mfma_f32_16x16x32_bf16 v[48:51], a[8:11], a[136:139], v[48:51]
  buffer_load_dwordx4 a[64:67], v240, s[4:7], s28 offen offset:1024 sc1
  v_mfma_f32_16x16x32_bf16 v[68:71], a[8:11], a[140:143], v[68:71]
  v_mfma_f32_16x16x32_bf16 v[12:15], a[12:15], a[128:131], v[12:15]
  buffer_load_dwordx4 a[68:71], v240, s[4:7], s28 offen offset:2048 sc1
  v_mfma_f32_16x16x32_bf16 v[32:35], a[12:15], a[132:135], v[32:35]
  v_mfma_f32_16x16x32_bf16 v[52:55], a[12:15], a[136:139], v[52:55]
  buffer_load_dwordx4 a[72:75], v240, s[4:7], s28 offen offset:3072 sc1
  v_mfma_f32_16x16x32_bf16 v[72:75], a[12:15], a[140:143], v[72:75]
  v_mfma_f32_16x16x32_bf16 v[16:19], a[16:19], a[128:131], v[16:19]
  buffer_load_dwordx4 a[76:79], v241, s[4:7], s28 offen sc1
  v_mfma_f32_16x16x32_bf16 v[36:39], a[16:19], a[132:135], v[36:39]
  s_add_u32 s28, s28, 5120
  v_mfma_f32_16x16x32_bf16 v[56:59], a[16:19], a[136:139], v[56:59]
  v_mfma_f32_16x16x32_bf16 v[76:79], a[16:19], a[140:143], v[76:79]
  s_waitcnt vmcnt(18)
  v_mfma_f32_16x16x32_bf16 v[0:3], a[20:23], a[144:147], v[0:3]
  v_mfma_f32_16x16x32_bf16 v[20:23], a[20:23], a[148:151], v[20:23]
  v_mfma_f32_16x16x32_bf16 v[40:43], a[20:23], a[152:155], v[40:43]
  v_mfma_f32_16x16x32_bf16 v[60:63], a[20:23], a[156:159], v[60:63]
  v_mfma_f32_16x16x32_bf16 v[4:7], a[24:27], a[144:147], v[4:7]
  v_mfma_f32_16x16x32_bf16 v[24:27], a[24:27], a[148:151], v[24:27]
  v_mfma_f32_16x16x32_bf16 v[44:47], a[24:27], a[152:155], v[44:47]
  v_mfma_f32_16x16x32_bf16 v[64:67], a[24:27], a[156:159], v[64:67]
  v_mfma_f32_16x16x32_bf16 v[8:11], a[28:31], a[144:147], v[8:11]
  v_mfma_f32_16x16x32_bf16 v[28:31], a[28:31], a[148:151], v[28:31]
  v_mfma_f32_16x16x32_bf16 v[48:51], a[28:31], a[152:155], v[48:51]
  v_mfma_f32_16x16x32_bf16 v[68:71], a[28:31], a[156:159], v[68:71]
  v_mfma_f32_16x16x32_bf16 v[12:15], a[32:35], a[144:147], v[12:15]
  v_mfma_f32_16x16x32_bf16 v[32:35], a[32:35], a[148:151], v[32:35]
  v_mfma_f32_16x16x32_bf16 v[52:55], a[32:35], a[152:155], v[52:55]
  v_mfma_f32_16x16x32_bf16 v[72:75], a[32:35], a[156:159], v[72:75]
  v_mfma_f32_16x16x32_bf16 v[16:19], a[36:39], a[144:147], v[16:19]
  v_mfma_f32_16x16x32_bf16 v[36:39], a[36:39], a[148:151], v[36:39]
  v_mfma_f32_16x16x32_bf16 v[56:59], a[36:39], a[152:155], v[56:59]
  v_mfma_f32_16x16x32_bf16 v[76:79], a[36:39], a[156:159], v[76:79]
  s_waitcnt vmcnt(9)
  v_mfma_f32_16x16x32_bf16 v[0:3], a[40:43], a[160:163], v[0:3]
  v_mfma_f32_16x16x32_bf16 v[20:23], a[40:43], a[164:167], v[20:23]
  v_mfma_f32_16x16x32_bf16 v[40:43], a[40:43], a[168:171], v[40:43]
  buffer_load_dwordx2 v[100:101], v218, s[12:15], s35 offen sc1
  v_mfma_f32_16x16x32_bf16 v[60:63], a[40:43], a[172:175], v[60:63]
  v_mfma_f32_16x16x32_bf16 v[4:7], a[44:47], a[160:163], v[4:7]
  v_mfma_f32_16x16x32_bf16 v[24:27], a[44:47], a[164:167], v[24:27]
  v_mfma_f32_16x16x32_bf16 v[44:47], a[44:47], a[168:171], v[44:47]
  buffer_load_dwordx2 v[102:103], v218, s[12:15], s36 offen sc1
  v_mfma_f32_16x16x32_bf16 v[64:67], a[44:47], a[172:175], v[64:67]
  v_mfma_f32_16x16x32_bf16 v[8:11], a[48:51], a[160:163], v[8:11]
  v_mfma_f32_16x16x32_bf16 v[28:31], a[48:51], a[164:167], v[28:31]
  v_mfma_f32_16x16x32_bf16 v[48:51], a[48:51], a[168:171], v[48:51]
  buffer_load_dwordx2 v[104:105], v218, s[12:15], s37 offen sc1
  v_mfma_f32_16x16x32_bf16 v[68:71], a[48:51], a[172:175], v[68:71]
  v_mfma_f32_16x16x32_bf16 v[12:15], a[52:55], a[160:163], v[12:15]
  v_mfma_f32_16x16x32_bf16 v[32:35], a[52:55], a[164:167], v[32:35]
  v_mfma_f32_16x16x32_bf16 v[52:55], a[52:55], a[168:171], v[52:55]
  buffer_load_dwordx2 v[106:107], v218, s[12:15], s38 offen sc1
  v_mfma_f32_16x16x32_bf16 v[72:75], a[52:55], a[172:175], v[72:75]
  v_mfma_f32_16x16x32_bf16 v[16:19], a[56:59], a[160:163], v[16:19]
  v_mfma_f32_16x16x32_bf16 v[36:39], a[56:59], a[164:167], v[36:39]
  v_mfma_f32_16x16x32_bf16 v[56:59], a[56:59], a[168:171], v[56:59]
  buffer_load_dwordx2 v[108:109], v218, s[12:15], s39 offen sc1
  v_mfma_f32_16x16x32_bf16 v[76:79], a[56:59], a[172:175], v[76:79]
  s_waitcnt vmcnt(5)
  v_mfma_f32_16x16x32_bf16 v[0:3], a[60:63], a[176:179], v[0:3]
  v_mfma_f32_16x16x32_bf16 v[20:23], a[60:63], a[180:183], v[20:23]
  v_mfma_f32_16x16x32_bf16 v[40:43], a[60:63], a[184:187], v[40:43]
  v_mfma_f32_16x16x32_bf16 v[60:63], a[60:63], a[188:191], v[60:63]
  v_mfma_f32_16x16x32_bf16 v[4:7], a[64:67], a[176:179], v[4:7]
  v_mfma_f32_16x16x32_bf16 v[24:27], a[64:67], a[180:183], v[24:27]
  v_mfma_f32_16x16x32_bf16 v[44:47], a[64:67], a[184:187], v[44:47]
  v_mfma_f32_16x16x32_bf16 v[64:67], a[64:67], a[188:191], v[64:67]
  v_mfma_f32_16x16x32_bf16 v[8:11], a[68:71], a[176:179], v[8:11]
  v_mfma_f32_16x16x32_bf16 v[28:31], a[68:71], a[180:183], v[28:31]
  v_mfma_f32_16x16x32_bf16 v[48:51], a[68:71], a[184:187], v[48:51]
  v_mfma_f32_16x16x32_bf16 v[68:71], a[68:71], a[188:191], v[68:71]
  v_mfma_f32_16x16x32_bf16 v[12:15], a[72:75], a[176:179], v[12:15]
  v_mfma_f32_16x16x32_bf16 v[32:35], a[72:75], a[180:183], v[32:35]
  v_mfma_f32_16x16x32_bf16 v[52:55], a[72:75], a[184:187], v[52:55]
  v_mfma_f32_16x16x32_bf16 v[72:75], a[72:75], a[188:191], v[72:75]
  v_mfma_f32_16x16x32_bf16 v[16:19], a[76:79], a[176:179], v[16:19]
  v_mfma_f32_16x16x32_bf16 v[36:39], a[76:79], a[180:183], v[36:39]
  v_mfma_f32_16x16x32_bf16 v[56:59], a[76:79], a[184:187], v[56:59]
  v_mfma_f32_16x16x32_bf16 v[76:79], a[76:79], a[188:191], v[76:79]
  s_nop 7
  ds_write_b128 v221, v[0:3] offset:0
  ds_write_b128 v221, v[4:7] offset:1024
  ds_write_b128 v221, v[8:11] offset:2048
  ds_write_b128 v221, v[12:15] offset:3072
  ds_write_b128 v221, v[16:19] offset:4096
  ds_write_b128 v221, v[20:23] offset:20480
  ds_write_b128 v221, v[24:27] offset:21504
  ds_write_b128 v221, v[28:31] offset:22528
  ds_write_b128 v221, v[32:35] offset:23552
  ds_write_b128 v221, v[36:39] offset:24576
  ds_write_b128 v223, v[40:43] offset:0
  ds_write_b128 v223, v[44:47] offset:1024
  ds_write_b128 v223, v[48:51] offset:2048
  ds_write_b128 v223, v[52:55] offset:3072
  ds_write_b128 v223, v[56:59] offset:4096
  ds_write_b128 v223, v[60:63] offset:20480
  ds_write_b128 v223, v[64:67] offset:21504
  ds_write_b128 v223, v[68:71] offset:22528
  ds_write_b128 v223, v[72:75] offset:23552
  ds_write_b128 v223, v[76:79] offset:24576
  s_waitcnt lgkmcnt(0)
  s_barrier
  ds_read_b128 v[0:3], v224 offset:0
  ds_read_b128 v[4:7], v224 offset:1024
  ds_read_b128 v[8:11], v224 offset:2048
  ds_read_b128 v[12:15], v224 offset:3072
  ds_read_b128 v[16:19], v224 offset:4096
  ds_read_b128 v[20:23], v224 offset:5120
  ds_read_b128 v[24:27], v224 offset:6144
  ds_read_b128 v[28:31], v224 offset:7168
  ds_read_b128 v[32:35], v224 offset:8192
  ds_read_b128 v[36:39], v224 offset:9216
  ds_read_b128 v[40:43], v224 offset:10240
  ds_read_b128 v[44:47], v224 offset:11264
  ds_read_b128 v[48:51], v224 offset:12288
  ds_read_b128 v[52:55], v224 offset:13312
  ds_read_b128 v[56:59], v224 offset:14336
  ds_read_b128 v[60:63], v224 offset:15360
  ds_read_b128 v[64:67], v224 offset:16384
  ds_read_b128 v[68:71], v224 offset:17408
  ds_read_b128 v[72:75], v224 offset:18432
  ds_read_b128 v[76:79], v224 offset:19456
  s_waitcnt vmcnt(0)
  v_lshlrev_b32 v132, 16, v100
  v_and_b32 v133, 0xffff0000, v100
  v_lshlrev_b32 v134, 16, v101
  v_and_b32 v135, 0xffff0000, v101
  v_lshlrev_b32 v140, 16, v102
  v_and_b32 v141, 0xffff0000, v102
  v_lshlrev_b32 v142, 16, v103
  v_and_b32 v143, 0xffff0000, v103
  v_lshlrev_b32 v148, 16, v104
  v_and_b32 v149, 0xffff0000, v104
  v_lshlrev_b32 v150, 16, v105
  v_and_b32 v151, 0xffff0000, v105
  v_lshlrev_b32 v156, 16, v106
  v_and_b32 v157, 0xffff0000, v106
  v_lshlrev_b32 v158, 16, v107
  v_and_b32 v159, 0xffff0000, v107
  v_lshlrev_b32 v164, 16, v108
  v_and_b32 v165, 0xffff0000, v108
  v_lshlrev_b32 v166, 16, v109
  v_and_b32 v167, 0xffff0000, v109
  s_waitcnt lgkmcnt(0)
  v_pk_add_f32 v[0:1], v[0:1], v[20:21]
  v_pk_add_f32 v[40:41], v[40:41], v[60:61]
  v_pk_add_f32 v[2:3], v[2:3], v[22:23]
  v_pk_add_f32 v[42:43], v[42:43], v[62:63]
  v_pk_add_f32 v[0:1], v[0:1], v[40:41]
  v_pk_add_f32 v[2:3], v[2:3], v[42:43]
  v_pk_fma_f32 v[132:133], v[0:1], v[112:113], v[132:133]
  v_pk_fma_f32 v[134:135], v[2:3], v[114:115], v[134:135]
  v_cvt_pk_bf16_f32 v136, v132, v133
  v_cvt_pk_bf16_f32 v137, v134, v135
  buffer_store_dwordx2 v[136:137], v222, s[20:23], s40 offen offset:0
  v_pk_add_f32 v[4:5], v[4:5], v[24:25]
  v_pk_add_f32 v[44:45], v[44:45], v[64:65]
  v_pk_add_f32 v[6:7], v[6:7], v[26:27]
  v_pk_add_f32 v[46:47], v[46:47], v[66:67]
  v_pk_add_f32 v[4:5], v[4:5], v[44:45]
  v_pk_add_f32 v[6:7], v[6:7], v[46:47]
  v_pk_fma_f32 v[140:141], v[4:5], v[116:117], v[140:141]
  v_pk_fma_f32 v[142:143], v[6:7], v[118:119], v[142:143]
  v_cvt_pk_bf16_f32 v144, v140, v141
  v_cvt_pk_bf16_f32 v145, v142, v143
  buffer_store_dwordx2 v[144:145], v222, s[20:23], s40 offen offset:32
  v_pk_add_f32 v[8:9], v[8:9], v[28:29]
  v_pk_add_f32 v[48:49], v[48:49], v[68:69]
  v_pk_add_f32 v[10:11], v[10:11], v[30:31]
  v_pk_add_f32 v[50:51], v[50:51], v[70:71]
  v_pk_add_f32 v[8:9], v[8:9], v[48:49]
  v_pk_add_f32 v[10:11], v[10:11], v[50:51]
  v_pk_fma_f32 v[148:149], v[8:9], v[120:121], v[148:149]
  v_pk_fma_f32 v[150:151], v[10:11], v[122:123], v[150:151]
  v_cvt_pk_bf16_f32 v152, v148, v149
  v_cvt_pk_bf16_f32 v153, v150, v151
  buffer_store_dwordx2 v[152:153], v222, s[20:23], s40 offen offset:64
  v_pk_add_f32 v[12:13], v[12:13], v[32:33]
  v_pk_add_f32 v[52:53], v[52:53], v[72:73]
  v_pk_add_f32 v[14:15], v[14:15], v[34:35]
  v_pk_add_f32 v[54:55], v[54:55], v[74:75]
  v_pk_add_f32 v[12:13], v[12:13], v[52:53]
  v_pk_add_f32 v[14:15], v[14:15], v[54:55]
  v_pk_fma_f32 v[156:157], v[12:13], v[124:125], v[156:157]
  v_pk_fma_f32 v[158:159], v[14:15], v[126:127], v[158:159]
  v_cvt_pk_bf16_f32 v160, v156, v157
  v_cvt_pk_bf16_f32 v161, v158, v159
  buffer_store_dwordx2 v[160:161], v222, s[20:23], s40 offen offset:96
  v_pk_add_f32 v[16:17], v[16:17], v[36:37]
  v_pk_add_f32 v[56:57], v[56:57], v[76:77]
  v_pk_add_f32 v[18:19], v[18:19], v[38:39]
  v_pk_add_f32 v[58:59], v[58:59], v[78:79]
  v_pk_add_f32 v[16:17], v[16:17], v[56:57]
  v_pk_add_f32 v[18:19], v[18:19], v[58:59]
  v_pk_fma_f32 v[164:165], v[16:17], v[128:129], v[164:165]
  v_pk_fma_f32 v[166:167], v[18:19], v[130:131], v[166:167]
  v_cvt_pk_bf16_f32 v168, v164, v165
  v_cvt_pk_bf16_f32 v169, v166, v167
  buffer_store_dwordx2 v[168:169], v222, s[20:23], s40 offen offset:128
  s_waitcnt vmcnt(0)
  s_endpgm
adaLN_cond__sliding_block_cached__glu_gated_swiglu__prompt_kernel_d_slow:
s_mov_b32 s3, 400000
adaLN_cond__sliding_block_cached__glu_gated_swiglu__prompt_kernel_d_spin:
buffer_load_dword v212, v210, s[20:23], 0 offen sc1
s_waitcnt vmcnt(0)
v_cmp_ne_u32 vcc, v211, v212
s_nop 1
s_cmp_eq_u64 vcc, 0
s_cbranch_scc1 adaLN_cond__sliding_block_cached__glu_gated_swiglu__prompt_kernel_d_back
s_sleep 1
s_sub_u32 s3, s3, 1
s_cmp_lg_u32 s3, 0
s_cbranch_scc1 adaLN_cond__sliding_block_cached__glu_gated_swiglu__prompt_kernel_d_spin
s_endpgm
adaLN_cond__sliding_block_cached__glu_gated_swiglu__prompt_kernel_c_redo:
v_and_b32 v218, 15, v255
v_lshrrev_b32 v219, 4, v255
v_lshrrev_b32 v220, 2, v218
v_lshl_add_u32 v220, v219, 3, v220
v_mul_u32_u24 v220, 0x180, v220
v_and_b32 v221, 3, v218
v_and_b32 v222, 8, v218
v_lshrrev_b32 v222, 1, v222
v_or_b32 v223, 0, v221
v_xor_b32 v223, v223, v222
v_lshl_add_u32 v198, v223, 4, v220
v_or_b32 v223, 4, v221
v_xor_b32 v223, v223, v222
v_lshl_add_u32 v199, v223, 4, v220
v_mul_u32_u24 v220, 0x180, v218
v_add_u32 v220, 0, v220
v_lshrrev_b32 v221, 1, v218
v_or_b32 v223, 0, v219
v_xor_b32 v223, v223, v221
v_lshl_add_u32 v214, v223, 4, v220
v_or_b32 v223, 4, v219
v_xor_b32 v223, v223, v221
v_lshl_add_u32 v215, v223, 4, v220
v_lshrrev_b32 v220, 2, v218
v_lshl_add_u32 v220, v219, 2, v220
v_mul_u32_u24 v220, 0x180, v220
v_add_u32 v220, 0, v220
v_bfe_u32 v221, v218, 1, 1
v_lshl_add_u32 v220, v221, 4, v220
v_and_b32 v221, 1, v218
v_lshl_add_u32 v220, v221, 3, v220
v_and_b32 v221, 1, v219
v_lshlrev_b32 v221, 1, v221
v_lshrrev_b32 v222, 3, v218
v_or_b32 v221, v221, v222
v_xor_b32 v223, 0, v221
v_lshl_add_u32 v200, v223, 5, v220
v_xor_b32 v223, 1, v221
v_lshl_add_u32 v201, v223, 5, v220
v_xor_b32 v223, 2, v221
v_lshl_add_u32 v202, v223, 5, v220
v_xor_b32 v223, 3, v221
v_lshl_add_u32 v203, v223, 5, v220
v_mov_b32 v198, v214
v_mov_b32 v199, v215
s_mul_i32 s28, s37, 786432
s_add_u32 s28, s28, 587776
s_mul_i32 s31, s82, 3072
v_mov_b32 v160, 0xff7fffff
v_mov_b32 v176, 0
v_mov_b32 v161, 0xff7fffff
v_mov_b32 v177, 0
v_mov_b32 v162, 0xff7fffff
v_mov_b32 v178, 0
v_mov_b32 v163, 0xff7fffff
v_mov_b32 v179, 0
v_accvgpr_write_b32 a0, 0
v_accvgpr_write_b32 a1, 0
v_accvgpr_write_b32 a2, 0
v_accvgpr_write_b32 a3, 0
v_accvgpr_write_b32 a4, 0
v_accvgpr_write_b32 a5, 0
v_accvgpr_write_b32 a6, 0
v_accvgpr_write_b32 a7, 0
v_accvgpr_write_b32 a8, 0
v_accvgpr_write_b32 a9, 0
v_accvgpr_write_b32 a10, 0
v_accvgpr_write_b32 a11, 0
v_accvgpr_write_b32 a12, 0
v_accvgpr_write_b32 a13, 0
v_accvgpr_write_b32 a14, 0
v_accvgpr_write_b32 a15, 0
v_accvgpr_write_b32 a16, 0
v_accvgpr_write_b32 a17, 0
v_accvgpr_write_b32 a18, 0
v_accvgpr_write_b32 a19, 0
v_accvgpr_write_b32 a20, 0
v_accvgpr_write_b32 a21, 0
v_accvgpr_write_b32 a22, 0
v_accvgpr_write_b32 a23, 0
v_accvgpr_write_b32 a24, 0
v_accvgpr_write_b32 a25, 0
v_accvgpr_write_b32 a26, 0
v_accvgpr_write_b32 a27, 0
v_accvgpr_write_b32 a28, 0
v_accvgpr_write_b32 a29, 0
v_accvgpr_write_b32 a30, 0
v_accvgpr_write_b32 a31, 0
v_accvgpr_write_b32 a32, 0
v_accvgpr_write_b32 a33, 0
v_accvgpr_write_b32 a34, 0
v_accvgpr_write_b32 a35, 0
v_accvgpr_write_b32 a36, 0
v_accvgpr_write_b32 a37, 0
v_accvgpr_write_b32 a38, 0
v_accvgpr_write_b32 a39, 0
v_accvgpr_write_b32 a40, 0
v_accvgpr_write_b32 a41, 0
v_accvgpr_write_b32 a42, 0
v_accvgpr_write_b32 a43, 0
v_accvgpr_write_b32 a44, 0
v_accvgpr_write_b32 a45, 0
v_accvgpr_write_b32 a46, 0
v_accvgpr_write_b32 a47, 0
v_accvgpr_write_b32 a48, 0
v_accvgpr_write_b32 a49, 0
v_accvgpr_write_b32 a50, 0
v_accvgpr_write_b32 a51, 0
v_accvgpr_write_b32 a52, 0
v_accvgpr_write_b32 a53, 0
v_accvgpr_write_b32 a54, 0
v_accvgpr_write_b32 a55, 0
v_accvgpr_write_b32 a56, 0
v_accvgpr_write_b32 a57, 0
v_accvgpr_write_b32 a58, 0
v_accvgpr_write_b32 a59, 0
v_accvgpr_write_b32 a60, 0
v_accvgpr_write_b32 a61, 0
v_accvgpr_write_b32 a62, 0
v_accvgpr_write_b32 a63, 0
v_accvgpr_write_b32 a64, 0
v_accvgpr_write_b32 a65, 0
v_accvgpr_write_b32 a66, 0
v_accvgpr_write_b32 a67, 0
v_accvgpr_write_b32 a68, 0
v_accvgpr_write_b32 a69, 0
v_accvgpr_write_b32 a70, 0
v_accvgpr_write_b32 a71, 0
v_accvgpr_write_b32 a72, 0
v_accvgpr_write_b32 a73, 0
v_accvgpr_write_b32 a74, 0
v_accvgpr_write_b32 a75, 0
v_accvgpr_write_b32 a76, 0
v_accvgpr_write_b32 a77, 0
v_accvgpr_write_b32 a78, 0
v_accvgpr_write_b32 a79, 0
v_accvgpr_write_b32 a80, 0
v_accvgpr_write_b32 a81, 0
v_accvgpr_write_b32 a82, 0
v_accvgpr_write_b32 a83, 0
v_accvgpr_write_b32 a84, 0
v_accvgpr_write_b32 a85, 0
v_accvgpr_write_b32 a86, 0
v_accvgpr_write_b32 a87, 0
v_accvgpr_write_b32 a88, 0
v_accvgpr_write_b32 a89, 0
v_accvgpr_write_b32 a90, 0
v_accvgpr_write_b32 a91, 0
v_accvgpr_write_b32 a92, 0
v_accvgpr_write_b32 a93, 0
v_accvgpr_write_b32 a94, 0
v_accvgpr_write_b32 a95, 0
v_accvgpr_write_b32 a96, 0
v_accvgpr_write_b32 a97, 0
v_accvgpr_write_b32 a98, 0
v_accvgpr_write_b32 a99, 0
v_accvgpr_write_b32 a100, 0
v_accvgpr_write_b32 a101, 0
v_accvgpr_write_b32 a102, 0
v_accvgpr_write_b32 a103, 0
v_accvgpr_write_b32 a104, 0
v_accvgpr_write_b32 a105, 0
v_accvgpr_write_b32 a106, 0
v_accvgpr_write_b32 a107, 0
v_accvgpr_write_b32 a108, 0
v_accvgpr_write_b32 a109, 0
v_accvgpr_write_b32 a110, 0
v_accvgpr_write_b32 a111, 0
v_accvgpr_write_b32 a112, 0
v_accvgpr_write_b32 a113, 0
v_accvgpr_write_b32 a114, 0
v_accvgpr_write_b32 a115, 0
v_accvgpr_write_b32 a116, 0
v_accvgpr_write_b32 a117, 0
v_accvgpr_write_b32 a118, 0
v_accvgpr_write_b32 a119, 0
v_accvgpr_write_b32 a120, 0
v_accvgpr_write_b32 a121, 0
v_accvgpr_write_b32 a122, 0
v_accvgpr_write_b32 a123, 0
v_accvgpr_write_b32 a124, 0
v_accvgpr_write_b32 a125, 0
v_accvgpr_write_b32 a126, 0
v_accvgpr_write_b32 a127, 0
v_accvgpr_write_b32 a128, 0
v_accvgpr_write_b32 a129, 0
v_accvgpr_write_b32 a130, 0
v_accvgpr_write_b32 a131, 0
v_accvgpr_write_b32 a132, 0
v_accvgpr_write_b32 a133, 0
v_accvgpr_write_b32 a134, 0
v_accvgpr_write_b32 a135, 0
v_accvgpr_write_b32 a136, 0
v_accvgpr_write_b32 a137, 0
v_accvgpr_write_b32 a138, 0
v_accvgpr_write_b32 a139, 0
v_accvgpr_write_b32 a140, 0
v_accvgpr_write_b32 a141, 0
v_accvgpr_write_b32 a142, 0
v_accvgpr_write_b32 a143, 0
v_accvgpr_write_b32 a144, 0
v_accvgpr_write_b32 a145, 0
v_accvgpr_write_b32 a146, 0
v_accvgpr_write_b32 a147, 0
v_accvgpr_write_b32 a148, 0
v_accvgpr_write_b32 a149, 0
v_accvgpr_write_b32 a150, 0
v_accvgpr_write_b32 a151, 0
v_accvgpr_write_b32 a152, 0
v_accvgpr_write_b32 a153, 0
v_accvgpr_write_b32 a154, 0
v_accvgpr_write_b32 a155, 0
v_accvgpr_write_b32 a156, 0
v_accvgpr_write_b32 a157, 0
v_accvgpr_write_b32 a158, 0
v_accvgpr_write_b32 a159, 0
v_accvgpr_write_b32 a160, 0
v_accvgpr_write_b32 a161, 0
v_accvgpr_write_b32 a162, 0
v_accvgpr_write_b32 a163, 0
v_accvgpr_write_b32 a164, 0
v_accvgpr_write_b32 a165, 0
v_accvgpr_write_b32 a166, 0
v_accvgpr_write_b32 a167, 0
v_accvgpr_write_b32 a168, 0
v_accvgpr_write_b32 a169, 0
v_accvgpr_write_b32 a170, 0
v_accvgpr_write_b32 a171, 0
v_accvgpr_write_b32 a172, 0
v_accvgpr_write_b32 a173, 0
v_accvgpr_write_b32 a174, 0
v_accvgpr_write_b32 a175, 0
v_accvgpr_write_b32 a176, 0
v_accvgpr_write_b32 a177, 0
v_accvgpr_write_b32 a178, 0
v_accvgpr_write_b32 a179, 0
v_accvgpr_write_b32 a180, 0
v_accvgpr_write_b32 a181, 0
v_accvgpr_write_b32 a182, 0
v_accvgpr_write_b32 a183, 0
v_accvgpr_write_b32 a184, 0
v_accvgpr_write_b32 a185, 0
v_accvgpr_write_b32 a186, 0
v_accvgpr_write_b32 a187, 0
v_accvgpr_write_b32 a188, 0
v_accvgpr_write_b32 a189, 0
v_accvgpr_write_b32 a190, 0
v_accvgpr_write_b32 a191, 0
s_mov_b32 s35, 16
adaLN_cond__sliding_block_cached__glu_gated_swiglu__prompt_kernel_c_redo_loop:
s_waitcnt lgkmcnt(0)
s_barrier
s_mov_b32 m0, s31
s_nop 0
buffer_load_dwordx4 v192, s[4:7], s28 offen lds
buffer_load_dwordx4 v193, s[4:7], s28 offen offset:1024 lds
buffer_load_dwordx4 v194, s[4:7], s28 offen offset:2048 lds
s_add_u32 m0, s31, 12288
s_nop 0
buffer_load_dwordx4 v195, s[8:11], s28 offen lds
buffer_load_dwordx4 v196, s[8:11], s28 offen offset:1024 lds
buffer_load_dwordx4 v197, s[8:11], s28 offen offset:2048 lds
s_add_u32 s28, s28, 12288
s_waitcnt vmcnt(0)
s_barrier
ds_read_b128 a[192:195], v198 offset:0
ds_read_b128 a[196:199], v199 offset:0
ds_read_b128 a[200:203], v198 offset:128
ds_read_b128 a[204:207], v199 offset:128
ds_read_b128 a[208:211], v198 offset:256
ds_read_b128 a[212:215], v199 offset:256
ds_read_b128 a[216:219], v198 offset:6144
ds_read_b128 a[220:223], v199 offset:6144
ds_read_b128 a[224:227], v198 offset:6272
ds_read_b128 a[228:231], v199 offset:6272
ds_read_b128 a[232:235], v198 offset:6400
ds_read_b128 a[236:239], v199 offset:6400
s_waitcnt lgkmcnt(0)
v_mfma_f32_16x16x32_bf16 v[96:99], a[192:195], v[0:3], 0
v_mfma_f32_16x16x32_bf16 v[100:103], a[192:195], v[24:27], 0
v_mfma_f32_16x16x32_bf16 v[104:107], a[192:195], v[48:51], 0
v_mfma_f32_16x16x32_bf16 v[108:111], a[192:195], v[72:75], 0
v_mfma_f32_16x16x32_bf16 v[96:99], a[196:199], v[4:7], v[96:99]
v_mfma_f32_16x16x32_bf16 v[100:103], a[196:199], v[28:31], v[100:103]
v_mfma_f32_16x16x32_bf16 v[104:107], a[196:199], v[52:55], v[104:107]
v_mfma_f32_16x16x32_bf16 v[108:111], a[196:199], v[76:79], v[108:111]
v_mfma_f32_16x16x32_bf16 v[96:99], a[200:203], v[8:11], v[96:99]
v_mfma_f32_16x16x32_bf16 v[100:103], a[200:203], v[32:35], v[100:103]
v_mfma_f32_16x16x32_bf16 v[104:107], a[200:203], v[56:59], v[104:107]
v_mfma_f32_16x16x32_bf16 v[108:111], a[200:203], v[80:83], v[108:111]
v_mfma_f32_16x16x32_bf16 v[96:99], a[204:207], v[12:15], v[96:99]
v_mfma_f32_16x16x32_bf16 v[100:103], a[204:207], v[36:39], v[100:103]
v_mfma_f32_16x16x32_bf16 v[104:107], a[204:207], v[60:63], v[104:107]
v_mfma_f32_16x16x32_bf16 v[108:111], a[204:207], v[84:87], v[108:111]
v_mfma_f32_16x16x32_bf16 v[96:99], a[208:211], v[16:19], v[96:99]
v_mfma_f32_16x16x32_bf16 v[100:103], a[208:211], v[40:43], v[100:103]
v_mfma_f32_16x16x32_bf16 v[104:107], a[208:211], v[64:67], v[104:107]
v_mfma_f32_16x16x32_bf16 v[108:111], a[208:211], v[88:91], v[108:111]
v_mfma_f32_16x16x32_bf16 v[96:99], a[212:215], v[20:23], v[96:99]
v_mfma_f32_16x16x32_bf16 v[100:103], a[212:215], v[44:47], v[100:103]
v_mfma_f32_16x16x32_bf16 v[104:107], a[212:215], v[68:71], v[104:107]
v_mfma_f32_16x16x32_bf16 v[108:111], a[212:215], v[92:95], v[108:111]
v_mfma_f32_16x16x32_bf16 v[112:115], a[216:219], v[0:3], 0
v_mfma_f32_16x16x32_bf16 v[116:119], a[216:219], v[24:27], 0
v_mfma_f32_16x16x32_bf16 v[120:123], a[216:219], v[48:51], 0
v_mfma_f32_16x16x32_bf16 v[124:127], a[216:219], v[72:75], 0
v_mfma_f32_16x16x32_bf16 v[112:115], a[220:223], v[4:7], v[112:115]
v_mfma_f32_16x16x32_bf16 v[116:119], a[220:223], v[28:31], v[116:119]
v_mfma_f32_16x16x32_bf16 v[120:123], a[220:223], v[52:55], v[120:123]
v_mfma_f32_16x16x32_bf16 v[124:127], a[220:223], v[76:79], v[124:127]
v_mfma_f32_16x16x32_bf16 v[112:115], a[224:227], v[8:11], v[112:115]
v_mfma_f32_16x16x32_bf16 v[116:119], a[224:227], v[32:35], v[116:119]
v_mfma_f32_16x16x32_bf16 v[120:123], a[224:227], v[56:59], v[120:123]
v_mfma_f32_16x16x32_bf16 v[124:127], a[224:227], v[80:83], v[124:127]
v_mfma_f32_16x16x32_bf16 v[112:115], a[228:231], v[12:15], v[112:115]
v_mfma_f32_16x16x32_bf16 v[116:119], a[228:231], v[36:39], v[116:119]
v_mfma_f32_16x16x32_bf16 v[120:123], a[228:231], v[60:63], v[120:123]
v_mfma_f32_16x16x32_bf16 v[124:127], a[228:231], v[84:87], v[124:127]
v_mfma_f32_16x16x32_bf16 v[112:115], a[232:235], v[16:19], v[112:115]
v_mfma_f32_16x16x32_bf16 v[116:119], a[232:235], v[40:43], v[116:119]
v_mfma_f32_16x16x32_bf16 v[120:123], a[232:235], v[64:67], v[120:123]
v_mfma_f32_16x16x32_bf16 v[124:127], a[232:235], v[88:91], v[124:127]
v_mfma_f32_16x16x32_bf16 v[112:115], a[236:239], v[20:23], v[112:115]
v_mfma_f32_16x16x32_bf16 v[116:119], a[236:239], v[44:47], v[116:119]
v_mfma_f32_16x16x32_bf16 v[120:123], a[236:239], v[68:71], v[120:123]
v_mfma_f32_16x16x32_bf16 v[124:127], a[236:239], v[92:95], v[124:127]
s_nop 7
ds_read_b64_tr_b16 a[192:193], v200 offset:12288
ds_read_b64_tr_b16 a[194:195], v200 offset:18432
ds_read_b64_tr_b16 a[196:197], v201 offset:12288
ds_read_b64_tr_b16 a[198:199], v201 offset:18432
ds_read_b64_tr_b16 a[200:201], v202 offset:12288
ds_read_b64_tr_b16 a[202:203], v202 offset:18432
ds_read_b64_tr_b16 a[204:205], v203 offset:12288
ds_read_b64_tr_b16 a[206:207], v203 offset:18432
ds_read_b64_tr_b16 a[208:209], v200 offset:12416
ds_read_b64_tr_b16 a[210:211], v200 offset:18560
ds_read_b64_tr_b16 a[212:213], v201 offset:12416
ds_read_b64_tr_b16 a[214:215], v201 offset:18560
ds_read_b64_tr_b16 a[216:217], v202 offset:12416
ds_read_b64_tr_b16 a[218:219], v202 offset:18560
ds_read_b64_tr_b16 a[220:221], v203 offset:12416
ds_read_b64_tr_b16 a[222:223], v203 offset:18560
ds_read_b64_tr_b16 a[224:225], v200 offset:12544
ds_read_b64_tr_b16 a[226:227], v200 offset:18688
ds_read_b64_tr_b16 a[228:229], v201 offset:12544
ds_read_b64_tr_b16 a[230:231], v201 offset:18688
ds_read_b64_tr_b16 a[232:233], v202 offset:12544
ds_read_b64_tr_b16 a[234:235], v202 offset:18688
ds_read_b64_tr_b16 a[236:237], v203 offset:12544
ds_read_b64_tr_b16 a[238:239], v203 offset:18688
v_max3_f32 v180, v96, v97, v98
v_max3_f32 v180, v180, v99, v112
v_max3_f32 v180, v180, v113, v114
v_max3_f32 v180, v180, v115, v160
v_max3_f32 v181, v100, v101, v102
v_max3_f32 v181, v181, v103, v116
v_max3_f32 v181, v181, v117, v118
v_max3_f32 v181, v181, v119, v161
v_max3_f32 v182, v104, v105, v106
v_max3_f32 v182, v182, v107, v120
v_max3_f32 v182, v182, v121, v122
v_max3_f32 v182, v182, v123, v162
v_max3_f32 v183, v108, v109, v110
v_max3_f32 v183, v183, v111, v124
v_max3_f32 v183, v183, v125, v126
v_max3_f32 v183, v183, v127, v163
v_mov_b32 v184, v180
s_nop 1
v_permlane32_swap_b32 v184, v180
v_max_f32 v180, v184, v180
v_mov_b32 v184, v180
s_nop 1
v_permlane16_swap_b32 v184, v180
v_max_f32 v180, v184, v180
v_mov_b32 v184, v181
s_nop 1
v_permlane32_swap_b32 v184, v181
v_max_f32 v181, v184, v181
v_mov_b32 v184, v181
s_nop 1
v_permlane16_swap_b32 v184, v181
v_max_f32 v181, v184, v181
v_mov_b32 v184, v182
s_nop 1
v_permlane32_swap_b32 v184, v182
v_max_f32 v182, v184, v182
v_mov_b32 v184, v182
s_nop 1
v_permlane16_swap_b32 v184, v182
v_max_f32 v182, v184, v182
v_mov_b32 v184, v183
s_nop 1
v_permlane32_swap_b32 v184, v183
v_max_f32 v183, v184, v183
v_mov_b32 v184, v183
s_nop 1
v_permlane16_swap_b32 v184, v183
v_max_f32 v183, v184, v183
v_sub_f32 v164, v160, v180
v_exp_f32 v164, v164
v_mov_b32 v160, v180
v_sub_f32 v165, v161, v181
v_exp_f32 v165, v165
v_mov_b32 v161, v181
v_sub_f32 v166, v162, v182
v_exp_f32 v166, v166
v_mov_b32 v162, v182
v_sub_f32 v167, v163, v183
v_exp_f32 v167, v167
v_mov_b32 v163, v183
v_mul_f32 v176, v176, v164
v_mul_f32 v177, v177, v165
v_mul_f32 v178, v178, v166
v_mul_f32 v179, v179, v167
v_accvgpr_read_b32 v188, a0
v_accvgpr_read_b32 v189, a1
v_accvgpr_read_b32 v190, a2
v_accvgpr_read_b32 v191, a3
v_mul_f32 v188, v188, v164
v_mul_f32 v189, v189, v164
v_mul_f32 v190, v190, v164
v_mul_f32 v191, v191, v164
v_accvgpr_write_b32 a0, v188
v_accvgpr_write_b32 a1, v189
v_accvgpr_write_b32 a2, v190
v_accvgpr_write_b32 a3, v191
v_accvgpr_read_b32 v188, a4
v_accvgpr_read_b32 v189, a5
v_accvgpr_read_b32 v190, a6
v_accvgpr_read_b32 v191, a7
v_mul_f32 v188, v188, v165
v_mul_f32 v189, v189, v165
v_mul_f32 v190, v190, v165
v_mul_f32 v191, v191, v165
v_accvgpr_write_b32 a4, v188
v_accvgpr_write_b32 a5, v189
v_accvgpr_write_b32 a6, v190
v_accvgpr_write_b32 a7, v191
v_accvgpr_read_b32 v188, a8
v_accvgpr_read_b32 v189, a9
v_accvgpr_read_b32 v190, a10
v_accvgpr_read_b32 v191, a11
v_mul_f32 v188, v188, v166
v_mul_f32 v189, v189, v166
v_mul_f32 v190, v190, v166
v_mul_f32 v191, v191, v166
v_accvgpr_write_b32 a8, v188
v_accvgpr_write_b32 a9, v189
v_accvgpr_write_b32 a10, v190
v_accvgpr_write_b32 a11, v191
v_accvgpr_read_b32 v188, a12
v_accvgpr_read_b32 v189, a13
v_accvgpr_read_b32 v190, a14
v_accvgpr_read_b32 v191, a15
v_mul_f32 v188, v188, v167
v_mul_f32 v189, v189, v167
v_mul_f32 v190, v190, v167
v_mul_f32 v191, v191, v167
v_accvgpr_write_b32 a12, v188
v_accvgpr_write_b32 a13, v189
v_accvgpr_write_b32 a14, v190
v_accvgpr_write_b32 a15, v191
v_accvgpr_read_b32 v188, a16
v_accvgpr_read_b32 v189, a17
v_accvgpr_read_b32 v190, a18
v_accvgpr_read_b32 v191, a19
v_mul_f32 v188, v188, v164
v_mul_f32 v189, v189, v164
v_mul_f32 v190, v190, v164
v_mul_f32 v191, v191, v164
v_accvgpr_write_b32 a16, v188
v_accvgpr_write_b32 a17, v189
v_accvgpr_write_b32 a18, v190
v_accvgpr_write_b32 a19, v191
v_accvgpr_read_b32 v188, a20
v_accvgpr_read_b32 v189, a21
v_accvgpr_read_b32 v190, a22
v_accvgpr_read_b32 v191, a23
v_mul_f32 v188, v188, v165
v_mul_f32 v189, v189, v165
v_mul_f32 v190, v190, v165
v_mul_f32 v191, v191, v165
v_accvgpr_write_b32 a20, v188
v_accvgpr_write_b32 a21, v189
v_accvgpr_write_b32 a22, v190
v_accvgpr_write_b32 a23, v191
v_accvgpr_read_b32 v188, a24
v_accvgpr_read_b32 v189, a25
v_accvgpr_read_b32 v190, a26
v_accvgpr_read_b32 v191, a27
v_mul_f32 v188, v188, v166
v_mul_f32 v189, v189, v166
v_mul_f32 v190, v190, v166
v_mul_f32 v191, v191, v166
v_accvgpr_write_b32 a24, v188
v_accvgpr_write_b32 a25, v189
v_accvgpr_write_b32 a26, v190
v_accvgpr_write_b32 a27, v191
v_accvgpr_read_b32 v188, a28
v_accvgpr_read_b32 v189, a29
v_accvgpr_read_b32 v190, a30
v_accvgpr_read_b32 v191, a31
v_mul_f32 v188, v188, v167
v_mul_f32 v189, v189, v167
v_mul_f32 v190, v190, v167
v_mul_f32 v191, v191, v167
v_accvgpr_write_b32 a28, v188
v_accvgpr_write_b32 a29, v189
v_accvgpr_write_b32 a30, v190
v_accvgpr_write_b32 a31, v191
v_accvgpr_read_b32 v188, a32
v_accvgpr_read_b32 v189, a33
v_accvgpr_read_b32 v190, a34
v_accvgpr_read_b32 v191, a35
v_mul_f32 v188, v188, v164
v_mul_f32 v189, v189, v164
v_mul_f32 v190, v190, v164
v_mul_f32 v191, v191, v164
v_accvgpr_write_b32 a32, v188
v_accvgpr_write_b32 a33, v189
v_accvgpr_write_b32 a34, v190
v_accvgpr_write_b32 a35, v191
v_accvgpr_read_b32 v188, a36
v_accvgpr_read_b32 v189, a37
v_accvgpr_read_b32 v190, a38
v_accvgpr_read_b32 v191, a39
v_mul_f32 v188, v188, v165
v_mul_f32 v189, v189, v165
v_mul_f32 v190, v190, v165
v_mul_f32 v191, v191, v165
v_accvgpr_write_b32 a36, v188
v_accvgpr_write_b32 a37, v189
v_accvgpr_write_b32 a38, v190
v_accvgpr_write_b32 a39, v191
v_accvgpr_read_b32 v188, a40
v_accvgpr_read_b32 v189, a41
v_accvgpr_read_b32 v190, a42
v_accvgpr_read_b32 v191, a43
v_mul_f32 v188, v188, v166
v_mul_f32 v189, v189, v166
v_mul_f32 v190, v190, v166
v_mul_f32 v191, v191, v166
v_accvgpr_write_b32 a40, v188
v_accvgpr_write_b32 a41, v189
v_accvgpr_write_b32 a42, v190
v_accvgpr_write_b32 a43, v191
v_accvgpr_read_b32 v188, a44
v_accvgpr_read_b32 v189, a45
v_accvgpr_read_b32 v190, a46
v_accvgpr_read_b32 v191, a47
v_mul_f32 v188, v188, v167
v_mul_f32 v189, v189, v167
v_mul_f32 v190, v190, v167
v_mul_f32 v191, v191, v167
v_accvgpr_write_b32 a44, v188
v_accvgpr_write_b32 a45, v189
v_accvgpr_write_b32 a46, v190
v_accvgpr_write_b32 a47, v191
v_accvgpr_read_b32 v188, a48
v_accvgpr_read_b32 v189, a49
v_accvgpr_read_b32 v190, a50
v_accvgpr_read_b32 v191, a51
v_mul_f32 v188, v188, v164
v_mul_f32 v189, v189, v164
v_mul_f32 v190, v190, v164
v_mul_f32 v191, v191, v164
v_accvgpr_write_b32 a48, v188
v_accvgpr_write_b32 a49, v189
v_accvgpr_write_b32 a50, v190
v_accvgpr_write_b32 a51, v191
v_accvgpr_read_b32 v188, a52
v_accvgpr_read_b32 v189, a53
v_accvgpr_read_b32 v190, a54
v_accvgpr_read_b32 v191, a55
v_mul_f32 v188, v188, v165
v_mul_f32 v189, v189, v165
v_mul_f32 v190, v190, v165
v_mul_f32 v191, v191, v165
v_accvgpr_write_b32 a52, v188
v_accvgpr_write_b32 a53, v189
v_accvgpr_write_b32 a54, v190
v_accvgpr_write_b32 a55, v191
v_accvgpr_read_b32 v188, a56
v_accvgpr_read_b32 v189, a57
v_accvgpr_read_b32 v190, a58
v_accvgpr_read_b32 v191, a59
v_mul_f32 v188, v188, v166
v_mul_f32 v189, v189, v166
v_mul_f32 v190, v190, v166
v_mul_f32 v191, v191, v166
v_accvgpr_write_b32 a56, v188
v_accvgpr_write_b32 a57, v189
v_accvgpr_write_b32 a58, v190
v_accvgpr_write_b32 a59, v191
v_accvgpr_read_b32 v188, a60
v_accvgpr_read_b32 v189, a61
v_accvgpr_read_b32 v190, a62
v_accvgpr_read_b32 v191, a63
v_mul_f32 v188, v188, v167
v_mul_f32 v189, v189, v167
v_mul_f32 v190, v190, v167
v_mul_f32 v191, v191, v167
v_accvgpr_write_b32 a60, v188
v_accvgpr_write_b32 a61, v189
v_accvgpr_write_b32 a62, v190
v_accvgpr_write_b32 a63, v191
v_accvgpr_read_b32 v188, a64
v_accvgpr_read_b32 v189, a65
v_accvgpr_read_b32 v190, a66
v_accvgpr_read_b32 v191, a67
v_mul_f32 v188, v188, v164
v_mul_f32 v189, v189, v164
v_mul_f32 v190, v190, v164
v_mul_f32 v191, v191, v164
v_accvgpr_write_b32 a64, v188
v_accvgpr_write_b32 a65, v189
v_accvgpr_write_b32 a66, v190
v_accvgpr_write_b32 a67, v191
v_accvgpr_read_b32 v188, a68
v_accvgpr_read_b32 v189, a69
v_accvgpr_read_b32 v190, a70
v_accvgpr_read_b32 v191, a71
v_mul_f32 v188, v188, v165
v_mul_f32 v189, v189, v165
v_mul_f32 v190, v190, v165
v_mul_f32 v191, v191, v165
v_accvgpr_write_b32 a68, v188
v_accvgpr_write_b32 a69, v189
v_accvgpr_write_b32 a70, v190
v_accvgpr_write_b32 a71, v191
v_accvgpr_read_b32 v188, a72
v_accvgpr_read_b32 v189, a73
v_accvgpr_read_b32 v190, a74
v_accvgpr_read_b32 v191, a75
v_mul_f32 v188, v188, v166
v_mul_f32 v189, v189, v166
v_mul_f32 v190, v190, v166
v_mul_f32 v191, v191, v166
v_accvgpr_write_b32 a72, v188
v_accvgpr_write_b32 a73, v189
v_accvgpr_write_b32 a74, v190
v_accvgpr_write_b32 a75, v191
v_accvgpr_read_b32 v188, a76
v_accvgpr_read_b32 v189, a77
v_accvgpr_read_b32 v190, a78
v_accvgpr_read_b32 v191, a79
v_mul_f32 v188, v188, v167
v_mul_f32 v189, v189, v167
v_mul_f32 v190, v190, v167
v_mul_f32 v191, v191, v167
v_accvgpr_write_b32 a76, v188
v_accvgpr_write_b32 a77, v189
v_accvgpr_write_b32 a78, v190
v_accvgpr_write_b32 a79, v191
v_accvgpr_read_b32 v188, a80
v_accvgpr_read_b32 v189, a81
v_accvgpr_read_b32 v190, a82
v_accvgpr_read_b32 v191, a83
v_mul_f32 v188, v188, v164
v_mul_f32 v189, v189, v164
v_mul_f32 v190, v190, v164
v_mul_f32 v191, v191, v164
v_accvgpr_write_b32 a80, v188
v_accvgpr_write_b32 a81, v189
v_accvgpr_write_b32 a82, v190
v_accvgpr_write_b32 a83, v191
v_accvgpr_read_b32 v188, a84
v_accvgpr_read_b32 v189, a85
v_accvgpr_read_b32 v190, a86
v_accvgpr_read_b32 v191, a87
v_mul_f32 v188, v188, v165
v_mul_f32 v189, v189, v165
v_mul_f32 v190, v190, v165
v_mul_f32 v191, v191, v165
v_accvgpr_write_b32 a84, v188
v_accvgpr_write_b32 a85, v189
v_accvgpr_write_b32 a86, v190
v_accvgpr_write_b32 a87, v191
v_accvgpr_read_b32 v188, a88
v_accvgpr_read_b32 v189, a89
v_accvgpr_read_b32 v190, a90
v_accvgpr_read_b32 v191, a91
v_mul_f32 v188, v188, v166
v_mul_f32 v189, v189, v166
v_mul_f32 v190, v190, v166
v_mul_f32 v191, v191, v166
v_accvgpr_write_b32 a88, v188
v_accvgpr_write_b32 a89, v189
v_accvgpr_write_b32 a90, v190
v_accvgpr_write_b32 a91, v191
v_accvgpr_read_b32 v188, a92
v_accvgpr_read_b32 v189, a93
v_accvgpr_read_b32 v190, a94
v_accvgpr_read_b32 v191, a95
v_mul_f32 v188, v188, v167
v_mul_f32 v189, v189, v167
v_mul_f32 v190, v190, v167
v_mul_f32 v191, v191, v167
v_accvgpr_write_b32 a92, v188
v_accvgpr_write_b32 a93, v189
v_accvgpr_write_b32 a94, v190
v_accvgpr_write_b32 a95, v191
v_accvgpr_read_b32 v188, a96
v_accvgpr_read_b32 v189, a97
v_accvgpr_read_b32 v190, a98
v_accvgpr_read_b32 v191, a99
v_mul_f32 v188, v188, v164
v_mul_f32 v189, v189, v164
v_mul_f32 v190, v190, v164
v_mul_f32 v191, v191, v164
v_accvgpr_write_b32 a96, v188
v_accvgpr_write_b32 a97, v189
v_accvgpr_write_b32 a98, v190
v_accvgpr_write_b32 a99, v191
v_accvgpr_read_b32 v188, a100
v_accvgpr_read_b32 v189, a101
v_accvgpr_read_b32 v190, a102
v_accvgpr_read_b32 v191, a103
v_mul_f32 v188, v188, v165
v_mul_f32 v189, v189, v165
v_mul_f32 v190, v190, v165
v_mul_f32 v191, v191, v165
v_accvgpr_write_b32 a100, v188
v_accvgpr_write_b32 a101, v189
v_accvgpr_write_b32 a102, v190
v_accvgpr_write_b32 a103, v191
v_accvgpr_read_b32 v188, a104
v_accvgpr_read_b32 v189, a105
v_accvgpr_read_b32 v190, a106
v_accvgpr_read_b32 v191, a107
v_mul_f32 v188, v188, v166
v_mul_f32 v189, v189, v166
v_mul_f32 v190, v190, v166
v_mul_f32 v191, v191, v166
v_accvgpr_write_b32 a104, v188
v_accvgpr_write_b32 a105, v189
v_accvgpr_write_b32 a106, v190
v_accvgpr_write_b32 a107, v191
v_accvgpr_read_b32 v188, a108
v_accvgpr_read_b32 v189, a109
v_accvgpr_read_b32 v190, a110
v_accvgpr_read_b32 v191, a111
v_mul_f32 v188, v188, v167
v_mul_f32 v189, v189, v167
v_mul_f32 v190, v190, v167
v_mul_f32 v191, v191, v167
v_accvgpr_write_b32 a108, v188
v_accvgpr_write_b32 a109, v189
v_accvgpr_write_b32 a110, v190
v_accvgpr_write_b32 a111, v191
v_accvgpr_read_b32 v188, a112
v_accvgpr_read_b32 v189, a113
v_accvgpr_read_b32 v190, a114
v_accvgpr_read_b32 v191, a115
v_mul_f32 v188, v188, v164
v_mul_f32 v189, v189, v164
v_mul_f32 v190, v190, v164
v_mul_f32 v191, v191, v164
v_accvgpr_write_b32 a112, v188
v_accvgpr_write_b32 a113, v189
v_accvgpr_write_b32 a114, v190
v_accvgpr_write_b32 a115, v191
v_accvgpr_read_b32 v188, a116
v_accvgpr_read_b32 v189, a117
v_accvgpr_read_b32 v190, a118
v_accvgpr_read_b32 v191, a119
v_mul_f32 v188, v188, v165
v_mul_f32 v189, v189, v165
v_mul_f32 v190, v190, v165
v_mul_f32 v191, v191, v165
v_accvgpr_write_b32 a116, v188
v_accvgpr_write_b32 a117, v189
v_accvgpr_write_b32 a118, v190
v_accvgpr_write_b32 a119, v191
v_accvgpr_read_b32 v188, a120
v_accvgpr_read_b32 v189, a121
v_accvgpr_read_b32 v190, a122
v_accvgpr_read_b32 v191, a123
v_mul_f32 v188, v188, v166
v_mul_f32 v189, v189, v166
v_mul_f32 v190, v190, v166
v_mul_f32 v191, v191, v166
v_accvgpr_write_b32 a120, v188
v_accvgpr_write_b32 a121, v189
v_accvgpr_write_b32 a122, v190
v_accvgpr_write_b32 a123, v191
v_accvgpr_read_b32 v188, a124
v_accvgpr_read_b32 v189, a125
v_accvgpr_read_b32 v190, a126
v_accvgpr_read_b32 v191, a127
v_mul_f32 v188, v188, v167
v_mul_f32 v189, v189, v167
v_mul_f32 v190, v190, v167
v_mul_f32 v191, v191, v167
v_accvgpr_write_b32 a124, v188
v_accvgpr_write_b32 a125, v189
v_accvgpr_write_b32 a126, v190
v_accvgpr_write_b32 a127, v191
v_accvgpr_read_b32 v188, a128
v_accvgpr_read_b32 v189, a129
v_accvgpr_read_b32 v190, a130
v_accvgpr_read_b32 v191, a131
v_mul_f32 v188, v188, v164
v_mul_f32 v189, v189, v164
v_mul_f32 v190, v190, v164
v_mul_f32 v191, v191, v164
v_accvgpr_write_b32 a128, v188
v_accvgpr_write_b32 a129, v189
v_accvgpr_write_b32 a130, v190
v_accvgpr_write_b32 a131, v191
v_accvgpr_read_b32 v188, a132
v_accvgpr_read_b32 v189, a133
v_accvgpr_read_b32 v190, a134
v_accvgpr_read_b32 v191, a135
v_mul_f32 v188, v188, v165
v_mul_f32 v189, v189, v165
v_mul_f32 v190, v190, v165
v_mul_f32 v191, v191, v165
v_accvgpr_write_b32 a132, v188
v_accvgpr_write_b32 a133, v189
v_accvgpr_write_b32 a134, v190
v_accvgpr_write_b32 a135, v191
v_accvgpr_read_b32 v188, a136
v_accvgpr_read_b32 v189, a137
v_accvgpr_read_b32 v190, a138
v_accvgpr_read_b32 v191, a139
v_mul_f32 v188, v188, v166
v_mul_f32 v189, v189, v166
v_mul_f32 v190, v190, v166
v_mul_f32 v191, v191, v166
v_accvgpr_write_b32 a136, v188
v_accvgpr_write_b32 a137, v189
v_accvgpr_write_b32 a138, v190
v_accvgpr_write_b32 a139, v191
v_accvgpr_read_b32 v188, a140
v_accvgpr_read_b32 v189, a141
v_accvgpr_read_b32 v190, a142
v_accvgpr_read_b32 v191, a143
v_mul_f32 v188, v188, v167
v_mul_f32 v189, v189, v167
v_mul_f32 v190, v190, v167
v_mul_f32 v191, v191, v167
v_accvgpr_write_b32 a140, v188
v_accvgpr_write_b32 a141, v189
v_accvgpr_write_b32 a142, v190
v_accvgpr_write_b32 a143, v191
v_accvgpr_read_b32 v188, a144
v_accvgpr_read_b32 v189, a145
v_accvgpr_read_b32 v190, a146
v_accvgpr_read_b32 v191, a147
v_mul_f32 v188, v188, v164
v_mul_f32 v189, v189, v164
v_mul_f32 v190, v190, v164
v_mul_f32 v191, v191, v164
v_accvgpr_write_b32 a144, v188
v_accvgpr_write_b32 a145, v189
v_accvgpr_write_b32 a146, v190
v_accvgpr_write_b32 a147, v191
v_accvgpr_read_b32 v188, a148
v_accvgpr_read_b32 v189, a149
v_accvgpr_read_b32 v190, a150
v_accvgpr_read_b32 v191, a151
v_mul_f32 v188, v188, v165
v_mul_f32 v189, v189, v165
v_mul_f32 v190, v190, v165
v_mul_f32 v191, v191, v165
v_accvgpr_write_b32 a148, v188
v_accvgpr_write_b32 a149, v189
v_accvgpr_write_b32 a150, v190
v_accvgpr_write_b32 a151, v191
v_accvgpr_read_b32 v188, a152
v_accvgpr_read_b32 v189, a153
v_accvgpr_read_b32 v190, a154
v_accvgpr_read_b32 v191, a155
v_mul_f32 v188, v188, v166
v_mul_f32 v189, v189, v166
v_mul_f32 v190, v190, v166
v_mul_f32 v191, v191, v166
v_accvgpr_write_b32 a152, v188
v_accvgpr_write_b32 a153, v189
v_accvgpr_write_b32 a154, v190
v_accvgpr_write_b32 a155, v191
v_accvgpr_read_b32 v188, a156
v_accvgpr_read_b32 v189, a157
v_accvgpr_read_b32 v190, a158
v_accvgpr_read_b32 v191, a159
v_mul_f32 v188, v188, v167
v_mul_f32 v189, v189, v167
v_mul_f32 v190, v190, v167
v_mul_f32 v191, v191, v167
v_accvgpr_write_b32 a156, v188
v_accvgpr_write_b32 a157, v189
v_accvgpr_write_b32 a158, v190
v_accvgpr_write_b32 a159, v191
v_accvgpr_read_b32 v188, a160
v_accvgpr_read_b32 v189, a161
v_accvgpr_read_b32 v190, a162
v_accvgpr_read_b32 v191, a163
v_mul_f32 v188, v188, v164
v_mul_f32 v189, v189, v164
v_mul_f32 v190, v190, v164
v_mul_f32 v191, v191, v164
v_accvgpr_write_b32 a160, v188
v_accvgpr_write_b32 a161, v189
v_accvgpr_write_b32 a162, v190
v_accvgpr_write_b32 a163, v191
v_accvgpr_read_b32 v188, a164
v_accvgpr_read_b32 v189, a165
v_accvgpr_read_b32 v190, a166
v_accvgpr_read_b32 v191, a167
v_mul_f32 v188, v188, v165
v_mul_f32 v189, v189, v165
v_mul_f32 v190, v190, v165
v_mul_f32 v191, v191, v165
v_accvgpr_write_b32 a164, v188
v_accvgpr_write_b32 a165, v189
v_accvgpr_write_b32 a166, v190
v_accvgpr_write_b32 a167, v191
v_accvgpr_read_b32 v188, a168
v_accvgpr_read_b32 v189, a169
v_accvgpr_read_b32 v190, a170
v_accvgpr_read_b32 v191, a171
v_mul_f32 v188, v188, v166
v_mul_f32 v189, v189, v166
v_mul_f32 v190, v190, v166
v_mul_f32 v191, v191, v166
v_accvgpr_write_b32 a168, v188
v_accvgpr_write_b32 a169, v189
v_accvgpr_write_b32 a170, v190
v_accvgpr_write_b32 a171, v191
v_accvgpr_read_b32 v188, a172
v_accvgpr_read_b32 v189, a173
v_accvgpr_read_b32 v190, a174
v_accvgpr_read_b32 v191, a175
v_mul_f32 v188, v188, v167
v_mul_f32 v189, v189, v167
v_mul_f32 v190, v190, v167
v_mul_f32 v191, v191, v167
v_accvgpr_write_b32 a172, v188
v_accvgpr_write_b32 a173, v189
v_accvgpr_write_b32 a174, v190
v_accvgpr_write_b32 a175, v191
v_accvgpr_read_b32 v188, a176
v_accvgpr_read_b32 v189, a177
v_accvgpr_read_b32 v190, a178
v_accvgpr_read_b32 v191, a179
v_mul_f32 v188, v188, v164
v_mul_f32 v189, v189, v164
v_mul_f32 v190, v190, v164
v_mul_f32 v191, v191, v164
v_accvgpr_write_b32 a176, v188
v_accvgpr_write_b32 a177, v189
v_accvgpr_write_b32 a178, v190
v_accvgpr_write_b32 a179, v191
v_accvgpr_read_b32 v188, a180
v_accvgpr_read_b32 v189, a181
v_accvgpr_read_b32 v190, a182
v_accvgpr_read_b32 v191, a183
v_mul_f32 v188, v188, v165
v_mul_f32 v189, v189, v165
v_mul_f32 v190, v190, v165
v_mul_f32 v191, v191, v165
v_accvgpr_write_b32 a180, v188
v_accvgpr_write_b32 a181, v189
v_accvgpr_write_b32 a182, v190
v_accvgpr_write_b32 a183, v191
v_accvgpr_read_b32 v188, a184
v_accvgpr_read_b32 v189, a185
v_accvgpr_read_b32 v190, a186
v_accvgpr_read_b32 v191, a187
v_mul_f32 v188, v188, v166
v_mul_f32 v189, v189, v166
v_mul_f32 v190, v190, v166
v_mul_f32 v191, v191, v166
v_accvgpr_write_b32 a184, v188
v_accvgpr_write_b32 a185, v189
v_accvgpr_write_b32 a186, v190
v_accvgpr_write_b32 a187, v191
v_accvgpr_read_b32 v188, a188
v_accvgpr_read_b32 v189, a189
v_accvgpr_read_b32 v190, a190
v_accvgpr_read_b32 v191, a191
v_mul_f32 v188, v188, v167
v_mul_f32 v189, v189, v167
v_mul_f32 v190, v190, v167
v_mul_f32 v191, v191, v167
v_accvgpr_write_b32 a188, v188
v_accvgpr_write_b32 a189, v189
v_accvgpr_write_b32 a190, v190
v_accvgpr_write_b32 a191, v191
v_sub_f32 v96, v96, v160
v_sub_f32 v97, v97, v160
v_sub_f32 v98, v98, v160
v_sub_f32 v99, v99, v160
v_exp_f32 v96, v96
v_exp_f32 v97, v97
v_exp_f32 v98, v98
v_exp_f32 v99, v99
s_nop 0
v_add_f32 v176, v96, v176
v_add_f32 v176, v97, v176
v_add_f32 v176, v98, v176
v_add_f32 v176, v99, v176
v_cvt_pk_bf16_f32 v128, v96, v97
v_cvt_pk_bf16_f32 v129, v98, v99
v_sub_f32 v100, v100, v161
v_sub_f32 v101, v101, v161
v_sub_f32 v102, v102, v161
v_sub_f32 v103, v103, v161
v_exp_f32 v100, v100
v_exp_f32 v101, v101
v_exp_f32 v102, v102
v_exp_f32 v103, v103
s_nop 0
v_add_f32 v177, v100, v177
v_add_f32 v177, v101, v177
v_add_f32 v177, v102, v177
v_add_f32 v177, v103, v177
v_cvt_pk_bf16_f32 v132, v100, v101
v_cvt_pk_bf16_f32 v133, v102, v103
v_sub_f32 v104, v104, v162
v_sub_f32 v105, v105, v162
v_sub_f32 v106, v106, v162
v_sub_f32 v107, v107, v162
v_exp_f32 v104, v104
v_exp_f32 v105, v105
v_exp_f32 v106, v106
v_exp_f32 v107, v107
s_nop 0
v_add_f32 v178, v104, v178
v_add_f32 v178, v105, v178
v_add_f32 v178, v106, v178
v_add_f32 v178, v107, v178
v_cvt_pk_bf16_f32 v136, v104, v105
v_cvt_pk_bf16_f32 v137, v106, v107
v_sub_f32 v108, v108, v163
v_sub_f32 v109, v109, v163
v_sub_f32 v110, v110, v163
v_sub_f32 v111, v111, v163
v_exp_f32 v108, v108
v_exp_f32 v109, v109
v_exp_f32 v110, v110
v_exp_f32 v111, v111
s_nop 0
v_add_f32 v179, v108, v179
v_add_f32 v179, v109, v179
v_add_f32 v179, v110, v179
v_add_f32 v179, v111, v179
v_cvt_pk_bf16_f32 v140, v108, v109
v_cvt_pk_bf16_f32 v141, v110, v111
v_sub_f32 v112, v112, v160
v_sub_f32 v113, v113, v160
v_sub_f32 v114, v114, v160
v_sub_f32 v115, v115, v160
v_exp_f32 v112, v112
v_exp_f32 v113, v113
v_exp_f32 v114, v114
v_exp_f32 v115, v115
s_nop 0
v_add_f32 v176, v112, v176
v_add_f32 v176, v113, v176
v_add_f32 v176, v114, v176
v_add_f32 v176, v115, v176
v_cvt_pk_bf16_f32 v130, v112, v113
v_cvt_pk_bf16_f32 v131, v114, v115
v_sub_f32 v116, v116, v161
v_sub_f32 v117, v117, v161
v_sub_f32 v118, v118, v161
v_sub_f32 v119, v119, v161
v_exp_f32 v116, v116
v_exp_f32 v117, v117
v_exp_f32 v118, v118
v_exp_f32 v119, v119
s_nop 0
v_add_f32 v177, v116, v177
v_add_f32 v177, v117, v177
v_add_f32 v177, v118, v177
v_add_f32 v177, v119, v177
v_cvt_pk_bf16_f32 v134, v116, v117
v_cvt_pk_bf16_f32 v135, v118, v119
v_sub_f32 v120, v120, v162
v_sub_f32 v121, v121, v162
v_sub_f32 v122, v122, v162
v_sub_f32 v123, v123, v162
v_exp_f32 v120, v120
v_exp_f32 v121, v121
v_exp_f32 v122, v122
v_exp_f32 v123, v123
s_nop 0
v_add_f32 v178, v120, v178
v_add_f32 v178, v121, v178
v_add_f32 v178, v122, v178
v_add_f32 v178, v123, v178
v_cvt_pk_bf16_f32 v138, v120, v121
v_cvt_pk_bf16_f32 v139, v122, v123
v_sub_f32 v124, v124, v163
v_sub_f32 v125, v125, v163
v_sub_f32 v126, v126, v163
v_sub_f32 v127, v127, v163
v_exp_f32 v124, v124
v_exp_f32 v125, v125
v_exp_f32 v126, v126
v_exp_f32 v127, v127
s_nop 0
v_add_f32 v179, v124, v179
v_add_f32 v179, v125, v179
v_add_f32 v179, v126, v179
v_add_f32 v179, v127, v179
v_cvt_pk_bf16_f32 v142, v124, v125
v_cvt_pk_bf16_f32 v143, v126, v127
s_waitcnt lgkmcnt(0)
v_mfma_f32_16x16x32_bf16 a[0:3], a[192:195], v[128:131], a[0:3]
v_mfma_f32_16x16x32_bf16 a[4:7], a[192:195], v[132:135], a[4:7]
v_mfma_f32_16x16x32_bf16 a[8:11], a[192:195], v[136:139], a[8:11]
v_mfma_f32_16x16x32_bf16 a[12:15], a[192:195], v[140:143], a[12:15]
v_mfma_f32_16x16x32_bf16 a[16:19], a[196:199], v[128:131], a[16:19]
v_mfma_f32_16x16x32_bf16 a[20:23], a[196:199], v[132:135], a[20:23]
v_mfma_f32_16x16x32_bf16 a[24:27], a[196:199], v[136:139], a[24:27]
v_mfma_f32_16x16x32_bf16 a[28:31], a[196:199], v[140:143], a[28:31]
v_mfma_f32_16x16x32_bf16 a[32:35], a[200:203], v[128:131], a[32:35]
v_mfma_f32_16x16x32_bf16 a[36:39], a[200:203], v[132:135], a[36:39]
v_mfma_f32_16x16x32_bf16 a[40:43], a[200:203], v[136:139], a[40:43]
v_mfma_f32_16x16x32_bf16 a[44:47], a[200:203], v[140:143], a[44:47]
v_mfma_f32_16x16x32_bf16 a[48:51], a[204:207], v[128:131], a[48:51]
v_mfma_f32_16x16x32_bf16 a[52:55], a[204:207], v[132:135], a[52:55]
v_mfma_f32_16x16x32_bf16 a[56:59], a[204:207], v[136:139], a[56:59]
v_mfma_f32_16x16x32_bf16 a[60:63], a[204:207], v[140:143], a[60:63]
v_mfma_f32_16x16x32_bf16 a[64:67], a[208:211], v[128:131], a[64:67]
v_mfma_f32_16x16x32_bf16 a[68:71], a[208:211], v[132:135], a[68:71]
v_mfma_f32_16x16x32_bf16 a[72:75], a[208:211], v[136:139], a[72:75]
v_mfma_f32_16x16x32_bf16 a[76:79], a[208:211], v[140:143], a[76:79]
v_mfma_f32_16x16x32_bf16 a[80:83], a[212:215], v[128:131], a[80:83]
v_mfma_f32_16x16x32_bf16 a[84:87], a[212:215], v[132:135], a[84:87]
v_mfma_f32_16x16x32_bf16 a[88:91], a[212:215], v[136:139], a[88:91]
v_mfma_f32_16x16x32_bf16 a[92:95], a[212:215], v[140:143], a[92:95]
v_mfma_f32_16x16x32_bf16 a[96:99], a[216:219], v[128:131], a[96:99]
v_mfma_f32_16x16x32_bf16 a[100:103], a[216:219], v[132:135], a[100:103]
v_mfma_f32_16x16x32_bf16 a[104:107], a[216:219], v[136:139], a[104:107]
v_mfma_f32_16x16x32_bf16 a[108:111], a[216:219], v[140:143], a[108:111]
v_mfma_f32_16x16x32_bf16 a[112:115], a[220:223], v[128:131], a[112:115]
v_mfma_f32_16x16x32_bf16 a[116:119], a[220:223], v[132:135], a[116:119]
v_mfma_f32_16x16x32_bf16 a[120:123], a[220:223], v[136:139], a[120:123]
v_mfma_f32_16x16x32_bf16 a[124:127], a[220:223], v[140:143], a[124:127]
v_mfma_f32_16x16x32_bf16 a[128:131], a[224:227], v[128:131], a[128:131]
v_mfma_f32_16x16x32_bf16 a[132:135], a[224:227], v[132:135], a[132:135]
v_mfma_f32_16x16x32_bf16 a[136:139], a[224:227], v[136:139], a[136:139]
v_mfma_f32_16x16x32_bf16 a[140:143], a[224:227], v[140:143], a[140:143]
v_mfma_f32_16x16x32_bf16 a[144:147], a[228:231], v[128:131], a[144:147]
v_mfma_f32_16x16x32_bf16 a[148:151], a[228:231], v[132:135], a[148:151]
v_mfma_f32_16x16x32_bf16 a[152:155], a[228:231], v[136:139], a[152:155]
v_mfma_f32_16x16x32_bf16 a[156:159], a[228:231], v[140:143], a[156:159]
v_mfma_f32_16x16x32_bf16 a[160:163], a[232:235], v[128:131], a[160:163]
v_mfma_f32_16x16x32_bf16 a[164:167], a[232:235], v[132:135], a[164:167]
v_mfma_f32_16x16x32_bf16 a[168:171], a[232:235], v[136:139], a[168:171]
v_mfma_f32_16x16x32_bf16 a[172:175], a[232:235], v[140:143], a[172:175]
v_mfma_f32_16x16x32_bf16 a[176:179], a[236:239], v[128:131], a[176:179]
v_mfma_f32_16x16x32_bf16 a[180:183], a[236:239], v[132:135], a[180:183]
v_mfma_f32_16x16x32_bf16 a[184:187], a[236:239], v[136:139], a[184:187]
v_mfma_f32_16x16x32_bf16 a[188:191], a[236:239], v[140:143], a[188:191]
s_nop 7
s_sub_u32 s35, s35, 1
s_cmp_lg_u32 s35, 0
s_cbranch_scc1 adaLN_cond__sliding_block_cached__glu_gated_swiglu__prompt_kernel_c_redo_loop
v_mov_b32 v184, v176
s_nop 1
v_permlane32_swap_b32 v184, v176
v_add_f32 v176, v184, v176
v_mov_b32 v184, v176
s_nop 1
v_permlane16_swap_b32 v184, v176
v_add_f32 v176, v184, v176
v_mov_b32 v184, v177
s_nop 1
v_permlane32_swap_b32 v184, v177
v_add_f32 v177, v184, v177
v_mov_b32 v184, v177
s_nop 1
v_permlane16_swap_b32 v184, v177
v_add_f32 v177, v184, v177
v_mov_b32 v184, v178
s_nop 1
v_permlane32_swap_b32 v184, v178
v_add_f32 v178, v184, v178
v_mov_b32 v184, v178
s_nop 1
v_permlane16_swap_b32 v184, v178
v_add_f32 v178, v184, v178
v_mov_b32 v184, v179
s_nop 1
v_permlane32_swap_b32 v184, v179
v_add_f32 v179, v184, v179
v_mov_b32 v184, v179
s_nop 1
v_permlane16_swap_b32 v184, v179
v_add_f32 v179, v184, v179
s_waitcnt lgkmcnt(0)
s_barrier
s_branch adaLN_cond__sliding_block_cached__glu_gated_swiglu__prompt_kernel_c_rows_done
adaLN_cond__sliding_block_cached__glu_gated_swiglu__prompt_kernel_end:
  s_endpgm
.section .rodata,"a"
.p2align 6
.amdhsa_kernel adaLN_cond__sliding_block_cached__glu_gated_swiglu__prompt_kernel
  .amdhsa_next_free_vgpr 512
  .amdhsa_next_free_sgpr 102
  .amdhsa_accum_offset 256
  .amdhsa_group_segment_fixed_size 0
  .amdhsa_kernarg_size 112
  .amdhsa_user_sgpr_count 2
  .amdhsa_user_sgpr_kernarg_segment_ptr 1
  .amdhsa_system_sgpr_workgroup_id_x 1
.end_amdhsa_kernel
```
